```python
import torch

def _softmax(x, axis=-1):
    return torch.softmax(x, dim=axis)

def _gelu(x):
    return torch.nn.functional.gelu(x, approximate='tanh')

def _silu(x):
    return torch.nn.functional.silu(x)

def _sigmoid(x):
    return torch.sigmoid(x)

def _layernorm(x, axis=-1, eps=1e-05):
    m = x.mean(dim=axis, keepdim=True)
    v = x.var(dim=axis, keepdim=True, unbiased=False)
    return (x - m) / torch.sqrt(v + eps)

def _scatter_add(tgt, idx, src, axis=0):
    return tgt.clone().index_add_(axis, idx, src)

def _segment_sum(src, seg, n):
    out = torch.zeros((n,) + src.shape[1:], dtype=src.dtype)
    return out.index_add_(0, seg, src)

def _pad(x, pw):
    flat = tuple((v for pair in reversed(pw) for v in pair))
    return torch.nn.functional.pad(x, flat)
kernel_name = 'gated_mix__ssm_conv_s4d__mixer_gmlp__prompt'

def setup_inputs():

    _w = lambda a: (lambda t: t.to(torch.bfloat16) if t.is_floating_point() else t)(torch.as_tensor(a))

    def _A_setup():
        Bsz, L, D, N = (1, 2048, 512, 128)
        return {'u': _w((lambda *s: torch.randn(*s, dtype=torch.bfloat16) * 0.05)(Bsz, L, D)), 'log_A_real': _w((lambda *s: torch.randn(*s, dtype=torch.bfloat16) * 12.8)(D, N) * 0.5), 'A_imag': _w((lambda *s: torch.randn(*s, dtype=torch.bfloat16) * 0.05)(D, N) * 3.14), 'C_real': _w((lambda *s: torch.randn(*s, dtype=torch.bfloat16) * 1.6)(D, N) / N ** 0.5), 'C_imag': _w((lambda *s: torch.randn(*s, dtype=torch.bfloat16) * 3.2)(D, N) / N ** 0.5), 'log_dt': _w((lambda *s: torch.randn(*s, dtype=torch.bfloat16) * 0.05)(D) * 0.5 - 4.0), 'D_skip': _w((lambda *s: torch.randn(*s, dtype=torch.bfloat16) * 0.8)(D))}
    _A_in = _A_setup()

    def _B_setup():
        B, S, D, F = (1, 2048, 512, 1792)
        Fh = F // 2
        return {'x': _w((lambda *s: torch.randn(*s, dtype=torch.bfloat16) * 0.05)(B, S, D)), 'w_in': _w((lambda *s: torch.randn(*s, dtype=torch.bfloat16) * 0.4)(D, 2 * Fh)), 'w_sp': _w(0.01 * (lambda *s: torch.randn(*s, dtype=torch.bfloat16) * 0.4)(S, S)), 'b_sp': _w(1.0 + 0.01 * (lambda *s: torch.randn(*s, dtype=torch.bfloat16) * 0.05)(S)), 'w_out': _w((lambda *s: torch.randn(*s, dtype=torch.bfloat16) * 0.05)(Fh, D))}
    _B_in = _B_setup()
    return {'A_u': _A_in['u'], 'A_log_A_real': _A_in['log_A_real'], 'A_A_imag': _A_in['A_imag'], 'A_C_real': _A_in['C_real'], 'A_C_imag': _A_in['C_imag'], 'A_log_dt': _A_in['log_dt'], 'A_D_skip': _A_in['D_skip'], 'B_x': _B_in['x'], 'B_w_in': _B_in['w_in'], 'B_w_sp': _B_in['w_sp'], 'B_b_sp': _B_in['b_sp'], 'B_w_out': _B_in['w_out'], 'gate_w': _w((lambda *s: torch.randn(*s, dtype=torch.bfloat16) * 0.05)(512) * 16.0)}

def reference(A_u, A_log_A_real, A_A_imag, A_C_real, A_C_imag, A_log_dt, A_D_skip, B_x, B_w_in, B_w_sp, B_b_sp, B_w_out, gate_w):

    def _A_ref(u, log_A_real, A_imag, C_real, C_imag, log_dt, D_skip):
        L = u.shape[1]
        dt = torch.exp(log_dt)
        A = -torch.exp(log_A_real) + 1j * A_imag
        C = (C_real + 1j * C_imag) * dt[:, None]
        pos = (lambda x, dt: x.to(dt))(torch.arange(L), log_dt.dtype)
        P = torch.exp((A * dt[:, None])[:, :, None] * pos[None, None, :])
        K = 2.0 * torch.einsum('dn,dnl->dl', C, P).real
        L2 = 2 * L
        u_t = (lambda x, *d: x.permute(*d))(u, 0, 2, 1)
        Kf = (lambda x, *a, **k: torch.fft.rfft(x.float(), *a, **k))(K, L2)
        Uf = (lambda x, *a, **k: torch.fft.rfft(x.float(), *a, **k))(u_t, L2)
        y = (lambda x, *a, **k: torch.fft.irfft(x, *a, **k).to(torch.bfloat16))(Uf * Kf[None, :, :], L2)[:, :, :L]
        y = (lambda x, *d: x.permute(*d))(y, 0, 2, 1)
        return y + u * D_skip[None, None, :]

    def _B_ref(x, w_in, w_sp, b_sp, w_out):
        B, S, D = x.shape
        F = w_in.shape[-1]
        Fh = F // 2
        z = _gelu(torch.einsum('bsd,df->bsf', x, w_in))
        z1 = z[..., :Fh].clone()
        z2 = _layernorm(z[..., Fh:], axis=-1)
        g = torch.einsum('ts,bsf->btf', w_sp, z2) + b_sp[None, :, None]
        return torch.einsum('bsf,fd->bsd', z1 * g, w_out)
    x = A_u
    g = _sigmoid((x * gate_w).sum(-1, keepdims=True))
    a = _A_ref(x, A_log_A_real, A_A_imag, A_C_real, A_C_imag, A_log_dt, A_D_skip)
    b = _B_ref(x, B_w_in, B_w_sp, B_b_sp, B_w_out)
    return g * a + (1 - g) * b
```

```asm
; @launch grid=(256,1,1) block=(512,1,1) lds=162816
.amdgcn_target "amdgcn-amd-amdhsa--gfx950"
.text
.globl gated_mix__ssm_conv_s4d__mixer_gmlp__prompt_kernel
.p2align 8
.type gated_mix__ssm_conv_s4d__mixer_gmlp__prompt_kernel,@function
gated_mix__ssm_conv_s4d__mixer_gmlp__prompt_kernel:
code_begin:
  s_cmp_ge_u32 s2, 256
  s_cbranch_scc1 pk_end
  v_and_b32 v1, 63, v0
  v_lshrrev_b32 v3, 6, v0
  s_nop 0
  v_readfirstlane_b32 s4, v3
  s_and_b32 s54, s2, 7
  s_lshr_b32 s55, s2, 3
  s_mov_b32 s53, 0
  s_mov_b32 s42, 17932288
  s_mov_b32 s43, 0x20000
  s_cmp_ge_u32 s4, 4
  s_cbranch_scc1 pk_conv
  s_load_dwordx2 s[8:9], s[0:1], 0
  s_load_dwordx16 s[24:39], s[0:1], 64
  s_cmp_ge_u32 s55, 28
  s_cbranch_scc1 pk_spare
  s_mul_i32 s14, s55, 37
  s_lshr_b32 s14, s14, 8
  s_lshl_b32 s12, s54, 2
  s_add_u32 s12, s12, s14
  s_mul_i32 s13, s14, 7
  s_sub_u32 s13, s55, s13
  s_lshl_b32 s14, s14, 1
  s_add_u32 s14, s14, s13
  s_lshr_b32 s10, s4, 1
  s_and_b32 s11, s4, 1
  s_lshl_b32 s15, s4, 11
  s_add_u32 s15, s15, 81920
  s_lshl_b32 s16, s4, 12
  s_lshl_b32 s21, s12, 16
  s_lshl_b32 s5, s4, 14
  s_add_u32 s21, s21, s5
  s_lshl_b32 s20, s13, 8
  s_mul_i32 s5, s4, 57344
  s_add_u32 s20, s20, s5
  s_add_u32 s19, s20, 1792
  v_lshrrev_b32 v3, 3, v1
  v_lshrrev_b32 v4, 4, v1
  v_and_b32 v5, 7, v1
  v_xor_b32 v5, v5, v4
  v_lshlrev_b32 v3, 10, v3
  v_lshl_add_u32 v7, v5, 4, v3
  v_xor_b32 v8, 64, v7
  v_add_u32 v8, 7168, v8
  v_and_b32 v5, 15, v1
  v_lshlrev_b32 v3, 2, v4
  v_xor_b32 v5, v5, v3
  v_mul_u32_u24 v3, 3584, v4
  v_lshl_add_u32 v9, v5, 4, v3
  v_add_u32 v10, 13312, v9
  v_add_u32 v11, 26624, v9
  v_add_u32 v12, 39936, v9
  s_waitcnt lgkmcnt(0)
  s_mov_b32 s40, s38
  s_mov_b32 s41, s39
  s_mov_b32 s44, s8
  s_mov_b32 s45, s9
  s_mov_b32 s46, 2097152
  s_mov_b32 s47, 0x20000
  s_mov_b32 s48, s24
  s_mov_b32 s49, s25
  s_mov_b32 s50, 1835008
  s_mov_b32 s51, 0x20000
  s_barrier
  s_setprio 1
  s_add_u32 s5, s14, 0
  s_and_b32 s5, s5, 7
  s_lshl_b32 s17, s5, 7
  s_add_u32 s17, s17, s21
  s_mul_i32 s18, s5, 229376
  s_add_u32 s18, s18, s19
  s_add_u32 m0, s15, 0
  s_nop 0
  buffer_load_dwordx4 v7, s[44:47], s17 offen offset:0  lds
  buffer_load_dwordx4 v8, s[44:47], s17 offen offset:1024  lds
  s_add_u32 m0, s16, 0
  s_nop 0
  buffer_load_dwordx4 v9, s[48:51], s18 offen offset:0  lds
  buffer_load_dwordx4 v10, s[48:51], s18 offen offset:1024  lds
  buffer_load_dwordx4 v11, s[48:51], s18 offen offset:2048  lds
  buffer_load_dwordx4 v12, s[48:51], s18 offen offset:3072  lds
  s_mov_b32 s5, 17367040
  buffer_load_dword v21, off, s[40:43], s5 sc1
  s_add_u32 s5, s14, 1
  s_and_b32 s5, s5, 7
  s_lshl_b32 s17, s5, 7
  s_add_u32 s17, s17, s21
  s_mul_i32 s18, s5, 229376
  s_add_u32 s18, s18, s19
  s_add_u32 m0, s15, 8192
  s_nop 0
  buffer_load_dwordx4 v7, s[44:47], s17 offen offset:0  lds
  buffer_load_dwordx4 v8, s[44:47], s17 offen offset:1024  lds
  s_add_u32 m0, s16, 16384
  s_nop 0
  buffer_load_dwordx4 v9, s[48:51], s18 offen offset:0  lds
  buffer_load_dwordx4 v10, s[48:51], s18 offen offset:1024  lds
  buffer_load_dwordx4 v11, s[48:51], s18 offen offset:2048  lds
  buffer_load_dwordx4 v12, s[48:51], s18 offen offset:3072  lds
  v_and_b32 v3, 31, v1
  v_lshrrev_b32 v4, 5, v1
  v_bfe_u32 v5, v1, 1, 3
  v_xor_b32 v5, v5, v4
  v_lshlrev_b32 v3, 7, v3
  v_lshl_add_u32 v13, v5, 4, v3
  s_lshl_b32 s5, s10, 12
  s_add_u32 s5, s5, 81920
  v_add_u32 v13, s5, v13
  v_xor_b32 v14, 32, v13
  v_xor_b32 v15, 64, v13
  v_xor_b32 v16, 96, v13
  v_bfe_u32 v3, v1, 2, 2
  v_lshrrev_b32 v4, 5, v1
  v_lshl_add_u32 v4, v4, 3, v3
  v_lshlrev_b32 v4, 8, v4
  s_lshl_b32 s5, s11, 1
  v_xor_b32 v3, s5, v3
  v_lshl_add_u32 v4, v3, 6, v4
  v_bfe_u32 v3, v1, 4, 1
  v_lshl_add_u32 v4, v3, 5, v4
  v_and_b32 v3, 3, v1
  v_lshl_add_u32 v17, v3, 3, v4
  v_xor_b32 v18, 64, v17
  v_add_u32 v19, 0x10000, v17
  v_add_u32 v20, 0x10000, v18
  v_mov_b32 v24, 0xbdd2d3e8
  v_mov_b32 v26, 0xc0135761
  v_mov_b32 v28, 1.0
  v_mov_b32 v25, 0xbdd2d3e8
  v_mov_b32 v27, 0xc0135761
  v_mov_b32 v29, 1.0
  v_lshlrev_b32 v38, 3, v1
  v_bfe_u32 v3, v1, 4, 1
  v_lshrrev_b32 v4, 5, v1
  v_and_b32 v5, 15, v1
  v_lshlrev_b32 v5, 4, v5
  v_lshl_add_u32 v5, v4, 8, v5
  v_lshl_add_u32 v40, v3, 10, v5
  v_mul_u32_u24 v3, 28672, v3
  v_add_u32 v39, v3, v5
  s_mov_b32 s92, 0xcccccccc
  s_mov_b32 s93, 0xcccccccc
  s_mov_b32 s94, 0xaaaaaaaa
  s_mov_b32 s95, 0xaaaaaaaa
  s_waitcnt vmcnt(6)
  v_readfirstlane_b32 s52, v21
  s_mul_i32 s5, s52, 0x9e3779b1
  s_add_u32 s5, s5, 0x7f4a7c15
  v_mov_b32 v2, s5
  v_mov_b32 v23, v2
  s_barrier
  ds_read_b128 v[140:143], v13 offset:0
  ds_read_b64_tr_b16 v[108:109], v17 offset:0
  ds_read_b64_tr_b16 v[110:111], v17 offset:1024
  ds_read_b64_tr_b16 v[112:113], v18 offset:0
  ds_read_b64_tr_b16 v[114:115], v18 offset:1024
  ds_read_b128 v[144:147], v14 offset:0
  ds_read_b64_tr_b16 v[116:117], v17 offset:4096
  ds_read_b64_tr_b16 v[118:119], v17 offset:5120
  ds_read_b64_tr_b16 v[120:121], v18 offset:4096
  ds_read_b64_tr_b16 v[122:123], v18 offset:5120
  ds_read_b128 v[148:151], v15 offset:0
  ds_read_b64_tr_b16 v[124:125], v17 offset:8192
  ds_read_b64_tr_b16 v[126:127], v17 offset:9216
  ds_read_b64_tr_b16 v[128:129], v18 offset:8192
  ds_read_b64_tr_b16 v[130:131], v18 offset:9216
  ds_read_b128 v[152:155], v16 offset:0
  ds_read_b64_tr_b16 v[132:133], v17 offset:12288
  ds_read_b64_tr_b16 v[134:135], v17 offset:13312
  ds_read_b64_tr_b16 v[136:137], v18 offset:12288
  ds_read_b64_tr_b16 v[138:139], v18 offset:13312
  s_waitcnt vmcnt(0)
  s_barrier
  s_add_u32 s5, s14, 2
  s_and_b32 s5, s5, 7
  s_lshl_b32 s17, s5, 7
  s_add_u32 s17, s17, s21
  s_mul_i32 s18, s5, 229376
  s_add_u32 s18, s18, s19
  s_waitcnt lgkmcnt(15)
  v_mfma_f32_32x32x16_bf16 v[44:59], v[140:143], v[108:111], 0
  s_add_u32 m0, s15, 16384
  s_nop 0
  buffer_load_dwordx4 v7, s[44:47], s17 offen offset:0  lds
  v_mfma_f32_32x32x16_bf16 v[60:75], v[140:143], v[112:115], 0
  buffer_load_dwordx4 v8, s[44:47], s17 offen offset:1024  lds
  ds_read_b128 v[156:159], v13 offset:8192
  ds_read_b64_tr_b16 v[108:109], v17 offset:16384
  ds_read_b64_tr_b16 v[110:111], v17 offset:17408
  ds_read_b64_tr_b16 v[112:113], v18 offset:16384
  ds_read_b64_tr_b16 v[114:115], v18 offset:17408
  s_waitcnt lgkmcnt(15)
  v_mfma_f32_32x32x16_bf16 v[44:59], v[144:147], v[116:119], v[44:59]
  s_add_u32 m0, s16, 32768
  s_nop 0
  buffer_load_dwordx4 v9, s[48:51], s18 offen offset:0  lds
  v_mfma_f32_32x32x16_bf16 v[60:75], v[144:147], v[120:123], v[60:75]
  buffer_load_dwordx4 v10, s[48:51], s18 offen offset:1024  lds
  ds_read_b128 v[160:163], v14 offset:8192
  ds_read_b64_tr_b16 v[116:117], v17 offset:20480
  ds_read_b64_tr_b16 v[118:119], v17 offset:21504
  ds_read_b64_tr_b16 v[120:121], v18 offset:20480
  ds_read_b64_tr_b16 v[122:123], v18 offset:21504
  s_waitcnt lgkmcnt(15)
  v_mfma_f32_32x32x16_bf16 v[44:59], v[148:151], v[124:127], v[44:59]
  buffer_load_dwordx4 v11, s[48:51], s18 offen offset:2048  lds
  v_mfma_f32_32x32x16_bf16 v[60:75], v[148:151], v[128:131], v[60:75]
  buffer_load_dwordx4 v12, s[48:51], s18 offen offset:3072  lds
  ds_read_b128 v[164:167], v15 offset:8192
  ds_read_b64_tr_b16 v[124:125], v17 offset:24576
  ds_read_b64_tr_b16 v[126:127], v17 offset:25600
  ds_read_b64_tr_b16 v[128:129], v18 offset:24576
  ds_read_b64_tr_b16 v[130:131], v18 offset:25600
  s_waitcnt lgkmcnt(15)
  v_mfma_f32_32x32x16_bf16 v[44:59], v[152:155], v[132:135], v[44:59]
  s_add_u32 s5, s14, 3
  s_and_b32 s5, s5, 7
  s_lshl_b32 s17, s5, 7
  s_add_u32 s17, s17, s21
  s_mul_i32 s18, s5, 229376
  s_add_u32 s18, s18, s19
  v_mfma_f32_32x32x16_bf16 v[60:75], v[152:155], v[136:139], v[60:75]
  s_add_u32 m0, s15, 24576
  s_nop 0
  buffer_load_dwordx4 v7, s[44:47], s17 offen offset:0  lds
  ds_read_b128 v[168:171], v16 offset:8192
  ds_read_b64_tr_b16 v[132:133], v17 offset:28672
  ds_read_b64_tr_b16 v[134:135], v17 offset:29696
  ds_read_b64_tr_b16 v[136:137], v18 offset:28672
  ds_read_b64_tr_b16 v[138:139], v18 offset:29696
  buffer_load_dwordx4 v8, s[44:47], s17 offen offset:1024  lds
  s_add_u32 m0, s16, 49152
  s_nop 0
  buffer_load_dwordx4 v9, s[48:51], s18 offen offset:0  lds
  buffer_load_dwordx4 v10, s[48:51], s18 offen offset:1024  lds
  buffer_load_dwordx4 v11, s[48:51], s18 offen offset:2048  lds
  buffer_load_dwordx4 v12, s[48:51], s18 offen offset:3072  lds
  s_waitcnt vmcnt(6)
  s_barrier
  s_add_u32 s5, s14, 4
  s_and_b32 s5, s5, 7
  s_lshl_b32 s17, s5, 7
  s_add_u32 s17, s17, s21
  s_mul_i32 s18, s5, 229376
  s_add_u32 s18, s18, s19
  s_waitcnt lgkmcnt(15)
  v_mfma_f32_32x32x16_bf16 v[44:59], v[156:159], v[108:111], v[44:59]
  s_add_u32 m0, s15, 32768
  s_nop 0
  buffer_load_dwordx4 v7, s[44:47], s17 offen offset:0  lds
  v_mfma_f32_32x32x16_bf16 v[60:75], v[156:159], v[112:115], v[60:75]
  buffer_load_dwordx4 v8, s[44:47], s17 offen offset:1024  lds
  ds_read_b128 v[172:175], v13 offset:16384
  ds_read_b64_tr_b16 v[108:109], v17 offset:32768
  ds_read_b64_tr_b16 v[110:111], v17 offset:33792
  ds_read_b64_tr_b16 v[112:113], v18 offset:32768
  ds_read_b64_tr_b16 v[114:115], v18 offset:33792
  s_waitcnt lgkmcnt(15)
  v_mfma_f32_32x32x16_bf16 v[44:59], v[160:163], v[116:119], v[44:59]
  s_add_u32 m0, s16, 65536
  s_nop 0
  buffer_load_dwordx4 v9, s[48:51], s18 offen offset:0  lds
  v_mfma_f32_32x32x16_bf16 v[60:75], v[160:163], v[120:123], v[60:75]
  buffer_load_dwordx4 v10, s[48:51], s18 offen offset:1024  lds
  ds_read_b128 v[176:179], v14 offset:16384
  ds_read_b64_tr_b16 v[116:117], v17 offset:36864
  ds_read_b64_tr_b16 v[118:119], v17 offset:37888
  ds_read_b64_tr_b16 v[120:121], v18 offset:36864
  ds_read_b64_tr_b16 v[122:123], v18 offset:37888
  s_waitcnt lgkmcnt(15)
  v_mfma_f32_32x32x16_bf16 v[44:59], v[164:167], v[124:127], v[44:59]
  buffer_load_dwordx4 v11, s[48:51], s18 offen offset:2048  lds
  v_mfma_f32_32x32x16_bf16 v[60:75], v[164:167], v[128:131], v[60:75]
  buffer_load_dwordx4 v12, s[48:51], s18 offen offset:3072  lds
  ds_read_b128 v[180:183], v15 offset:16384
  ds_read_b64_tr_b16 v[124:125], v17 offset:40960
  ds_read_b64_tr_b16 v[126:127], v17 offset:41984
  ds_read_b64_tr_b16 v[128:129], v18 offset:40960
  ds_read_b64_tr_b16 v[130:131], v18 offset:41984
  s_waitcnt lgkmcnt(15)
  v_mfma_f32_32x32x16_bf16 v[44:59], v[168:171], v[132:135], v[44:59]
  s_add_u32 s5, s14, 5
  s_and_b32 s5, s5, 7
  s_lshl_b32 s17, s5, 7
  s_add_u32 s17, s17, s21
  s_mul_i32 s18, s5, 229376
  s_add_u32 s18, s18, s19
  v_mfma_f32_32x32x16_bf16 v[60:75], v[168:171], v[136:139], v[60:75]
  s_add_u32 m0, s15, 40960
  s_nop 0
  buffer_load_dwordx4 v7, s[44:47], s17 offen offset:0  lds
  ds_read_b128 v[184:187], v16 offset:16384
  ds_read_b64_tr_b16 v[132:133], v17 offset:45056
  ds_read_b64_tr_b16 v[134:135], v17 offset:46080
  ds_read_b64_tr_b16 v[136:137], v18 offset:45056
  ds_read_b64_tr_b16 v[138:139], v18 offset:46080
  buffer_load_dwordx4 v8, s[44:47], s17 offen offset:1024  lds
  s_add_u32 m0, s16, 0
  s_nop 0
  buffer_load_dwordx4 v9, s[48:51], s18 offen offset:0  lds
  buffer_load_dwordx4 v10, s[48:51], s18 offen offset:1024  lds
  buffer_load_dwordx4 v11, s[48:51], s18 offen offset:2048  lds
  buffer_load_dwordx4 v12, s[48:51], s18 offen offset:3072  lds
  s_waitcnt vmcnt(12)
  s_barrier
  s_add_u32 s5, s14, 6
  s_and_b32 s5, s5, 7
  s_lshl_b32 s17, s5, 7
  s_add_u32 s17, s17, s21
  s_mul_i32 s18, s5, 229376
  s_add_u32 s18, s18, s19
  s_waitcnt lgkmcnt(15)
  v_mfma_f32_32x32x16_bf16 v[44:59], v[172:175], v[108:111], v[44:59]
  s_add_u32 m0, s15, 49152
  s_nop 0
  buffer_load_dwordx4 v7, s[44:47], s17 offen offset:0  lds
  v_mfma_f32_32x32x16_bf16 v[60:75], v[172:175], v[112:115], v[60:75]
  buffer_load_dwordx4 v8, s[44:47], s17 offen offset:1024  lds
  ds_read_b128 v[188:191], v13 offset:24576
  ds_read_b64_tr_b16 v[108:109], v17 offset:49152
  ds_read_b64_tr_b16 v[110:111], v17 offset:50176
  ds_read_b64_tr_b16 v[112:113], v18 offset:49152
  ds_read_b64_tr_b16 v[114:115], v18 offset:50176
  s_waitcnt lgkmcnt(15)
  v_mfma_f32_32x32x16_bf16 v[44:59], v[176:179], v[116:119], v[44:59]
  s_add_u32 m0, s16, 16384
  s_nop 0
  buffer_load_dwordx4 v9, s[48:51], s18 offen offset:0  lds
  v_mfma_f32_32x32x16_bf16 v[60:75], v[176:179], v[120:123], v[60:75]
  buffer_load_dwordx4 v10, s[48:51], s18 offen offset:1024  lds
  ds_read_b128 v[192:195], v14 offset:24576
  ds_read_b64_tr_b16 v[116:117], v17 offset:53248
  ds_read_b64_tr_b16 v[118:119], v17 offset:54272
  ds_read_b64_tr_b16 v[120:121], v18 offset:53248
  ds_read_b64_tr_b16 v[122:123], v18 offset:54272
  s_waitcnt lgkmcnt(15)
  v_mfma_f32_32x32x16_bf16 v[44:59], v[180:183], v[124:127], v[44:59]
  buffer_load_dwordx4 v11, s[48:51], s18 offen offset:2048  lds
  v_mfma_f32_32x32x16_bf16 v[60:75], v[180:183], v[128:131], v[60:75]
  buffer_load_dwordx4 v12, s[48:51], s18 offen offset:3072  lds
  ds_read_b128 v[196:199], v15 offset:24576
  ds_read_b64_tr_b16 v[124:125], v17 offset:57344
  ds_read_b64_tr_b16 v[126:127], v17 offset:58368
  ds_read_b64_tr_b16 v[128:129], v18 offset:57344
  ds_read_b64_tr_b16 v[130:131], v18 offset:58368
  s_waitcnt lgkmcnt(15)
  v_mfma_f32_32x32x16_bf16 v[44:59], v[184:187], v[132:135], v[44:59]
  v_mfma_f32_32x32x16_bf16 v[60:75], v[184:187], v[136:139], v[60:75]
  ds_read_b128 v[200:203], v16 offset:24576
  ds_read_b64_tr_b16 v[132:133], v17 offset:61440
  ds_read_b64_tr_b16 v[134:135], v17 offset:62464
  ds_read_b64_tr_b16 v[136:137], v18 offset:61440
  ds_read_b64_tr_b16 v[138:139], v18 offset:62464
  s_waitcnt vmcnt(12)
  s_barrier
  s_add_u32 s5, s14, 7
  s_and_b32 s5, s5, 7
  s_lshl_b32 s17, s5, 7
  s_add_u32 s17, s17, s21
  s_mul_i32 s18, s5, 229376
  s_add_u32 s18, s18, s19
  s_waitcnt lgkmcnt(15)
  v_mfma_f32_32x32x16_bf16 v[44:59], v[188:191], v[108:111], v[44:59]
  s_add_u32 m0, s15, 57344
  s_nop 0
  buffer_load_dwordx4 v7, s[44:47], s17 offen offset:0  lds
  v_mfma_f32_32x32x16_bf16 v[60:75], v[188:191], v[112:115], v[60:75]
  buffer_load_dwordx4 v8, s[44:47], s17 offen offset:1024  lds
  ds_read_b128 v[204:207], v13 offset:32768
  ds_read_b64_tr_b16 v[108:109], v19 offset:0
  ds_read_b64_tr_b16 v[110:111], v19 offset:1024
  ds_read_b64_tr_b16 v[112:113], v20 offset:0
  ds_read_b64_tr_b16 v[114:115], v20 offset:1024
  s_waitcnt lgkmcnt(15)
  v_mfma_f32_32x32x16_bf16 v[44:59], v[192:195], v[116:119], v[44:59]
  s_add_u32 m0, s16, 32768
  s_nop 0
  buffer_load_dwordx4 v9, s[48:51], s18 offen offset:0  lds
  v_mfma_f32_32x32x16_bf16 v[60:75], v[192:195], v[120:123], v[60:75]
  buffer_load_dwordx4 v10, s[48:51], s18 offen offset:1024  lds
  ds_read_b128 v[208:211], v14 offset:32768
  ds_read_b64_tr_b16 v[116:117], v19 offset:4096
  ds_read_b64_tr_b16 v[118:119], v19 offset:5120
  ds_read_b64_tr_b16 v[120:121], v20 offset:4096
  ds_read_b64_tr_b16 v[122:123], v20 offset:5120
  s_waitcnt lgkmcnt(15)
  v_mfma_f32_32x32x16_bf16 v[44:59], v[196:199], v[124:127], v[44:59]
  buffer_load_dwordx4 v11, s[48:51], s18 offen offset:2048  lds
  v_mfma_f32_32x32x16_bf16 v[60:75], v[196:199], v[128:131], v[60:75]
  buffer_load_dwordx4 v12, s[48:51], s18 offen offset:3072  lds
  ds_read_b128 v[212:215], v15 offset:32768
  ds_read_b64_tr_b16 v[124:125], v19 offset:8192
  ds_read_b64_tr_b16 v[126:127], v19 offset:9216
  ds_read_b64_tr_b16 v[128:129], v20 offset:8192
  ds_read_b64_tr_b16 v[130:131], v20 offset:9216
  s_waitcnt lgkmcnt(15)
  v_mfma_f32_32x32x16_bf16 v[44:59], v[200:203], v[132:135], v[44:59]
  v_mfma_f32_32x32x16_bf16 v[60:75], v[200:203], v[136:139], v[60:75]
  ds_read_b128 v[216:219], v16 offset:32768
  ds_read_b64_tr_b16 v[132:133], v19 offset:12288
  ds_read_b64_tr_b16 v[134:135], v19 offset:13312
  ds_read_b64_tr_b16 v[136:137], v20 offset:12288
  ds_read_b64_tr_b16 v[138:139], v20 offset:13312
  s_waitcnt vmcnt(12)
  s_barrier
  s_add_u32 s5, s14, 0
  s_and_b32 s5, s5, 7
  s_mul_i32 s18, s5, 229376
  s_add_u32 s18, s18, s20
  s_waitcnt lgkmcnt(15)
  v_mfma_f32_32x32x16_bf16 v[44:59], v[204:207], v[108:111], v[44:59]
  s_add_u32 m0, s16, 49152
  s_nop 0
  buffer_load_dwordx4 v9, s[48:51], s18 offen offset:0  lds
  v_mfma_f32_32x32x16_bf16 v[60:75], v[204:207], v[112:115], v[60:75]
  buffer_load_dwordx4 v10, s[48:51], s18 offen offset:1024  lds
  ds_read_b128 v[220:223], v13 offset:40960
  ds_read_b64_tr_b16 v[108:109], v17 offset:0
  ds_read_b64_tr_b16 v[110:111], v17 offset:1024
  ds_read_b64_tr_b16 v[112:113], v18 offset:0
  ds_read_b64_tr_b16 v[114:115], v18 offset:1024
  s_waitcnt lgkmcnt(15)
  v_mfma_f32_32x32x16_bf16 v[44:59], v[208:211], v[116:119], v[44:59]
  buffer_load_dwordx4 v11, s[48:51], s18 offen offset:2048  lds
  v_mfma_f32_32x32x16_bf16 v[60:75], v[208:211], v[120:123], v[60:75]
  buffer_load_dwordx4 v12, s[48:51], s18 offen offset:3072  lds
  ds_read_b128 v[224:227], v14 offset:40960
  ds_read_b64_tr_b16 v[116:117], v17 offset:4096
  ds_read_b64_tr_b16 v[118:119], v17 offset:5120
  ds_read_b64_tr_b16 v[120:121], v18 offset:4096
  ds_read_b64_tr_b16 v[122:123], v18 offset:5120
  s_waitcnt lgkmcnt(15)
  v_mfma_f32_32x32x16_bf16 v[44:59], v[212:215], v[124:127], v[44:59]
  v_mfma_f32_32x32x16_bf16 v[60:75], v[212:215], v[128:131], v[60:75]
  ds_read_b128 v[228:231], v15 offset:40960
  ds_read_b64_tr_b16 v[124:125], v17 offset:8192
  ds_read_b64_tr_b16 v[126:127], v17 offset:9216
  ds_read_b64_tr_b16 v[128:129], v18 offset:8192
  ds_read_b64_tr_b16 v[130:131], v18 offset:9216
  s_waitcnt lgkmcnt(15)
  v_mfma_f32_32x32x16_bf16 v[44:59], v[216:219], v[132:135], v[44:59]
  v_mfma_f32_32x32x16_bf16 v[60:75], v[216:219], v[136:139], v[60:75]
  ds_read_b128 v[232:235], v16 offset:40960
  ds_read_b64_tr_b16 v[132:133], v17 offset:12288
  ds_read_b64_tr_b16 v[134:135], v17 offset:13312
  ds_read_b64_tr_b16 v[136:137], v18 offset:12288
  ds_read_b64_tr_b16 v[138:139], v18 offset:13312
  s_waitcnt vmcnt(10)
  s_barrier
  s_add_u32 s5, s14, 1
  s_and_b32 s5, s5, 7
  s_mul_i32 s18, s5, 229376
  s_add_u32 s18, s18, s20
  s_waitcnt lgkmcnt(15)
  v_mfma_f32_32x32x16_bf16 v[44:59], v[220:223], v[108:111], v[44:59]
  s_add_u32 m0, s16, 65536
  s_nop 0
  buffer_load_dwordx4 v9, s[48:51], s18 offen offset:0  lds
  v_mfma_f32_32x32x16_bf16 v[60:75], v[220:223], v[112:115], v[60:75]
  buffer_load_dwordx4 v10, s[48:51], s18 offen offset:1024  lds
  ds_read_b128 v[236:239], v13 offset:49152
  ds_read_b64_tr_b16 v[108:109], v17 offset:16384
  ds_read_b64_tr_b16 v[110:111], v17 offset:17408
  ds_read_b64_tr_b16 v[112:113], v18 offset:16384
  ds_read_b64_tr_b16 v[114:115], v18 offset:17408
  s_waitcnt lgkmcnt(15)
  v_mfma_f32_32x32x16_bf16 v[44:59], v[224:227], v[116:119], v[44:59]
  buffer_load_dwordx4 v11, s[48:51], s18 offen offset:2048  lds
  v_mfma_f32_32x32x16_bf16 v[60:75], v[224:227], v[120:123], v[60:75]
  buffer_load_dwordx4 v12, s[48:51], s18 offen offset:3072  lds
  ds_read_b128 v[240:243], v14 offset:49152
  ds_read_b64_tr_b16 v[116:117], v17 offset:20480
  ds_read_b64_tr_b16 v[118:119], v17 offset:21504
  ds_read_b64_tr_b16 v[120:121], v18 offset:20480
  ds_read_b64_tr_b16 v[122:123], v18 offset:21504
  s_waitcnt lgkmcnt(15)
  v_mfma_f32_32x32x16_bf16 v[44:59], v[228:231], v[124:127], v[44:59]
  v_mfma_f32_32x32x16_bf16 v[60:75], v[228:231], v[128:131], v[60:75]
  ds_read_b128 v[244:247], v15 offset:49152
  ds_read_b64_tr_b16 v[124:125], v17 offset:24576
  ds_read_b64_tr_b16 v[126:127], v17 offset:25600
  ds_read_b64_tr_b16 v[128:129], v18 offset:24576
  ds_read_b64_tr_b16 v[130:131], v18 offset:25600
  s_waitcnt lgkmcnt(15)
  v_mfma_f32_32x32x16_bf16 v[44:59], v[232:235], v[132:135], v[44:59]
  v_mfma_f32_32x32x16_bf16 v[60:75], v[232:235], v[136:139], v[60:75]
  ds_read_b128 v[248:251], v16 offset:49152
  ds_read_b64_tr_b16 v[132:133], v17 offset:28672
  ds_read_b64_tr_b16 v[134:135], v17 offset:29696
  ds_read_b64_tr_b16 v[136:137], v18 offset:28672
  ds_read_b64_tr_b16 v[138:139], v18 offset:29696
  s_waitcnt vmcnt(8)
  s_barrier
  s_add_u32 s5, s14, 2
  s_and_b32 s5, s5, 7
  s_mul_i32 s18, s5, 229376
  s_add_u32 s18, s18, s20
  s_waitcnt lgkmcnt(15)
  v_mfma_f32_32x32x16_bf16 v[44:59], v[236:239], v[108:111], v[44:59]
  s_add_u32 m0, s16, 0
  s_nop 0
  buffer_load_dwordx4 v9, s[48:51], s18 offen offset:0  lds
  v_mfma_f32_32x32x16_bf16 v[60:75], v[236:239], v[112:115], v[60:75]
  buffer_load_dwordx4 v10, s[48:51], s18 offen offset:1024  lds
  ds_read_b128 v[76:79], v13 offset:57344
  ds_read_b64_tr_b16 v[108:109], v17 offset:32768
  ds_read_b64_tr_b16 v[110:111], v17 offset:33792
  ds_read_b64_tr_b16 v[112:113], v18 offset:32768
  ds_read_b64_tr_b16 v[114:115], v18 offset:33792
  s_waitcnt lgkmcnt(15)
  v_mfma_f32_32x32x16_bf16 v[44:59], v[240:243], v[116:119], v[44:59]
  buffer_load_dwordx4 v11, s[48:51], s18 offen offset:2048  lds
  v_mfma_f32_32x32x16_bf16 v[60:75], v[240:243], v[120:123], v[60:75]
  buffer_load_dwordx4 v12, s[48:51], s18 offen offset:3072  lds
  ds_read_b128 v[80:83], v14 offset:57344
  ds_read_b64_tr_b16 v[116:117], v17 offset:36864
  ds_read_b64_tr_b16 v[118:119], v17 offset:37888
  ds_read_b64_tr_b16 v[120:121], v18 offset:36864
  ds_read_b64_tr_b16 v[122:123], v18 offset:37888
  s_waitcnt lgkmcnt(15)
  v_mfma_f32_32x32x16_bf16 v[44:59], v[244:247], v[124:127], v[44:59]
  v_mfma_f32_32x32x16_bf16 v[60:75], v[244:247], v[128:131], v[60:75]
  ds_read_b128 v[84:87], v15 offset:57344
  ds_read_b64_tr_b16 v[124:125], v17 offset:40960
  ds_read_b64_tr_b16 v[126:127], v17 offset:41984
  ds_read_b64_tr_b16 v[128:129], v18 offset:40960
  ds_read_b64_tr_b16 v[130:131], v18 offset:41984
  s_waitcnt lgkmcnt(15)
  v_mfma_f32_32x32x16_bf16 v[44:59], v[248:251], v[132:135], v[44:59]
  v_mfma_f32_32x32x16_bf16 v[60:75], v[248:251], v[136:139], v[60:75]
  ds_read_b128 v[88:91], v16 offset:57344
  ds_read_b64_tr_b16 v[132:133], v17 offset:45056
  ds_read_b64_tr_b16 v[134:135], v17 offset:46080
  ds_read_b64_tr_b16 v[136:137], v18 offset:45056
  ds_read_b64_tr_b16 v[138:139], v18 offset:46080
  s_waitcnt vmcnt(8)
  s_barrier
  s_add_u32 s5, s14, 3
  s_and_b32 s5, s5, 7
  s_mul_i32 s18, s5, 229376
  s_add_u32 s18, s18, s20
  s_waitcnt lgkmcnt(15)
  v_mfma_f32_32x32x16_bf16 v[44:59], v[76:79], v[108:111], v[44:59]
  s_add_u32 m0, s16, 16384
  s_nop 0
  buffer_load_dwordx4 v9, s[48:51], s18 offen offset:0  lds
  v_mfma_f32_32x32x16_bf16 v[60:75], v[76:79], v[112:115], v[60:75]
  buffer_load_dwordx4 v10, s[48:51], s18 offen offset:1024  lds
  ds_read_b64_tr_b16 v[108:109], v17 offset:49152
  ds_read_b64_tr_b16 v[110:111], v17 offset:50176
  ds_read_b64_tr_b16 v[112:113], v18 offset:49152
  ds_read_b64_tr_b16 v[114:115], v18 offset:50176
  s_waitcnt lgkmcnt(14)
  v_mfma_f32_32x32x16_bf16 v[44:59], v[80:83], v[116:119], v[44:59]
  buffer_load_dwordx4 v11, s[48:51], s18 offen offset:2048  lds
  v_mfma_f32_32x32x16_bf16 v[60:75], v[80:83], v[120:123], v[60:75]
  buffer_load_dwordx4 v12, s[48:51], s18 offen offset:3072  lds
  ds_read_b64_tr_b16 v[116:117], v17 offset:53248
  ds_read_b64_tr_b16 v[118:119], v17 offset:54272
  ds_read_b64_tr_b16 v[120:121], v18 offset:53248
  ds_read_b64_tr_b16 v[122:123], v18 offset:54272
  s_waitcnt lgkmcnt(13)
  v_mfma_f32_32x32x16_bf16 v[44:59], v[84:87], v[124:127], v[44:59]
  v_mfma_f32_32x32x16_bf16 v[60:75], v[84:87], v[128:131], v[60:75]
  ds_read_b64_tr_b16 v[124:125], v17 offset:57344
  ds_read_b64_tr_b16 v[126:127], v17 offset:58368
  ds_read_b64_tr_b16 v[128:129], v18 offset:57344
  ds_read_b64_tr_b16 v[130:131], v18 offset:58368
  s_waitcnt lgkmcnt(12)
  v_mfma_f32_32x32x16_bf16 v[44:59], v[88:91], v[132:135], v[44:59]
  v_mfma_f32_32x32x16_bf16 v[60:75], v[88:91], v[136:139], v[60:75]
  ds_read_b64_tr_b16 v[132:133], v17 offset:61440
  ds_read_b64_tr_b16 v[134:135], v17 offset:62464
  ds_read_b64_tr_b16 v[136:137], v18 offset:61440
  ds_read_b64_tr_b16 v[138:139], v18 offset:62464
  s_nop 6
  v_pk_mul_f32 v[30:31], v[44:45], v[44:45]
  v_pk_mul_f32 v[32:33], v[46:47], v[46:47]
  v_pk_mul_f32 v[34:35], v[48:49], v[48:49]
  v_pk_mul_f32 v[36:37], v[50:51], v[50:51]
  v_pk_fma_f32 v[30:31], v[30:31], v[24:25], v[26:27]
  v_pk_fma_f32 v[32:33], v[32:33], v[24:25], v[26:27]
  v_pk_fma_f32 v[34:35], v[34:35], v[24:25], v[26:27]
  v_pk_fma_f32 v[36:37], v[36:37], v[24:25], v[26:27]
  v_pk_mul_f32 v[30:31], v[30:31], v[44:45]
  v_pk_mul_f32 v[32:33], v[32:33], v[46:47]
  v_pk_mul_f32 v[34:35], v[34:35], v[48:49]
  v_pk_mul_f32 v[36:37], v[36:37], v[50:51]
  v_exp_f32 v30, v30
  v_exp_f32 v31, v31
  v_exp_f32 v32, v32
  v_exp_f32 v33, v33
  v_exp_f32 v34, v34
  v_exp_f32 v35, v35
  v_exp_f32 v36, v36
  v_exp_f32 v37, v37
  v_pk_add_f32 v[30:31], v[30:31], v[28:29]
  v_pk_add_f32 v[32:33], v[32:33], v[28:29]
  v_pk_add_f32 v[34:35], v[34:35], v[28:29]
  v_pk_add_f32 v[36:37], v[36:37], v[28:29]
  v_rcp_f32 v30, v30
  v_rcp_f32 v31, v31
  v_rcp_f32 v32, v32
  v_rcp_f32 v33, v33
  v_rcp_f32 v34, v34
  v_rcp_f32 v35, v35
  v_rcp_f32 v36, v36
  v_rcp_f32 v37, v37
  v_pk_mul_f32 v[44:45], v[44:45], v[30:31]
  v_pk_mul_f32 v[46:47], v[46:47], v[32:33]
  v_pk_mul_f32 v[48:49], v[48:49], v[34:35]
  v_pk_mul_f32 v[50:51], v[50:51], v[36:37]
  v_pk_mul_f32 v[30:31], v[52:53], v[52:53]
  v_pk_mul_f32 v[32:33], v[54:55], v[54:55]
  v_pk_mul_f32 v[34:35], v[56:57], v[56:57]
  v_pk_mul_f32 v[36:37], v[58:59], v[58:59]
  v_pk_fma_f32 v[30:31], v[30:31], v[24:25], v[26:27]
  v_pk_fma_f32 v[32:33], v[32:33], v[24:25], v[26:27]
  v_pk_fma_f32 v[34:35], v[34:35], v[24:25], v[26:27]
  v_pk_fma_f32 v[36:37], v[36:37], v[24:25], v[26:27]
  v_pk_mul_f32 v[30:31], v[30:31], v[52:53]
  v_pk_mul_f32 v[32:33], v[32:33], v[54:55]
  v_pk_mul_f32 v[34:35], v[34:35], v[56:57]
  v_pk_mul_f32 v[36:37], v[36:37], v[58:59]
  v_exp_f32 v30, v30
  v_exp_f32 v31, v31
  v_exp_f32 v32, v32
  v_exp_f32 v33, v33
  v_exp_f32 v34, v34
  v_exp_f32 v35, v35
  v_exp_f32 v36, v36
  v_exp_f32 v37, v37
  v_pk_add_f32 v[30:31], v[30:31], v[28:29]
  v_pk_add_f32 v[32:33], v[32:33], v[28:29]
  v_pk_add_f32 v[34:35], v[34:35], v[28:29]
  v_pk_add_f32 v[36:37], v[36:37], v[28:29]
  v_rcp_f32 v30, v30
  v_rcp_f32 v31, v31
  v_rcp_f32 v32, v32
  v_rcp_f32 v33, v33
  v_rcp_f32 v34, v34
  v_rcp_f32 v35, v35
  v_rcp_f32 v36, v36
  v_rcp_f32 v37, v37
  v_pk_mul_f32 v[52:53], v[52:53], v[30:31]
  v_pk_mul_f32 v[54:55], v[54:55], v[32:33]
  v_pk_mul_f32 v[56:57], v[56:57], v[34:35]
  v_pk_mul_f32 v[58:59], v[58:59], v[36:37]
  v_pk_mul_f32 v[30:31], v[60:61], v[60:61]
  v_pk_mul_f32 v[32:33], v[62:63], v[62:63]
  v_pk_mul_f32 v[34:35], v[64:65], v[64:65]
  v_pk_mul_f32 v[36:37], v[66:67], v[66:67]
  v_pk_fma_f32 v[30:31], v[30:31], v[24:25], v[26:27]
  v_pk_fma_f32 v[32:33], v[32:33], v[24:25], v[26:27]
  v_pk_fma_f32 v[34:35], v[34:35], v[24:25], v[26:27]
  v_pk_fma_f32 v[36:37], v[36:37], v[24:25], v[26:27]
  v_pk_mul_f32 v[30:31], v[30:31], v[60:61]
  v_pk_mul_f32 v[32:33], v[32:33], v[62:63]
  v_pk_mul_f32 v[34:35], v[34:35], v[64:65]
  v_pk_mul_f32 v[36:37], v[36:37], v[66:67]
  v_exp_f32 v30, v30
  v_exp_f32 v31, v31
  v_exp_f32 v32, v32
  v_exp_f32 v33, v33
  v_exp_f32 v34, v34
  v_exp_f32 v35, v35
  v_exp_f32 v36, v36
  v_exp_f32 v37, v37
  v_pk_add_f32 v[30:31], v[30:31], v[28:29]
  v_pk_add_f32 v[32:33], v[32:33], v[28:29]
  v_pk_add_f32 v[34:35], v[34:35], v[28:29]
  v_pk_add_f32 v[36:37], v[36:37], v[28:29]
  v_rcp_f32 v30, v30
  v_rcp_f32 v31, v31
  v_rcp_f32 v32, v32
  v_rcp_f32 v33, v33
  v_rcp_f32 v34, v34
  v_rcp_f32 v35, v35
  v_rcp_f32 v36, v36
  v_rcp_f32 v37, v37
  v_pk_mul_f32 v[60:61], v[60:61], v[30:31]
  v_pk_mul_f32 v[62:63], v[62:63], v[32:33]
  v_pk_mul_f32 v[64:65], v[64:65], v[34:35]
  v_pk_mul_f32 v[66:67], v[66:67], v[36:37]
  v_pk_mul_f32 v[30:31], v[68:69], v[68:69]
  v_pk_mul_f32 v[32:33], v[70:71], v[70:71]
  v_pk_mul_f32 v[34:35], v[72:73], v[72:73]
  v_pk_mul_f32 v[36:37], v[74:75], v[74:75]
  v_pk_fma_f32 v[30:31], v[30:31], v[24:25], v[26:27]
  v_pk_fma_f32 v[32:33], v[32:33], v[24:25], v[26:27]
  v_pk_fma_f32 v[34:35], v[34:35], v[24:25], v[26:27]
  v_pk_fma_f32 v[36:37], v[36:37], v[24:25], v[26:27]
  v_pk_mul_f32 v[30:31], v[30:31], v[68:69]
  v_pk_mul_f32 v[32:33], v[32:33], v[70:71]
  v_pk_mul_f32 v[34:35], v[34:35], v[72:73]
  v_pk_mul_f32 v[36:37], v[36:37], v[74:75]
  v_exp_f32 v30, v30
  v_exp_f32 v31, v31
  v_exp_f32 v32, v32
  v_exp_f32 v33, v33
  v_exp_f32 v34, v34
  v_exp_f32 v35, v35
  v_exp_f32 v36, v36
  v_exp_f32 v37, v37
  v_pk_add_f32 v[30:31], v[30:31], v[28:29]
  v_pk_add_f32 v[32:33], v[32:33], v[28:29]
  v_pk_add_f32 v[34:35], v[34:35], v[28:29]
  v_pk_add_f32 v[36:37], v[36:37], v[28:29]
  v_rcp_f32 v30, v30
  v_rcp_f32 v31, v31
  v_rcp_f32 v32, v32
  v_rcp_f32 v33, v33
  v_rcp_f32 v34, v34
  v_rcp_f32 v35, v35
  v_rcp_f32 v36, v36
  v_rcp_f32 v37, v37
  v_pk_mul_f32 v[68:69], v[68:69], v[30:31]
  v_pk_mul_f32 v[70:71], v[70:71], v[32:33]
  v_pk_mul_f32 v[72:73], v[72:73], v[34:35]
  v_pk_mul_f32 v[74:75], v[74:75], v[36:37]
  v_pk_add_f32 v[76:77], v[44:45], v[60:61]
  v_pk_add_f32 v[78:79], v[46:47], v[62:63]
  v_pk_add_f32 v[80:81], v[48:49], v[64:65]
  v_pk_add_f32 v[82:83], v[50:51], v[66:67]
  v_pk_add_f32 v[84:85], v[52:53], v[68:69]
  v_pk_add_f32 v[86:87], v[54:55], v[70:71]
  v_pk_add_f32 v[88:89], v[56:57], v[72:73]
  v_pk_add_f32 v[90:91], v[58:59], v[74:75]
  v_pk_mul_f32 v[92:93], v[44:45], v[44:45]
  v_pk_mul_f32 v[94:95], v[46:47], v[46:47]
  v_pk_mul_f32 v[96:97], v[48:49], v[48:49]
  v_pk_mul_f32 v[98:99], v[50:51], v[50:51]
  v_pk_mul_f32 v[100:101], v[52:53], v[52:53]
  v_pk_mul_f32 v[102:103], v[54:55], v[54:55]
  v_pk_mul_f32 v[104:105], v[56:57], v[56:57]
  v_pk_mul_f32 v[106:107], v[58:59], v[58:59]
  v_pk_fma_f32 v[92:93], v[60:61], v[60:61], v[92:93]
  v_pk_fma_f32 v[94:95], v[62:63], v[62:63], v[94:95]
  v_pk_fma_f32 v[96:97], v[64:65], v[64:65], v[96:97]
  v_pk_fma_f32 v[98:99], v[66:67], v[66:67], v[98:99]
  v_pk_fma_f32 v[100:101], v[68:69], v[68:69], v[100:101]
  v_pk_fma_f32 v[102:103], v[70:71], v[70:71], v[102:103]
  v_pk_fma_f32 v[104:105], v[72:73], v[72:73], v[104:105]
  v_pk_fma_f32 v[106:107], v[74:75], v[74:75], v[106:107]
  v_permlane16_swap_b32 v76, v92
  v_permlane16_swap_b32 v77, v93
  v_permlane16_swap_b32 v78, v94
  v_permlane16_swap_b32 v79, v95
  v_permlane16_swap_b32 v80, v96
  v_permlane16_swap_b32 v81, v97
  v_permlane16_swap_b32 v82, v98
  v_permlane16_swap_b32 v83, v99
  v_permlane16_swap_b32 v84, v100
  v_permlane16_swap_b32 v85, v101
  v_permlane16_swap_b32 v86, v102
  v_permlane16_swap_b32 v87, v103
  v_permlane16_swap_b32 v88, v104
  v_permlane16_swap_b32 v89, v105
  v_permlane16_swap_b32 v90, v106
  v_permlane16_swap_b32 v91, v107
  v_add_f32 v76, v76, v92
  v_add_f32 v77, v77, v93
  v_add_f32 v78, v78, v94
  v_add_f32 v79, v79, v95
  v_add_f32 v80, v80, v96
  v_add_f32 v81, v81, v97
  v_add_f32 v82, v82, v98
  v_add_f32 v83, v83, v99
  v_add_f32 v84, v84, v100
  v_add_f32 v85, v85, v101
  v_add_f32 v86, v86, v102
  v_add_f32 v87, v87, v103
  v_add_f32 v88, v88, v104
  v_add_f32 v89, v89, v105
  v_add_f32 v90, v90, v106
  v_add_f32 v91, v91, v107
  v_add_f32_dpp v76, v76, v76 row_mirror row_mask:0xf bank_mask:0x3
  v_add_f32_dpp v77, v77, v77 row_mirror row_mask:0xf bank_mask:0x3
  v_add_f32_dpp v78, v78, v78 row_mirror row_mask:0xf bank_mask:0x3
  v_add_f32_dpp v79, v79, v79 row_mirror row_mask:0xf bank_mask:0x3
  v_add_f32_dpp v80, v80, v80 row_mirror row_mask:0xf bank_mask:0x3
  v_add_f32_dpp v81, v81, v81 row_mirror row_mask:0xf bank_mask:0x3
  v_add_f32_dpp v82, v82, v82 row_mirror row_mask:0xf bank_mask:0x3
  v_add_f32_dpp v83, v83, v83 row_mirror row_mask:0xf bank_mask:0x3
  v_add_f32_dpp v76, v84, v84 row_mirror row_mask:0xf bank_mask:0xc
  v_add_f32_dpp v77, v85, v85 row_mirror row_mask:0xf bank_mask:0xc
  v_add_f32_dpp v78, v86, v86 row_mirror row_mask:0xf bank_mask:0xc
  v_add_f32_dpp v79, v87, v87 row_mirror row_mask:0xf bank_mask:0xc
  v_add_f32_dpp v80, v88, v88 row_mirror row_mask:0xf bank_mask:0xc
  v_add_f32_dpp v81, v89, v89 row_mirror row_mask:0xf bank_mask:0xc
  v_add_f32_dpp v82, v90, v90 row_mirror row_mask:0xf bank_mask:0xc
  v_add_f32_dpp v83, v91, v91 row_mirror row_mask:0xf bank_mask:0xc
  v_add_f32_dpp v76, v76, v76 row_half_mirror row_mask:0xf bank_mask:0x5
  v_add_f32_dpp v77, v77, v77 row_half_mirror row_mask:0xf bank_mask:0x5
  v_add_f32_dpp v78, v78, v78 row_half_mirror row_mask:0xf bank_mask:0x5
  v_add_f32_dpp v79, v79, v79 row_half_mirror row_mask:0xf bank_mask:0x5
  v_add_f32_dpp v76, v80, v80 row_half_mirror row_mask:0xf bank_mask:0xa
  v_add_f32_dpp v77, v81, v81 row_half_mirror row_mask:0xf bank_mask:0xa
  v_add_f32_dpp v78, v82, v82 row_half_mirror row_mask:0xf bank_mask:0xa
  v_add_f32_dpp v79, v83, v83 row_half_mirror row_mask:0xf bank_mask:0xa
  v_add_f32_dpp v76, v76, v76 quad_perm:[2,3,0,1] row_mask:0xf bank_mask:0xf
  v_add_f32_dpp v77, v77, v77 quad_perm:[2,3,0,1] row_mask:0xf bank_mask:0xf
  v_add_f32_dpp v78, v78, v78 quad_perm:[2,3,0,1] row_mask:0xf bank_mask:0xf
  v_add_f32_dpp v79, v79, v79 quad_perm:[2,3,0,1] row_mask:0xf bank_mask:0xf
  v_cndmask_b32_e64 v76, v76, v78, s[92:93]
  v_cndmask_b32_e64 v77, v77, v79, s[92:93]
  s_nop 0
  v_add_f32_dpp v76, v76, v76 quad_perm:[1,0,3,2] row_mask:0xf bank_mask:0xf
  v_add_f32_dpp v77, v77, v77 quad_perm:[1,0,3,2] row_mask:0xf bank_mask:0xf
  v_cndmask_b32_e64 v22, v76, v77, s[94:95]
  s_lshl_b32 s22, s12, 1
  s_add_u32 s22, s22, s10
  s_mul_i32 s22, s22, 7168
  s_add_u32 s22, s22, 16842752
  s_lshl_b32 s5, s13, 1
  s_add_u32 s5, s5, s11
  s_lshl_b32 s5, s5, 9
  s_add_u32 s5, s5, s22
  buffer_store_dwordx2 v[22:23], v38, s[40:43], s5 offen sc1
  s_waitcnt vmcnt(9)
  s_barrier
  s_add_u32 s5, s14, 4
  s_and_b32 s5, s5, 7
  s_mul_i32 s18, s5, 229376
  s_add_u32 s18, s18, s20
  s_waitcnt lgkmcnt(12)
  v_mfma_f32_32x32x16_bf16 v[76:91], v[108:111], v[140:143], 0
  s_add_u32 m0, s16, 32768
  s_nop 0
  buffer_load_dwordx4 v9, s[48:51], s18 offen offset:0  lds
  v_mfma_f32_32x32x16_bf16 v[92:107], v[112:115], v[140:143], 0
  buffer_load_dwordx4 v10, s[48:51], s18 offen offset:1024  lds
  ds_read_b64_tr_b16 v[108:109], v19 offset:0
  ds_read_b64_tr_b16 v[110:111], v19 offset:1024
  ds_read_b64_tr_b16 v[112:113], v20 offset:0
  ds_read_b64_tr_b16 v[114:115], v20 offset:1024
  s_waitcnt lgkmcnt(12)
  v_mfma_f32_32x32x16_bf16 v[76:91], v[116:119], v[144:147], v[76:91]
  buffer_load_dwordx4 v11, s[48:51], s18 offen offset:2048  lds
  v_mfma_f32_32x32x16_bf16 v[92:107], v[120:123], v[144:147], v[92:107]
  buffer_load_dwordx4 v12, s[48:51], s18 offen offset:3072  lds
  ds_read_b64_tr_b16 v[116:117], v19 offset:4096
  ds_read_b64_tr_b16 v[118:119], v19 offset:5120
  ds_read_b64_tr_b16 v[120:121], v20 offset:4096
  ds_read_b64_tr_b16 v[122:123], v20 offset:5120
  s_waitcnt lgkmcnt(12)
  v_mfma_f32_32x32x16_bf16 v[76:91], v[124:127], v[148:151], v[76:91]
  v_mfma_f32_32x32x16_bf16 v[92:107], v[128:131], v[148:151], v[92:107]
  ds_read_b64_tr_b16 v[124:125], v19 offset:8192
  ds_read_b64_tr_b16 v[126:127], v19 offset:9216
  ds_read_b64_tr_b16 v[128:129], v20 offset:8192
  ds_read_b64_tr_b16 v[130:131], v20 offset:9216
  s_waitcnt lgkmcnt(12)
  v_mfma_f32_32x32x16_bf16 v[76:91], v[132:135], v[152:155], v[76:91]
  v_mfma_f32_32x32x16_bf16 v[92:107], v[136:139], v[152:155], v[92:107]
  ds_read_b64_tr_b16 v[132:133], v19 offset:12288
  ds_read_b64_tr_b16 v[134:135], v19 offset:13312
  ds_read_b64_tr_b16 v[136:137], v20 offset:12288
  ds_read_b64_tr_b16 v[138:139], v20 offset:13312
  s_waitcnt vmcnt(9)
  s_barrier
  s_add_u32 s5, s14, 5
  s_and_b32 s5, s5, 7
  s_mul_i32 s18, s5, 229376
  s_add_u32 s18, s18, s20
  s_waitcnt lgkmcnt(12)
  v_mfma_f32_32x32x16_bf16 v[76:91], v[108:111], v[156:159], v[76:91]
  s_add_u32 m0, s16, 49152
  s_nop 0
  buffer_load_dwordx4 v9, s[48:51], s18 offen offset:0  lds
  v_mfma_f32_32x32x16_bf16 v[92:107], v[112:115], v[156:159], v[92:107]
  buffer_load_dwordx4 v10, s[48:51], s18 offen offset:1024  lds
  ds_read_b64_tr_b16 v[108:109], v17 offset:0
  ds_read_b64_tr_b16 v[110:111], v17 offset:1024
  ds_read_b64_tr_b16 v[112:113], v18 offset:0
  ds_read_b64_tr_b16 v[114:115], v18 offset:1024
  s_waitcnt lgkmcnt(12)
  v_mfma_f32_32x32x16_bf16 v[76:91], v[116:119], v[160:163], v[76:91]
  buffer_load_dwordx4 v11, s[48:51], s18 offen offset:2048  lds
  v_mfma_f32_32x32x16_bf16 v[92:107], v[120:123], v[160:163], v[92:107]
  buffer_load_dwordx4 v12, s[48:51], s18 offen offset:3072  lds
  ds_read_b64_tr_b16 v[116:117], v17 offset:4096
  ds_read_b64_tr_b16 v[118:119], v17 offset:5120
  ds_read_b64_tr_b16 v[120:121], v18 offset:4096
  ds_read_b64_tr_b16 v[122:123], v18 offset:5120
  s_waitcnt lgkmcnt(12)
  v_mfma_f32_32x32x16_bf16 v[76:91], v[124:127], v[164:167], v[76:91]
  v_mfma_f32_32x32x16_bf16 v[92:107], v[128:131], v[164:167], v[92:107]
  ds_read_b64_tr_b16 v[124:125], v17 offset:8192
  ds_read_b64_tr_b16 v[126:127], v17 offset:9216
  ds_read_b64_tr_b16 v[128:129], v18 offset:8192
  ds_read_b64_tr_b16 v[130:131], v18 offset:9216
  s_waitcnt lgkmcnt(12)
  v_mfma_f32_32x32x16_bf16 v[76:91], v[132:135], v[168:171], v[76:91]
  v_mfma_f32_32x32x16_bf16 v[92:107], v[136:139], v[168:171], v[92:107]
  ds_read_b64_tr_b16 v[132:133], v17 offset:12288
  ds_read_b64_tr_b16 v[134:135], v17 offset:13312
  ds_read_b64_tr_b16 v[136:137], v18 offset:12288
  ds_read_b64_tr_b16 v[138:139], v18 offset:13312
  s_waitcnt vmcnt(9)
  s_barrier
  s_add_u32 s5, s14, 6
  s_and_b32 s5, s5, 7
  s_mul_i32 s18, s5, 229376
  s_add_u32 s18, s18, s20
  s_waitcnt lgkmcnt(12)
  v_mfma_f32_32x32x16_bf16 v[76:91], v[108:111], v[172:175], v[76:91]
  s_add_u32 m0, s16, 65536
  s_nop 0
  buffer_load_dwordx4 v9, s[48:51], s18 offen offset:0  lds
  v_mfma_f32_32x32x16_bf16 v[92:107], v[112:115], v[172:175], v[92:107]
  buffer_load_dwordx4 v10, s[48:51], s18 offen offset:1024  lds
  ds_read_b64_tr_b16 v[108:109], v17 offset:16384
  ds_read_b64_tr_b16 v[110:111], v17 offset:17408
  ds_read_b64_tr_b16 v[112:113], v18 offset:16384
  ds_read_b64_tr_b16 v[114:115], v18 offset:17408
  s_waitcnt lgkmcnt(12)
  v_mfma_f32_32x32x16_bf16 v[76:91], v[116:119], v[176:179], v[76:91]
  buffer_load_dwordx4 v11, s[48:51], s18 offen offset:2048  lds
  v_mfma_f32_32x32x16_bf16 v[92:107], v[120:123], v[176:179], v[92:107]
  buffer_load_dwordx4 v12, s[48:51], s18 offen offset:3072  lds
  ds_read_b64_tr_b16 v[116:117], v17 offset:20480
  ds_read_b64_tr_b16 v[118:119], v17 offset:21504
  ds_read_b64_tr_b16 v[120:121], v18 offset:20480
  ds_read_b64_tr_b16 v[122:123], v18 offset:21504
  s_waitcnt lgkmcnt(12)
  v_mfma_f32_32x32x16_bf16 v[76:91], v[124:127], v[180:183], v[76:91]
  v_mfma_f32_32x32x16_bf16 v[92:107], v[128:131], v[180:183], v[92:107]
  ds_read_b64_tr_b16 v[124:125], v17 offset:24576
  ds_read_b64_tr_b16 v[126:127], v17 offset:25600
  ds_read_b64_tr_b16 v[128:129], v18 offset:24576
  ds_read_b64_tr_b16 v[130:131], v18 offset:25600
  s_waitcnt lgkmcnt(12)
  v_mfma_f32_32x32x16_bf16 v[76:91], v[132:135], v[184:187], v[76:91]
  v_mfma_f32_32x32x16_bf16 v[92:107], v[136:139], v[184:187], v[92:107]
  ds_read_b64_tr_b16 v[132:133], v17 offset:28672
  ds_read_b64_tr_b16 v[134:135], v17 offset:29696
  ds_read_b64_tr_b16 v[136:137], v18 offset:28672
  ds_read_b64_tr_b16 v[138:139], v18 offset:29696
  s_waitcnt vmcnt(8)
  s_barrier
  s_add_u32 s5, s14, 7
  s_and_b32 s5, s5, 7
  s_mul_i32 s18, s5, 229376
  s_add_u32 s18, s18, s20
  s_waitcnt lgkmcnt(12)
  v_mfma_f32_32x32x16_bf16 v[76:91], v[108:111], v[188:191], v[76:91]
  s_add_u32 m0, s16, 0
  s_nop 0
  buffer_load_dwordx4 v9, s[48:51], s18 offen offset:0  lds
  v_mfma_f32_32x32x16_bf16 v[92:107], v[112:115], v[188:191], v[92:107]
  buffer_load_dwordx4 v10, s[48:51], s18 offen offset:1024  lds
  ds_read_b64_tr_b16 v[108:109], v17 offset:32768
  ds_read_b64_tr_b16 v[110:111], v17 offset:33792
  ds_read_b64_tr_b16 v[112:113], v18 offset:32768
  ds_read_b64_tr_b16 v[114:115], v18 offset:33792
  s_waitcnt lgkmcnt(12)
  v_mfma_f32_32x32x16_bf16 v[76:91], v[116:119], v[192:195], v[76:91]
  buffer_load_dwordx4 v11, s[48:51], s18 offen offset:2048  lds
  v_mfma_f32_32x32x16_bf16 v[92:107], v[120:123], v[192:195], v[92:107]
  buffer_load_dwordx4 v12, s[48:51], s18 offen offset:3072  lds
  ds_read_b64_tr_b16 v[116:117], v17 offset:36864
  ds_read_b64_tr_b16 v[118:119], v17 offset:37888
  ds_read_b64_tr_b16 v[120:121], v18 offset:36864
  ds_read_b64_tr_b16 v[122:123], v18 offset:37888
  s_waitcnt lgkmcnt(12)
  v_mfma_f32_32x32x16_bf16 v[76:91], v[124:127], v[196:199], v[76:91]
  v_mfma_f32_32x32x16_bf16 v[92:107], v[128:131], v[196:199], v[92:107]
  ds_read_b64_tr_b16 v[124:125], v17 offset:40960
  ds_read_b64_tr_b16 v[126:127], v17 offset:41984
  ds_read_b64_tr_b16 v[128:129], v18 offset:40960
  ds_read_b64_tr_b16 v[130:131], v18 offset:41984
  s_waitcnt lgkmcnt(12)
  v_mfma_f32_32x32x16_bf16 v[76:91], v[132:135], v[200:203], v[76:91]
  v_mfma_f32_32x32x16_bf16 v[92:107], v[136:139], v[200:203], v[92:107]
  ds_read_b64_tr_b16 v[132:133], v17 offset:45056
  ds_read_b64_tr_b16 v[134:135], v17 offset:46080
  ds_read_b64_tr_b16 v[136:137], v18 offset:45056
  ds_read_b64_tr_b16 v[138:139], v18 offset:46080
  s_waitcnt vmcnt(8)
  s_barrier
  s_waitcnt lgkmcnt(12)
  v_mfma_f32_32x32x16_bf16 v[76:91], v[108:111], v[204:207], v[76:91]
  v_mfma_f32_32x32x16_bf16 v[92:107], v[112:115], v[204:207], v[92:107]
  ds_read_b64_tr_b16 v[108:109], v17 offset:49152
  ds_read_b64_tr_b16 v[110:111], v17 offset:50176
  ds_read_b64_tr_b16 v[112:113], v18 offset:49152
  ds_read_b64_tr_b16 v[114:115], v18 offset:50176
  s_waitcnt lgkmcnt(12)
  v_mfma_f32_32x32x16_bf16 v[76:91], v[116:119], v[208:211], v[76:91]
  v_mfma_f32_32x32x16_bf16 v[92:107], v[120:123], v[208:211], v[92:107]
  ds_read_b64_tr_b16 v[116:117], v17 offset:53248
  ds_read_b64_tr_b16 v[118:119], v17 offset:54272
  ds_read_b64_tr_b16 v[120:121], v18 offset:53248
  ds_read_b64_tr_b16 v[122:123], v18 offset:54272
  s_waitcnt lgkmcnt(12)
  v_mfma_f32_32x32x16_bf16 v[76:91], v[124:127], v[212:215], v[76:91]
  v_mfma_f32_32x32x16_bf16 v[92:107], v[128:131], v[212:215], v[92:107]
  ds_read_b64_tr_b16 v[124:125], v17 offset:57344
  ds_read_b64_tr_b16 v[126:127], v17 offset:58368
  ds_read_b64_tr_b16 v[128:129], v18 offset:57344
  ds_read_b64_tr_b16 v[130:131], v18 offset:58368
  s_waitcnt lgkmcnt(12)
  v_mfma_f32_32x32x16_bf16 v[76:91], v[132:135], v[216:219], v[76:91]
  v_mfma_f32_32x32x16_bf16 v[92:107], v[136:139], v[216:219], v[92:107]
  ds_read_b64_tr_b16 v[132:133], v17 offset:61440
  ds_read_b64_tr_b16 v[134:135], v17 offset:62464
  ds_read_b64_tr_b16 v[136:137], v18 offset:61440
  ds_read_b64_tr_b16 v[138:139], v18 offset:62464
  s_waitcnt vmcnt(4)
  s_barrier
  s_waitcnt lgkmcnt(12)
  v_mfma_f32_32x32x16_bf16 v[76:91], v[108:111], v[220:223], v[76:91]
  v_mfma_f32_32x32x16_bf16 v[92:107], v[112:115], v[220:223], v[92:107]
  ds_read_b64_tr_b16 v[108:109], v19 offset:0
  ds_read_b64_tr_b16 v[110:111], v19 offset:1024
  ds_read_b64_tr_b16 v[112:113], v20 offset:0
  ds_read_b64_tr_b16 v[114:115], v20 offset:1024
  s_waitcnt lgkmcnt(12)
  v_mfma_f32_32x32x16_bf16 v[76:91], v[116:119], v[224:227], v[76:91]
  v_mfma_f32_32x32x16_bf16 v[92:107], v[120:123], v[224:227], v[92:107]
  ds_read_b64_tr_b16 v[116:117], v19 offset:4096
  ds_read_b64_tr_b16 v[118:119], v19 offset:5120
  ds_read_b64_tr_b16 v[120:121], v20 offset:4096
  ds_read_b64_tr_b16 v[122:123], v20 offset:5120
  s_waitcnt lgkmcnt(12)
  v_mfma_f32_32x32x16_bf16 v[76:91], v[124:127], v[228:231], v[76:91]
  v_mfma_f32_32x32x16_bf16 v[92:107], v[128:131], v[228:231], v[92:107]
  ds_read_b64_tr_b16 v[124:125], v19 offset:8192
  ds_read_b64_tr_b16 v[126:127], v19 offset:9216
  ds_read_b64_tr_b16 v[128:129], v20 offset:8192
  ds_read_b64_tr_b16 v[130:131], v20 offset:9216
  s_waitcnt lgkmcnt(12)
  v_mfma_f32_32x32x16_bf16 v[76:91], v[132:135], v[232:235], v[76:91]
  v_mfma_f32_32x32x16_bf16 v[92:107], v[136:139], v[232:235], v[92:107]
  ds_read_b64_tr_b16 v[132:133], v19 offset:12288
  ds_read_b64_tr_b16 v[134:135], v19 offset:13312
  ds_read_b64_tr_b16 v[136:137], v20 offset:12288
  ds_read_b64_tr_b16 v[138:139], v20 offset:13312
  s_waitcnt vmcnt(0)
  s_barrier
  s_waitcnt lgkmcnt(12)
  v_mfma_f32_32x32x16_bf16 v[76:91], v[108:111], v[236:239], v[76:91]
  s_add_u32 s5, s22, 4096
  buffer_load_dwordx2 v[156:157], v38, s[40:43], s22 offen offset:0 sc1
  buffer_load_dwordx2 v[158:159], v38, s[40:43], s22 offen offset:512 sc1
  buffer_load_dwordx2 v[160:161], v38, s[40:43], s22 offen offset:1024 sc1
  buffer_load_dwordx2 v[162:163], v38, s[40:43], s22 offen offset:1536 sc1
  buffer_load_dwordx2 v[164:165], v38, s[40:43], s22 offen offset:2048 sc1
  buffer_load_dwordx2 v[166:167], v38, s[40:43], s22 offen offset:2560 sc1
  buffer_load_dwordx2 v[168:169], v38, s[40:43], s22 offen offset:3072 sc1
  buffer_load_dwordx2 v[170:171], v38, s[40:43], s22 offen offset:3584 sc1
  buffer_load_dwordx2 v[172:173], v38, s[40:43], s5 offen offset:0 sc1
  buffer_load_dwordx2 v[174:175], v38, s[40:43], s5 offen offset:512 sc1
  buffer_load_dwordx2 v[176:177], v38, s[40:43], s5 offen offset:1024 sc1
  buffer_load_dwordx2 v[178:179], v38, s[40:43], s5 offen offset:1536 sc1
  buffer_load_dwordx2 v[180:181], v38, s[40:43], s5 offen offset:2048 sc1
  buffer_load_dwordx2 v[182:183], v38, s[40:43], s5 offen offset:2560 sc1
  v_mfma_f32_32x32x16_bf16 v[92:107], v[112:115], v[236:239], v[92:107]
  ds_read_b128 v[140:143], v13 offset:57344
  ds_read_b64_tr_b16 v[108:109], v17 offset:0
  ds_read_b64_tr_b16 v[110:111], v17 offset:1024
  ds_read_b64_tr_b16 v[112:113], v18 offset:0
  ds_read_b64_tr_b16 v[114:115], v18 offset:1024
  s_waitcnt lgkmcnt(13)
  v_mfma_f32_32x32x16_bf16 v[76:91], v[116:119], v[240:243], v[76:91]
  v_mfma_f32_32x32x16_bf16 v[92:107], v[120:123], v[240:243], v[92:107]
  ds_read_b128 v[144:147], v14 offset:57344
  ds_read_b64_tr_b16 v[116:117], v17 offset:4096
  ds_read_b64_tr_b16 v[118:119], v17 offset:5120
  ds_read_b64_tr_b16 v[120:121], v18 offset:4096
  ds_read_b64_tr_b16 v[122:123], v18 offset:5120
  s_waitcnt lgkmcnt(14)
  v_mfma_f32_32x32x16_bf16 v[76:91], v[124:127], v[244:247], v[76:91]
  v_mfma_f32_32x32x16_bf16 v[92:107], v[128:131], v[244:247], v[92:107]
  ds_read_b128 v[148:151], v15 offset:57344
  ds_read_b64_tr_b16 v[124:125], v17 offset:8192
  ds_read_b64_tr_b16 v[126:127], v17 offset:9216
  ds_read_b64_tr_b16 v[128:129], v18 offset:8192
  ds_read_b64_tr_b16 v[130:131], v18 offset:9216
  s_waitcnt lgkmcnt(15)
  v_mfma_f32_32x32x16_bf16 v[76:91], v[132:135], v[248:251], v[76:91]
  v_mfma_f32_32x32x16_bf16 v[92:107], v[136:139], v[248:251], v[92:107]
  ds_read_b128 v[152:155], v16 offset:57344
  ds_read_b64_tr_b16 v[132:133], v17 offset:12288
  ds_read_b64_tr_b16 v[134:135], v17 offset:13312
  ds_read_b64_tr_b16 v[136:137], v18 offset:12288
  ds_read_b64_tr_b16 v[138:139], v18 offset:13312
  s_waitcnt lgkmcnt(15)
  v_mfma_f32_32x32x16_bf16 v[76:91], v[108:111], v[140:143], v[76:91]
  v_mfma_f32_32x32x16_bf16 v[92:107], v[112:115], v[140:143], v[92:107]
  s_waitcnt lgkmcnt(10)
  v_mfma_f32_32x32x16_bf16 v[76:91], v[116:119], v[144:147], v[76:91]
  v_mfma_f32_32x32x16_bf16 v[92:107], v[120:123], v[144:147], v[92:107]
  s_waitcnt lgkmcnt(5)
  v_mfma_f32_32x32x16_bf16 v[76:91], v[124:127], v[148:151], v[76:91]
  v_mfma_f32_32x32x16_bf16 v[92:107], v[128:131], v[148:151], v[92:107]
  s_waitcnt lgkmcnt(0)
  s_barrier
  v_mfma_f32_32x32x16_bf16 v[76:91], v[132:135], v[152:155], v[76:91]
  v_mfma_f32_32x32x16_bf16 v[92:107], v[136:139], v[152:155], v[92:107]
  s_waitcnt vmcnt(0)
p1_check:
  v_min3_u32 v30, v157, v159, v2
  v_max3_u32 v31, v157, v159, v2
  v_min3_u32 v30, v161, v163, v30
  v_max3_u32 v31, v161, v163, v31
  v_min3_u32 v30, v165, v167, v30
  v_max3_u32 v31, v165, v167, v31
  v_min3_u32 v30, v169, v171, v30
  v_max3_u32 v31, v169, v171, v31
  v_min3_u32 v30, v173, v175, v30
  v_max3_u32 v31, v173, v175, v31
  v_min3_u32 v30, v177, v179, v30
  v_max3_u32 v31, v177, v179, v31
  v_min3_u32 v30, v181, v183, v30
  v_max3_u32 v31, v181, v183, v31
  v_cmp_ne_u32 vcc, v30, v31
  s_cmp_eq_u64 vcc, 0
  s_cbranch_scc0 p1_retry
p1_ready:
  v_add_f32 v156, v156, v158
  v_add_f32 v160, v160, v162
  v_add_f32 v164, v164, v166
  v_add_f32 v168, v168, v170
  v_add_f32 v172, v172, v174
  v_add_f32 v176, v176, v178
  v_add_f32 v180, v180, v182
  v_add_f32 v156, v156, v160
  v_add_f32 v164, v164, v168
  v_add_f32 v172, v172, v176
  v_add_f32 v156, v156, v164
  v_add_f32 v172, v172, v180
  v_add_f32 v156, v156, v172
  v_mov_b32 v32, v156
  s_nop 1
  v_permlane16_swap_b32 v156, v32
  v_mul_f32 v33, 0x3a924925, v156
  v_mul_f32 v32, 0x3a924925, v32
  v_fma_f32 v32, -v33, v33, v32
  v_max_f32 v32, 0, v32
  v_cvt_pk_bf16_f32 v33, v33, v33
  v_lshlrev_b32 v33, 16, v33
  v_cvt_pk_bf16_f32 v32, v32, v32
  v_lshlrev_b32 v32, 16, v32
  v_add_f32 v32, 0x3727c5ac, v32
  v_cvt_pk_bf16_f32 v32, v32, v32
  v_lshlrev_b32 v32, 16, v32
  v_sqrt_f32 v32, v32
  s_nop 0
  v_cvt_pk_bf16_f32 v32, v32, v32
  v_lshlrev_b32 v32, 16, v32
  v_rcp_f32 v34, v32
  s_nop 0
  v_sub_f32 v34, 0, v34
  s_lshl_b32 s5, s12, 1
  s_add_u32 s5, s5, s10
  s_mul_i32 s5, s5, 56
  s_lshl_b32 s6, s13, 3
  s_add_u32 s5, s5, s6
  s_lshl_b32 s6, s11, 2
  s_add_u32 s5, s5, s6
  s_lshl_b32 s5, s5, 10
  s_add_u32 s5, s5, 0
  v_sub_f32_dpp v44, v33, v44 row_newbcast:0 row_mask:0xf bank_mask:0xf
  v_sub_f32_dpp v45, v33, v45 row_newbcast:1 row_mask:0xf bank_mask:0xf
  v_sub_f32_dpp v46, v33, v46 row_newbcast:2 row_mask:0xf bank_mask:0xf
  v_sub_f32_dpp v47, v33, v47 row_newbcast:3 row_mask:0xf bank_mask:0xf
  v_sub_f32_dpp v48, v33, v48 row_newbcast:4 row_mask:0xf bank_mask:0xf
  v_sub_f32_dpp v49, v33, v49 row_newbcast:5 row_mask:0xf bank_mask:0xf
  v_sub_f32_dpp v50, v33, v50 row_newbcast:6 row_mask:0xf bank_mask:0xf
  v_sub_f32_dpp v51, v33, v51 row_newbcast:7 row_mask:0xf bank_mask:0xf
  v_sub_f32_dpp v52, v33, v52 row_newbcast:8 row_mask:0xf bank_mask:0xf
  v_sub_f32_dpp v53, v33, v53 row_newbcast:9 row_mask:0xf bank_mask:0xf
  v_sub_f32_dpp v54, v33, v54 row_newbcast:10 row_mask:0xf bank_mask:0xf
  v_sub_f32_dpp v55, v33, v55 row_newbcast:11 row_mask:0xf bank_mask:0xf
  v_sub_f32_dpp v56, v33, v56 row_newbcast:12 row_mask:0xf bank_mask:0xf
  v_sub_f32_dpp v57, v33, v57 row_newbcast:13 row_mask:0xf bank_mask:0xf
  v_sub_f32_dpp v58, v33, v58 row_newbcast:14 row_mask:0xf bank_mask:0xf
  v_sub_f32_dpp v59, v33, v59 row_newbcast:15 row_mask:0xf bank_mask:0xf
  v_mul_f32_dpp v44, v34, v44 row_newbcast:0 row_mask:0xf bank_mask:0xf
  v_mul_f32_dpp v45, v34, v45 row_newbcast:1 row_mask:0xf bank_mask:0xf
  v_mul_f32_dpp v46, v34, v46 row_newbcast:2 row_mask:0xf bank_mask:0xf
  v_mul_f32_dpp v47, v34, v47 row_newbcast:3 row_mask:0xf bank_mask:0xf
  v_mul_f32_dpp v48, v34, v48 row_newbcast:4 row_mask:0xf bank_mask:0xf
  v_mul_f32_dpp v49, v34, v49 row_newbcast:5 row_mask:0xf bank_mask:0xf
  v_mul_f32_dpp v50, v34, v50 row_newbcast:6 row_mask:0xf bank_mask:0xf
  v_mul_f32_dpp v51, v34, v51 row_newbcast:7 row_mask:0xf bank_mask:0xf
  v_mul_f32_dpp v52, v34, v52 row_newbcast:8 row_mask:0xf bank_mask:0xf
  v_mul_f32_dpp v53, v34, v53 row_newbcast:9 row_mask:0xf bank_mask:0xf
  v_mul_f32_dpp v54, v34, v54 row_newbcast:10 row_mask:0xf bank_mask:0xf
  v_mul_f32_dpp v55, v34, v55 row_newbcast:11 row_mask:0xf bank_mask:0xf
  v_mul_f32_dpp v56, v34, v56 row_newbcast:12 row_mask:0xf bank_mask:0xf
  v_mul_f32_dpp v57, v34, v57 row_newbcast:13 row_mask:0xf bank_mask:0xf
  v_mul_f32_dpp v58, v34, v58 row_newbcast:14 row_mask:0xf bank_mask:0xf
  v_mul_f32_dpp v59, v34, v59 row_newbcast:15 row_mask:0xf bank_mask:0xf
  v_cvt_pk_bf16_f32 v44, v44, v45
  v_cvt_pk_bf16_f32 v45, v46, v47
  v_cvt_pk_bf16_f32 v46, v48, v49
  v_cvt_pk_bf16_f32 v47, v50, v51
  v_cvt_pk_bf16_f32 v48, v52, v53
  v_cvt_pk_bf16_f32 v49, v54, v55
  v_cvt_pk_bf16_f32 v50, v56, v57
  v_cvt_pk_bf16_f32 v51, v58, v59
  v_permlane32_swap_b32 v44, v46
  v_permlane32_swap_b32 v45, v47
  v_permlane32_swap_b32 v48, v50
  v_permlane32_swap_b32 v49, v51
  buffer_store_dwordx4 v[44:47], v40, s[40:43], s5 offen offset:0 sc1
  buffer_store_dwordx4 v[48:51], v40, s[40:43], s5 offen offset:512 sc1
  v_sub_f32_dpp v60, v33, v60 row_newbcast:0 row_mask:0xf bank_mask:0xf
  v_sub_f32_dpp v61, v33, v61 row_newbcast:1 row_mask:0xf bank_mask:0xf
  v_sub_f32_dpp v62, v33, v62 row_newbcast:2 row_mask:0xf bank_mask:0xf
  v_sub_f32_dpp v63, v33, v63 row_newbcast:3 row_mask:0xf bank_mask:0xf
  v_sub_f32_dpp v64, v33, v64 row_newbcast:4 row_mask:0xf bank_mask:0xf
  v_sub_f32_dpp v65, v33, v65 row_newbcast:5 row_mask:0xf bank_mask:0xf
  v_sub_f32_dpp v66, v33, v66 row_newbcast:6 row_mask:0xf bank_mask:0xf
  v_sub_f32_dpp v67, v33, v67 row_newbcast:7 row_mask:0xf bank_mask:0xf
  v_sub_f32_dpp v68, v33, v68 row_newbcast:8 row_mask:0xf bank_mask:0xf
  v_sub_f32_dpp v69, v33, v69 row_newbcast:9 row_mask:0xf bank_mask:0xf
  v_sub_f32_dpp v70, v33, v70 row_newbcast:10 row_mask:0xf bank_mask:0xf
  v_sub_f32_dpp v71, v33, v71 row_newbcast:11 row_mask:0xf bank_mask:0xf
  v_sub_f32_dpp v72, v33, v72 row_newbcast:12 row_mask:0xf bank_mask:0xf
  v_sub_f32_dpp v73, v33, v73 row_newbcast:13 row_mask:0xf bank_mask:0xf
  v_sub_f32_dpp v74, v33, v74 row_newbcast:14 row_mask:0xf bank_mask:0xf
  v_sub_f32_dpp v75, v33, v75 row_newbcast:15 row_mask:0xf bank_mask:0xf
  v_mul_f32_dpp v60, v34, v60 row_newbcast:0 row_mask:0xf bank_mask:0xf
  v_mul_f32_dpp v61, v34, v61 row_newbcast:1 row_mask:0xf bank_mask:0xf
  v_mul_f32_dpp v62, v34, v62 row_newbcast:2 row_mask:0xf bank_mask:0xf
  v_mul_f32_dpp v63, v34, v63 row_newbcast:3 row_mask:0xf bank_mask:0xf
  v_mul_f32_dpp v64, v34, v64 row_newbcast:4 row_mask:0xf bank_mask:0xf
  v_mul_f32_dpp v65, v34, v65 row_newbcast:5 row_mask:0xf bank_mask:0xf
  v_mul_f32_dpp v66, v34, v66 row_newbcast:6 row_mask:0xf bank_mask:0xf
  v_mul_f32_dpp v67, v34, v67 row_newbcast:7 row_mask:0xf bank_mask:0xf
  v_mul_f32_dpp v68, v34, v68 row_newbcast:8 row_mask:0xf bank_mask:0xf
  v_mul_f32_dpp v69, v34, v69 row_newbcast:9 row_mask:0xf bank_mask:0xf
  v_mul_f32_dpp v70, v34, v70 row_newbcast:10 row_mask:0xf bank_mask:0xf
  v_mul_f32_dpp v71, v34, v71 row_newbcast:11 row_mask:0xf bank_mask:0xf
  v_mul_f32_dpp v72, v34, v72 row_newbcast:12 row_mask:0xf bank_mask:0xf
  v_mul_f32_dpp v73, v34, v73 row_newbcast:13 row_mask:0xf bank_mask:0xf
  v_mul_f32_dpp v74, v34, v74 row_newbcast:14 row_mask:0xf bank_mask:0xf
  v_mul_f32_dpp v75, v34, v75 row_newbcast:15 row_mask:0xf bank_mask:0xf
  v_cvt_pk_bf16_f32 v60, v60, v61
  v_cvt_pk_bf16_f32 v61, v62, v63
  v_cvt_pk_bf16_f32 v62, v64, v65
  v_cvt_pk_bf16_f32 v63, v66, v67
  v_cvt_pk_bf16_f32 v64, v68, v69
  v_cvt_pk_bf16_f32 v65, v70, v71
  v_cvt_pk_bf16_f32 v66, v72, v73
  v_cvt_pk_bf16_f32 v67, v74, v75
  v_permlane32_swap_b32 v60, v62
  v_permlane32_swap_b32 v61, v63
  v_permlane32_swap_b32 v64, v66
  v_permlane32_swap_b32 v65, v67
  buffer_store_dwordx4 v[60:63], v40, s[40:43], s5 offen offset:2048 sc1
  buffer_store_dwordx4 v[64:67], v40, s[40:43], s5 offen offset:2560 sc1
  v_pk_mul_f32 v[30:31], v[76:77], v[76:77]
  v_pk_mul_f32 v[32:33], v[78:79], v[78:79]
  v_pk_mul_f32 v[34:35], v[80:81], v[80:81]
  v_pk_mul_f32 v[36:37], v[82:83], v[82:83]
  v_pk_fma_f32 v[30:31], v[30:31], v[24:25], v[26:27]
  v_pk_fma_f32 v[32:33], v[32:33], v[24:25], v[26:27]
  v_pk_fma_f32 v[34:35], v[34:35], v[24:25], v[26:27]
  v_pk_fma_f32 v[36:37], v[36:37], v[24:25], v[26:27]
  v_pk_mul_f32 v[30:31], v[30:31], v[76:77]
  v_pk_mul_f32 v[32:33], v[32:33], v[78:79]
  v_pk_mul_f32 v[34:35], v[34:35], v[80:81]
  v_pk_mul_f32 v[36:37], v[36:37], v[82:83]
  v_exp_f32 v30, v30
  v_exp_f32 v31, v31
  v_exp_f32 v32, v32
  v_exp_f32 v33, v33
  v_exp_f32 v34, v34
  v_exp_f32 v35, v35
  v_exp_f32 v36, v36
  v_exp_f32 v37, v37
  v_pk_add_f32 v[30:31], v[30:31], v[28:29]
  v_pk_add_f32 v[32:33], v[32:33], v[28:29]
  v_pk_add_f32 v[34:35], v[34:35], v[28:29]
  v_pk_add_f32 v[36:37], v[36:37], v[28:29]
  v_rcp_f32 v30, v30
  v_rcp_f32 v31, v31
  v_rcp_f32 v32, v32
  v_rcp_f32 v33, v33
  v_rcp_f32 v34, v34
  v_rcp_f32 v35, v35
  v_rcp_f32 v36, v36
  v_rcp_f32 v37, v37
  v_pk_mul_f32 v[76:77], v[76:77], v[30:31]
  v_pk_mul_f32 v[78:79], v[78:79], v[32:33]
  v_pk_mul_f32 v[80:81], v[80:81], v[34:35]
  v_pk_mul_f32 v[82:83], v[82:83], v[36:37]
  v_pk_mul_f32 v[30:31], v[84:85], v[84:85]
  v_pk_mul_f32 v[32:33], v[86:87], v[86:87]
  v_pk_mul_f32 v[34:35], v[88:89], v[88:89]
  v_pk_mul_f32 v[36:37], v[90:91], v[90:91]
  v_pk_fma_f32 v[30:31], v[30:31], v[24:25], v[26:27]
  v_pk_fma_f32 v[32:33], v[32:33], v[24:25], v[26:27]
  v_pk_fma_f32 v[34:35], v[34:35], v[24:25], v[26:27]
  v_pk_fma_f32 v[36:37], v[36:37], v[24:25], v[26:27]
  v_pk_mul_f32 v[30:31], v[30:31], v[84:85]
  v_pk_mul_f32 v[32:33], v[32:33], v[86:87]
  v_pk_mul_f32 v[34:35], v[34:35], v[88:89]
  v_pk_mul_f32 v[36:37], v[36:37], v[90:91]
  v_exp_f32 v30, v30
  v_exp_f32 v31, v31
  v_exp_f32 v32, v32
  v_exp_f32 v33, v33
  v_exp_f32 v34, v34
  v_exp_f32 v35, v35
  v_exp_f32 v36, v36
  v_exp_f32 v37, v37
  v_pk_add_f32 v[30:31], v[30:31], v[28:29]
  v_pk_add_f32 v[32:33], v[32:33], v[28:29]
  v_pk_add_f32 v[34:35], v[34:35], v[28:29]
  v_pk_add_f32 v[36:37], v[36:37], v[28:29]
  v_rcp_f32 v30, v30
  v_rcp_f32 v31, v31
  v_rcp_f32 v32, v32
  v_rcp_f32 v33, v33
  v_rcp_f32 v34, v34
  v_rcp_f32 v35, v35
  v_rcp_f32 v36, v36
  v_rcp_f32 v37, v37
  v_pk_mul_f32 v[84:85], v[84:85], v[30:31]
  v_pk_mul_f32 v[86:87], v[86:87], v[32:33]
  v_pk_mul_f32 v[88:89], v[88:89], v[34:35]
  v_pk_mul_f32 v[90:91], v[90:91], v[36:37]
  v_pk_mul_f32 v[30:31], v[92:93], v[92:93]
  v_pk_mul_f32 v[32:33], v[94:95], v[94:95]
  v_pk_mul_f32 v[34:35], v[96:97], v[96:97]
  v_pk_mul_f32 v[36:37], v[98:99], v[98:99]
  v_pk_fma_f32 v[30:31], v[30:31], v[24:25], v[26:27]
  v_pk_fma_f32 v[32:33], v[32:33], v[24:25], v[26:27]
  v_pk_fma_f32 v[34:35], v[34:35], v[24:25], v[26:27]
  v_pk_fma_f32 v[36:37], v[36:37], v[24:25], v[26:27]
  v_pk_mul_f32 v[30:31], v[30:31], v[92:93]
  v_pk_mul_f32 v[32:33], v[32:33], v[94:95]
  v_pk_mul_f32 v[34:35], v[34:35], v[96:97]
  v_pk_mul_f32 v[36:37], v[36:37], v[98:99]
  v_exp_f32 v30, v30
  v_exp_f32 v31, v31
  v_exp_f32 v32, v32
  v_exp_f32 v33, v33
  v_exp_f32 v34, v34
  v_exp_f32 v35, v35
  v_exp_f32 v36, v36
  v_exp_f32 v37, v37
  v_pk_add_f32 v[30:31], v[30:31], v[28:29]
  v_pk_add_f32 v[32:33], v[32:33], v[28:29]
  v_pk_add_f32 v[34:35], v[34:35], v[28:29]
  v_pk_add_f32 v[36:37], v[36:37], v[28:29]
  v_rcp_f32 v30, v30
  v_rcp_f32 v31, v31
  v_rcp_f32 v32, v32
  v_rcp_f32 v33, v33
  v_rcp_f32 v34, v34
  v_rcp_f32 v35, v35
  v_rcp_f32 v36, v36
  v_rcp_f32 v37, v37
  v_pk_mul_f32 v[92:93], v[92:93], v[30:31]
  v_pk_mul_f32 v[94:95], v[94:95], v[32:33]
  v_pk_mul_f32 v[96:97], v[96:97], v[34:35]
  v_pk_mul_f32 v[98:99], v[98:99], v[36:37]
  v_pk_mul_f32 v[30:31], v[100:101], v[100:101]
  v_pk_mul_f32 v[32:33], v[102:103], v[102:103]
  v_pk_mul_f32 v[34:35], v[104:105], v[104:105]
  v_pk_mul_f32 v[36:37], v[106:107], v[106:107]
  v_pk_fma_f32 v[30:31], v[30:31], v[24:25], v[26:27]
  v_pk_fma_f32 v[32:33], v[32:33], v[24:25], v[26:27]
  v_pk_fma_f32 v[34:35], v[34:35], v[24:25], v[26:27]
  v_pk_fma_f32 v[36:37], v[36:37], v[24:25], v[26:27]
  v_pk_mul_f32 v[30:31], v[30:31], v[100:101]
  v_pk_mul_f32 v[32:33], v[32:33], v[102:103]
  v_pk_mul_f32 v[34:35], v[34:35], v[104:105]
  v_pk_mul_f32 v[36:37], v[36:37], v[106:107]
  v_exp_f32 v30, v30
  v_exp_f32 v31, v31
  v_exp_f32 v32, v32
  v_exp_f32 v33, v33
  v_exp_f32 v34, v34
  v_exp_f32 v35, v35
  v_exp_f32 v36, v36
  v_exp_f32 v37, v37
  v_pk_add_f32 v[30:31], v[30:31], v[28:29]
  v_pk_add_f32 v[32:33], v[32:33], v[28:29]
  v_pk_add_f32 v[34:35], v[34:35], v[28:29]
  v_pk_add_f32 v[36:37], v[36:37], v[28:29]
  v_rcp_f32 v30, v30
  v_rcp_f32 v31, v31
  v_rcp_f32 v32, v32
  v_rcp_f32 v33, v33
  v_rcp_f32 v34, v34
  v_rcp_f32 v35, v35
  v_rcp_f32 v36, v36
  v_rcp_f32 v37, v37
  v_pk_mul_f32 v[100:101], v[100:101], v[30:31]
  v_pk_mul_f32 v[102:103], v[102:103], v[32:33]
  v_pk_mul_f32 v[104:105], v[104:105], v[34:35]
  v_pk_mul_f32 v[106:107], v[106:107], v[36:37]
  v_cvt_pk_bf16_f32 v76, v76, v77
  v_cvt_pk_bf16_f32 v92, v92, v93
  v_cvt_pk_bf16_f32 v77, v78, v79
  v_cvt_pk_bf16_f32 v93, v94, v95
  v_cvt_pk_bf16_f32 v78, v84, v85
  v_cvt_pk_bf16_f32 v94, v100, v101
  v_cvt_pk_bf16_f32 v79, v86, v87
  v_cvt_pk_bf16_f32 v95, v102, v103
  v_cvt_pk_bf16_f32 v80, v80, v81
  v_cvt_pk_bf16_f32 v96, v96, v97
  v_cvt_pk_bf16_f32 v81, v82, v83
  v_cvt_pk_bf16_f32 v97, v98, v99
  v_cvt_pk_bf16_f32 v82, v88, v89
  v_cvt_pk_bf16_f32 v98, v104, v105
  v_cvt_pk_bf16_f32 v83, v90, v91
  v_cvt_pk_bf16_f32 v99, v106, v107
  s_lshl_b32 s5, s12, 2
  s_lshl_b32 s6, s10, 1
  s_add_u32 s5, s5, s6
  s_mul_i32 s5, s5, 28
  s_lshl_b32 s6, s13, 2
  s_add_u32 s5, s5, s6
  s_lshl_b32 s6, s11, 1
  s_add_u32 s5, s5, s6
  s_lshl_b32 s5, s5, 10
  s_add_u32 s5, s5, 4194304
  buffer_store_dwordx4 v[76:79], v39, s[40:43], s5 offen offset:0 sc1
  buffer_store_dwordx4 v[80:83], v39, s[40:43], s5 offen offset:512 sc1
  buffer_store_dwordx4 v[92:95], v39, s[40:43], s5 offen offset:1024 sc1
  buffer_store_dwordx4 v[96:99], v39, s[40:43], s5 offen offset:1536 sc1
  s_mov_b32 s22, s2
  s_waitcnt vmcnt(4)
  v_mov_b32 v3, 1
  v_mov_b32 v4, 162592
  s_mov_b64 exec, 1
  ds_add_rtn_u32 v5, v4, v3
  s_lshl_b32 s5, s22, 7
  s_add_u32 s5, s5, 17375232
  s_waitcnt lgkmcnt(0)
  v_readfirstlane_b32 s6, v5
  s_mov_b64 exec, -1
  s_cmp_eq_u32 s6, 3
  s_cselect_b32 s5, s5, 1073741824
  buffer_store_dword v2, off, s[40:43], s5 sc1
p2_setup:
  s_mov_b32 s44, s26
  s_mov_b32 s45, s27
  s_mov_b32 s46, 8388608
  s_mov_b32 s47, 0x20000
  s_mov_b32 s48, s28
  s_mov_b32 s49, s29
  s_mov_b32 s50, 4096
  s_mov_b32 s51, 0x20000
  s_lshr_b32 s10, s54, 1
  s_lshl_b32 s10, s10, 3
  s_and_b32 s7, s55, 7
  s_add_u32 s10, s10, s7
  s_and_b32 s11, s54, 1
  s_lshl_b32 s11, s11, 2
  s_lshr_b32 s7, s55, 3
  s_add_u32 s11, s11, s7
  s_mov_b32 s12, 0
  s_lshl_b32 s13, s10, 18
  s_lshl_b32 s5, s4, 10
  s_add_u32 s13, s13, s5
  s_lshl_b32 s15, s4, 14
  v_lshrrev_b32 v3, 3, v1
  v_lshrrev_b32 v4, 4, v1
  v_and_b32 v5, 7, v1
  v_xor_b32 v5, v5, v4
  v_lshlrev_b32 v3, 12, v3
  v_lshl_add_u32 v3, v5, 4, v3
  v_xor_b32 v5, 64, v3
  s_add_u32 s5, s4, 0
  s_and_b32 s5, s5, 3
  s_lshl_b32 s5, s5, 16
  v_add_u32 v8, s5, v3
  s_add_u32 s5, s4, 0
  s_and_b32 s5, s5, 3
  s_lshl_b32 s5, s5, 16
  s_add_u32 s5, s5, 31744
  v_add_u32 v9, s5, v5
  s_add_u32 s5, s4, 1
  s_and_b32 s5, s5, 3
  s_lshl_b32 s5, s5, 16
  v_add_u32 v10, s5, v3
  s_add_u32 s5, s4, 1
  s_and_b32 s5, s5, 3
  s_lshl_b32 s5, s5, 16
  s_add_u32 s5, s5, 31744
  v_add_u32 v11, s5, v5
  s_add_u32 s5, s4, 2
  s_and_b32 s5, s5, 3
  s_lshl_b32 s5, s5, 16
  v_add_u32 v12, s5, v3
  s_add_u32 s5, s4, 2
  s_and_b32 s5, s5, 3
  s_lshl_b32 s5, s5, 16
  s_add_u32 s5, s5, 31744
  v_add_u32 v13, s5, v5
  s_add_u32 s5, s4, 3
  s_and_b32 s5, s5, 3
  s_lshl_b32 s5, s5, 16
  v_add_u32 v14, s5, v3
  s_add_u32 s5, s4, 3
  s_and_b32 s5, s5, 3
  s_lshl_b32 s5, s5, 16
  s_add_u32 s5, s5, 31744
  v_add_u32 v15, s5, v5
  s_xor_b32 s16, s12, 0
  s_lshl_b32 s16, s16, 7
  s_add_u32 s16, s16, s13
  s_add_u32 m0, s15, 0
  s_nop 0
  buffer_load_dwordx4 v8, s[44:47], s16 offen offset:0  lds
  buffer_load_dwordx4 v9, s[44:47], s16 offen offset:1024  lds
  s_add_u32 m0, s15, 2048
  s_nop 0
  buffer_load_dwordx4 v10, s[44:47], s16 offen offset:0  lds
  buffer_load_dwordx4 v11, s[44:47], s16 offen offset:1024  lds
  s_add_u32 m0, s15, 4096
  s_nop 0
  buffer_load_dwordx4 v12, s[44:47], s16 offen offset:0  lds
  buffer_load_dwordx4 v13, s[44:47], s16 offen offset:1024  lds
  s_add_u32 m0, s15, 6144
  s_nop 0
  buffer_load_dwordx4 v14, s[44:47], s16 offen offset:0  lds
  buffer_load_dwordx4 v15, s[44:47], s16 offen offset:1024  lds
  s_mul_i32 s14, s4, 896
  s_mul_i32 s5, s11, 7
  s_add_u32 s14, s14, s5
  s_lshl_b32 s14, s14, 10
  v_lshlrev_b32 v16, 4, v1
  v_add_u32 v17, 4096, v16
  v_and_b32 v3, 15, v1
  v_lshrrev_b32 v5, 1, v3
  v_xor_b32 v5, v5, v4
  v_lshlrev_b32 v3, 7, v3
  v_lshl_add_u32 v3, v5, 4, v3
  v_add_u32 v18, s15, v3
  v_xor_b32 v19, 64, v18
  s_lshl_b32 s5, s4, 2
  s_add_u32 s5, s5, 162576
  v_mov_b32 v20, s5
  s_mul_i32 s5, s11, 7
  s_add_u32 s6, s5, 6
  s_lshr_b32 s5, s5, 3
  s_lshr_b32 s6, s6, 3
  s_sub_u32 s6, s6, s5
  v_bfe_u32 v3, v1, 3, 1
  v_mul_u32_u24 v3, s6, v3
  v_add_u32 v3, s5, v3
  v_and_b32 v136, 7, v1
  s_lshl_b32 s5, s4, 3
  v_add_u32 v136, s5, v136
  v_and_b32 v5, 3, v136
  v_mad_u32_u24 v5, v5, 7, v3
  v_lshrrev_b32 v136, 2, v136
  v_lshl_add_u32 v136, v5, 3, v136
  v_lshlrev_b32 v136, 7, v136
  v_add_u32 v136, 17375232, v136
  v_mov_b32 v252, s10
  v_and_b32 v5, 3, v252
  v_mad_u32_u24 v5, v5, 7, v3
  v_lshrrev_b32 v252, 2, v252
  v_lshl_add_u32 v252, v5, 3, v252
  v_lshlrev_b32 v252, 7, v252
  v_add_u32 v252, 17506304, v252
p2_s_w:
  buffer_load_dword v138, v136, s[40:43], 0 offen sc1
  s_waitcnt vmcnt(0)
  v_xor_b32 v138, v138, v2
  v_cmp_ne_u32 vcc, 0, v138
  s_cmp_eq_u64 vcc, 0
  s_cbranch_scc1 p2_s_g
  s_add_u32 s53, s53, 1
  s_cmp_ge_u32 s53, 131072
  s_cbranch_scc1 p2_s_g
  s_sleep 2
  s_branch p2_s_w
p2_s_g:
  v_mov_b32 v3, 1
  v_mov_b32 v4, 162596
  s_mov_b64 exec, 1
  ds_add_rtn_u32 v5, v4, v3
  s_lshl_b32 s5, s22, 7
  s_add_u32 s5, s5, 17506304
  s_waitcnt lgkmcnt(0)
  v_readfirstlane_b32 s6, v5
  s_mov_b64 exec, -1
  s_cmp_eq_u32 s6, 3
  s_cselect_b32 s5, s5, 1073741824
  buffer_store_dword v2, off, s[40:43], s5 sc1
  s_setprio 1
  s_xor_b32 s17, s12, 0
  s_mul_i32 s17, s17, 114688
  s_add_u32 s17, s17, s14
  s_add_u32 s18, s17, 57344
  buffer_load_dwordx4 v[136:139], v16, s[40:43], s17 offen offset:0 sc1
  buffer_load_dwordx4 v[140:143], v16, s[40:43], s17 offen offset:1024 sc1
  buffer_load_dwordx4 v[144:147], v16, s[40:43], s17 offen offset:2048 sc1
  buffer_load_dwordx4 v[148:151], v16, s[40:43], s17 offen offset:3072 sc1
  buffer_load_dwordx4 v[152:155], v17, s[40:43], s17 offen offset:0 sc1
  buffer_load_dwordx4 v[156:159], v17, s[40:43], s17 offen offset:1024 sc1
  buffer_load_dwordx4 v[160:163], v17, s[40:43], s17 offen offset:2048 sc1
  ds_read_b128 v[220:223], v18 offset:0
  ds_read_b128 v[224:227], v18 offset:2048
  ds_read_b128 v[228:231], v18 offset:4096
  ds_read_b128 v[232:235], v18 offset:6144
  buffer_load_dwordx4 v[164:167], v16, s[40:43], s18 offen offset:0 sc1
  buffer_load_dwordx4 v[168:171], v16, s[40:43], s18 offen offset:1024 sc1
  buffer_load_dwordx4 v[172:175], v16, s[40:43], s18 offen offset:2048 sc1
  buffer_load_dwordx4 v[176:179], v16, s[40:43], s18 offen offset:3072 sc1
  buffer_load_dwordx4 v[180:183], v17, s[40:43], s18 offen offset:0 sc1
  buffer_load_dwordx4 v[184:187], v17, s[40:43], s18 offen offset:1024 sc1
  buffer_load_dwordx4 v[188:191], v17, s[40:43], s18 offen offset:2048 sc1
  s_xor_b32 s16, s12, 1
  s_lshl_b32 s16, s16, 7
  s_add_u32 s16, s16, s13
  s_add_u32 m0, s15, 8192
  s_nop 0
  buffer_load_dwordx4 v8, s[44:47], s16 offen offset:0  lds
  buffer_load_dwordx4 v9, s[44:47], s16 offen offset:1024  lds
  s_add_u32 m0, s15, 10240
  s_nop 0
  buffer_load_dwordx4 v10, s[44:47], s16 offen offset:0  lds
  buffer_load_dwordx4 v11, s[44:47], s16 offen offset:1024  lds
  s_add_u32 m0, s15, 12288
  s_nop 0
  buffer_load_dwordx4 v12, s[44:47], s16 offen offset:0  lds
  buffer_load_dwordx4 v13, s[44:47], s16 offen offset:1024  lds
  s_add_u32 m0, s15, 14336
  s_nop 0
  buffer_load_dwordx4 v14, s[44:47], s16 offen offset:0  lds
  buffer_load_dwordx4 v15, s[44:47], s16 offen offset:1024  lds
  s_xor_b32 s17, s12, 1
  s_mul_i32 s17, s17, 114688
  s_add_u32 s17, s17, s14
  s_add_u32 s18, s17, 57344
  buffer_load_dwordx4 v[192:195], v16, s[40:43], s17 offen offset:0 sc1
  buffer_load_dwordx4 v[196:199], v16, s[40:43], s17 offen offset:1024 sc1
  buffer_load_dwordx4 v[200:203], v16, s[40:43], s17 offen offset:2048 sc1
  buffer_load_dwordx4 v[204:207], v16, s[40:43], s17 offen offset:3072 sc1
  buffer_load_dwordx4 v[208:211], v17, s[40:43], s17 offen offset:0 sc1
  buffer_load_dwordx4 v[212:215], v17, s[40:43], s17 offen offset:1024 sc1
  buffer_load_dwordx4 v[216:219], v17, s[40:43], s17 offen offset:2048 sc1
  s_waitcnt lgkmcnt(0)
  s_waitcnt vmcnt(28)
  v_mfma_f32_16x16x32_bf16 v[24:27], v[136:139], v[220:223], 0
  v_mfma_f32_16x16x32_bf16 v[52:55], v[136:139], v[224:227], 0
  v_mfma_f32_16x16x32_bf16 v[80:83], v[136:139], v[228:231], 0
  v_mfma_f32_16x16x32_bf16 v[108:111], v[136:139], v[232:235], 0
  buffer_load_dwordx4 v[136:139], v16, s[40:43], s18 offen offset:0 sc1
  s_waitcnt vmcnt(28)
  v_mfma_f32_16x16x32_bf16 v[28:31], v[140:143], v[220:223], 0
  v_mfma_f32_16x16x32_bf16 v[56:59], v[140:143], v[224:227], 0
  v_mfma_f32_16x16x32_bf16 v[84:87], v[140:143], v[228:231], 0
  v_mfma_f32_16x16x32_bf16 v[112:115], v[140:143], v[232:235], 0
  buffer_load_dwordx4 v[140:143], v16, s[40:43], s18 offen offset:1024 sc1
  s_waitcnt vmcnt(28)
  v_mfma_f32_16x16x32_bf16 v[32:35], v[144:147], v[220:223], 0
  v_mfma_f32_16x16x32_bf16 v[60:63], v[144:147], v[224:227], 0
  v_mfma_f32_16x16x32_bf16 v[88:91], v[144:147], v[228:231], 0
  v_mfma_f32_16x16x32_bf16 v[116:119], v[144:147], v[232:235], 0
  buffer_load_dwordx4 v[144:147], v16, s[40:43], s18 offen offset:2048 sc1
  ds_read_b128 v[236:239], v19 offset:0
  ds_read_b128 v[240:243], v19 offset:2048
  ds_read_b128 v[244:247], v19 offset:4096
  ds_read_b128 v[248:251], v19 offset:6144
  s_waitcnt vmcnt(28)
  v_mfma_f32_16x16x32_bf16 v[36:39], v[148:151], v[220:223], 0
  v_mfma_f32_16x16x32_bf16 v[64:67], v[148:151], v[224:227], 0
  v_mfma_f32_16x16x32_bf16 v[92:95], v[148:151], v[228:231], 0
  v_mfma_f32_16x16x32_bf16 v[120:123], v[148:151], v[232:235], 0
  buffer_load_dwordx4 v[148:151], v16, s[40:43], s18 offen offset:3072 sc1
  s_waitcnt vmcnt(28)
  v_mfma_f32_16x16x32_bf16 v[40:43], v[152:155], v[220:223], 0
  v_mfma_f32_16x16x32_bf16 v[68:71], v[152:155], v[224:227], 0
  v_mfma_f32_16x16x32_bf16 v[96:99], v[152:155], v[228:231], 0
  v_mfma_f32_16x16x32_bf16 v[124:127], v[152:155], v[232:235], 0
  buffer_load_dwordx4 v[152:155], v17, s[40:43], s18 offen offset:0 sc1
  s_waitcnt vmcnt(28)
  v_mfma_f32_16x16x32_bf16 v[44:47], v[156:159], v[220:223], 0
  v_mfma_f32_16x16x32_bf16 v[72:75], v[156:159], v[224:227], 0
  v_mfma_f32_16x16x32_bf16 v[100:103], v[156:159], v[228:231], 0
  v_mfma_f32_16x16x32_bf16 v[128:131], v[156:159], v[232:235], 0
  buffer_load_dwordx4 v[156:159], v17, s[40:43], s18 offen offset:1024 sc1
  s_waitcnt vmcnt(28)
  v_mfma_f32_16x16x32_bf16 v[48:51], v[160:163], v[220:223], 0
  v_mfma_f32_16x16x32_bf16 v[76:79], v[160:163], v[224:227], 0
  v_mfma_f32_16x16x32_bf16 v[104:107], v[160:163], v[228:231], 0
  v_mfma_f32_16x16x32_bf16 v[132:135], v[160:163], v[232:235], 0
  buffer_load_dwordx4 v[160:163], v17, s[40:43], s18 offen offset:2048 sc1
  s_waitcnt lgkmcnt(0)
  s_xor_b32 s17, s12, 2
  s_mul_i32 s17, s17, 114688
  s_add_u32 s17, s17, s14
  s_add_u32 s18, s17, 57344
  s_xor_b32 s16, s12, 2
  s_lshl_b32 s16, s16, 7
  s_add_u32 s16, s16, s13
  s_waitcnt vmcnt(28)
  v_mfma_f32_16x16x32_bf16 v[24:27], v[164:167], v[236:239], v[24:27]
  v_mfma_f32_16x16x32_bf16 v[52:55], v[164:167], v[240:243], v[52:55]
  v_mfma_f32_16x16x32_bf16 v[80:83], v[164:167], v[244:247], v[80:83]
  v_mfma_f32_16x16x32_bf16 v[108:111], v[164:167], v[248:251], v[108:111]
  buffer_load_dwordx4 v[164:167], v16, s[40:43], s17 offen offset:0 sc1
  s_add_u32 m0, s15, 0
  s_nop 0
  buffer_load_dwordx4 v8, s[44:47], s16 offen offset:0  lds
  buffer_load_dwordx4 v9, s[44:47], s16 offen offset:1024  lds
  s_waitcnt vmcnt(30)
  v_mfma_f32_16x16x32_bf16 v[28:31], v[168:171], v[236:239], v[28:31]
  v_mfma_f32_16x16x32_bf16 v[56:59], v[168:171], v[240:243], v[56:59]
  v_mfma_f32_16x16x32_bf16 v[84:87], v[168:171], v[244:247], v[84:87]
  v_mfma_f32_16x16x32_bf16 v[112:115], v[168:171], v[248:251], v[112:115]
  buffer_load_dwordx4 v[168:171], v16, s[40:43], s17 offen offset:1024 sc1
  s_add_u32 m0, s15, 2048
  s_nop 0
  buffer_load_dwordx4 v10, s[44:47], s16 offen offset:0  lds
  s_waitcnt vmcnt(31)
  v_mfma_f32_16x16x32_bf16 v[32:35], v[172:175], v[236:239], v[32:35]
  v_mfma_f32_16x16x32_bf16 v[60:63], v[172:175], v[240:243], v[60:63]
  v_mfma_f32_16x16x32_bf16 v[88:91], v[172:175], v[244:247], v[88:91]
  v_mfma_f32_16x16x32_bf16 v[116:119], v[172:175], v[248:251], v[116:119]
  buffer_load_dwordx4 v[172:175], v16, s[40:43], s17 offen offset:2048 sc1
  buffer_load_dwordx4 v11, s[44:47], s16 offen offset:1024  lds
  s_waitcnt vmcnt(21)
  ds_read_b128 v[220:223], v18 offset:8192
  ds_read_b128 v[224:227], v18 offset:10240
  ds_read_b128 v[228:231], v18 offset:12288
  ds_read_b128 v[232:235], v18 offset:14336
  v_mfma_f32_16x16x32_bf16 v[36:39], v[176:179], v[236:239], v[36:39]
  v_mfma_f32_16x16x32_bf16 v[64:67], v[176:179], v[240:243], v[64:67]
  v_mfma_f32_16x16x32_bf16 v[92:95], v[176:179], v[244:247], v[92:95]
  v_mfma_f32_16x16x32_bf16 v[120:123], v[176:179], v[248:251], v[120:123]
  buffer_load_dwordx4 v[176:179], v16, s[40:43], s17 offen offset:3072 sc1
  s_add_u32 m0, s15, 4096
  s_nop 0
  buffer_load_dwordx4 v12, s[44:47], s16 offen offset:0  lds
  v_mfma_f32_16x16x32_bf16 v[40:43], v[180:183], v[236:239], v[40:43]
  v_mfma_f32_16x16x32_bf16 v[68:71], v[180:183], v[240:243], v[68:71]
  v_mfma_f32_16x16x32_bf16 v[96:99], v[180:183], v[244:247], v[96:99]
  v_mfma_f32_16x16x32_bf16 v[124:127], v[180:183], v[248:251], v[124:127]
  buffer_load_dwordx4 v[180:183], v17, s[40:43], s17 offen offset:0 sc1
  buffer_load_dwordx4 v13, s[44:47], s16 offen offset:1024  lds
  v_mfma_f32_16x16x32_bf16 v[44:47], v[184:187], v[236:239], v[44:47]
  v_mfma_f32_16x16x32_bf16 v[72:75], v[184:187], v[240:243], v[72:75]
  v_mfma_f32_16x16x32_bf16 v[100:103], v[184:187], v[244:247], v[100:103]
  v_mfma_f32_16x16x32_bf16 v[128:131], v[184:187], v[248:251], v[128:131]
  buffer_load_dwordx4 v[184:187], v17, s[40:43], s17 offen offset:1024 sc1
  s_add_u32 m0, s15, 6144
  s_nop 0
  buffer_load_dwordx4 v14, s[44:47], s16 offen offset:0  lds
  v_mfma_f32_16x16x32_bf16 v[48:51], v[188:191], v[236:239], v[48:51]
  v_mfma_f32_16x16x32_bf16 v[76:79], v[188:191], v[240:243], v[76:79]
  v_mfma_f32_16x16x32_bf16 v[104:107], v[188:191], v[244:247], v[104:107]
  v_mfma_f32_16x16x32_bf16 v[132:135], v[188:191], v[248:251], v[132:135]
  buffer_load_dwordx4 v[188:191], v17, s[40:43], s17 offen offset:2048 sc1
  buffer_load_dwordx4 v15, s[44:47], s16 offen offset:1024  lds
  s_waitcnt lgkmcnt(0)
  s_waitcnt vmcnt(28)
  v_mfma_f32_16x16x32_bf16 v[24:27], v[192:195], v[220:223], v[24:27]
  v_mfma_f32_16x16x32_bf16 v[52:55], v[192:195], v[224:227], v[52:55]
  v_mfma_f32_16x16x32_bf16 v[80:83], v[192:195], v[228:231], v[80:83]
  v_mfma_f32_16x16x32_bf16 v[108:111], v[192:195], v[232:235], v[108:111]
  buffer_load_dwordx4 v[192:195], v16, s[40:43], s18 offen offset:0 sc1
  s_waitcnt vmcnt(28)
  v_mfma_f32_16x16x32_bf16 v[28:31], v[196:199], v[220:223], v[28:31]
  v_mfma_f32_16x16x32_bf16 v[56:59], v[196:199], v[224:227], v[56:59]
  v_mfma_f32_16x16x32_bf16 v[84:87], v[196:199], v[228:231], v[84:87]
  v_mfma_f32_16x16x32_bf16 v[112:115], v[196:199], v[232:235], v[112:115]
  buffer_load_dwordx4 v[196:199], v16, s[40:43], s18 offen offset:1024 sc1
  s_waitcnt vmcnt(28)
  v_mfma_f32_16x16x32_bf16 v[32:35], v[200:203], v[220:223], v[32:35]
  v_mfma_f32_16x16x32_bf16 v[60:63], v[200:203], v[224:227], v[60:63]
  v_mfma_f32_16x16x32_bf16 v[88:91], v[200:203], v[228:231], v[88:91]
  v_mfma_f32_16x16x32_bf16 v[116:119], v[200:203], v[232:235], v[116:119]
  buffer_load_dwordx4 v[200:203], v16, s[40:43], s18 offen offset:2048 sc1
  ds_read_b128 v[236:239], v19 offset:8192
  ds_read_b128 v[240:243], v19 offset:10240
  ds_read_b128 v[244:247], v19 offset:12288
  ds_read_b128 v[248:251], v19 offset:14336
  s_waitcnt vmcnt(28)
  v_mfma_f32_16x16x32_bf16 v[36:39], v[204:207], v[220:223], v[36:39]
  v_mfma_f32_16x16x32_bf16 v[64:67], v[204:207], v[224:227], v[64:67]
  v_mfma_f32_16x16x32_bf16 v[92:95], v[204:207], v[228:231], v[92:95]
  v_mfma_f32_16x16x32_bf16 v[120:123], v[204:207], v[232:235], v[120:123]
  buffer_load_dwordx4 v[204:207], v16, s[40:43], s18 offen offset:3072 sc1
  s_waitcnt vmcnt(28)
  v_mfma_f32_16x16x32_bf16 v[40:43], v[208:211], v[220:223], v[40:43]
  v_mfma_f32_16x16x32_bf16 v[68:71], v[208:211], v[224:227], v[68:71]
  v_mfma_f32_16x16x32_bf16 v[96:99], v[208:211], v[228:231], v[96:99]
  v_mfma_f32_16x16x32_bf16 v[124:127], v[208:211], v[232:235], v[124:127]
  buffer_load_dwordx4 v[208:211], v17, s[40:43], s18 offen offset:0 sc1
  s_waitcnt vmcnt(28)
  v_mfma_f32_16x16x32_bf16 v[44:47], v[212:215], v[220:223], v[44:47]
  v_mfma_f32_16x16x32_bf16 v[72:75], v[212:215], v[224:227], v[72:75]
  v_mfma_f32_16x16x32_bf16 v[100:103], v[212:215], v[228:231], v[100:103]
  v_mfma_f32_16x16x32_bf16 v[128:131], v[212:215], v[232:235], v[128:131]
  buffer_load_dwordx4 v[212:215], v17, s[40:43], s18 offen offset:1024 sc1
  s_waitcnt vmcnt(28)
  v_mfma_f32_16x16x32_bf16 v[48:51], v[216:219], v[220:223], v[48:51]
  v_mfma_f32_16x16x32_bf16 v[76:79], v[216:219], v[224:227], v[76:79]
  v_mfma_f32_16x16x32_bf16 v[104:107], v[216:219], v[228:231], v[104:107]
  v_mfma_f32_16x16x32_bf16 v[132:135], v[216:219], v[232:235], v[132:135]
  buffer_load_dwordx4 v[216:219], v17, s[40:43], s18 offen offset:2048 sc1
  s_waitcnt lgkmcnt(0)
  s_xor_b32 s17, s12, 3
  s_mul_i32 s17, s17, 114688
  s_add_u32 s17, s17, s14
  s_add_u32 s18, s17, 57344
  s_xor_b32 s16, s12, 3
  s_lshl_b32 s16, s16, 7
  s_add_u32 s16, s16, s13
  s_waitcnt vmcnt(28)
  v_mfma_f32_16x16x32_bf16 v[24:27], v[136:139], v[236:239], v[24:27]
  v_mfma_f32_16x16x32_bf16 v[52:55], v[136:139], v[240:243], v[52:55]
  v_mfma_f32_16x16x32_bf16 v[80:83], v[136:139], v[244:247], v[80:83]
  v_mfma_f32_16x16x32_bf16 v[108:111], v[136:139], v[248:251], v[108:111]
  buffer_load_dwordx4 v[136:139], v16, s[40:43], s17 offen offset:0 sc1
  s_add_u32 m0, s15, 8192
  s_nop 0
  buffer_load_dwordx4 v8, s[44:47], s16 offen offset:0  lds
  buffer_load_dwordx4 v9, s[44:47], s16 offen offset:1024  lds
  s_waitcnt vmcnt(30)
  v_mfma_f32_16x16x32_bf16 v[28:31], v[140:143], v[236:239], v[28:31]
  v_mfma_f32_16x16x32_bf16 v[56:59], v[140:143], v[240:243], v[56:59]
  v_mfma_f32_16x16x32_bf16 v[84:87], v[140:143], v[244:247], v[84:87]
  v_mfma_f32_16x16x32_bf16 v[112:115], v[140:143], v[248:251], v[112:115]
  buffer_load_dwordx4 v[140:143], v16, s[40:43], s17 offen offset:1024 sc1
  s_add_u32 m0, s15, 10240
  s_nop 0
  buffer_load_dwordx4 v10, s[44:47], s16 offen offset:0  lds
  s_waitcnt vmcnt(31)
  v_mfma_f32_16x16x32_bf16 v[32:35], v[144:147], v[236:239], v[32:35]
  v_mfma_f32_16x16x32_bf16 v[60:63], v[144:147], v[240:243], v[60:63]
  v_mfma_f32_16x16x32_bf16 v[88:91], v[144:147], v[244:247], v[88:91]
  v_mfma_f32_16x16x32_bf16 v[116:119], v[144:147], v[248:251], v[116:119]
  buffer_load_dwordx4 v[144:147], v16, s[40:43], s17 offen offset:2048 sc1
  buffer_load_dwordx4 v11, s[44:47], s16 offen offset:1024  lds
  s_waitcnt vmcnt(14)
  ds_read_b128 v[220:223], v18 offset:0
  ds_read_b128 v[224:227], v18 offset:2048
  ds_read_b128 v[228:231], v18 offset:4096
  ds_read_b128 v[232:235], v18 offset:6144
  v_mfma_f32_16x16x32_bf16 v[36:39], v[148:151], v[236:239], v[36:39]
  v_mfma_f32_16x16x32_bf16 v[64:67], v[148:151], v[240:243], v[64:67]
  v_mfma_f32_16x16x32_bf16 v[92:95], v[148:151], v[244:247], v[92:95]
  v_mfma_f32_16x16x32_bf16 v[120:123], v[148:151], v[248:251], v[120:123]
  buffer_load_dwordx4 v[148:151], v16, s[40:43], s17 offen offset:3072 sc1
  s_add_u32 m0, s15, 12288
  s_nop 0
  buffer_load_dwordx4 v12, s[44:47], s16 offen offset:0  lds
  v_mfma_f32_16x16x32_bf16 v[40:43], v[152:155], v[236:239], v[40:43]
  v_mfma_f32_16x16x32_bf16 v[68:71], v[152:155], v[240:243], v[68:71]
  v_mfma_f32_16x16x32_bf16 v[96:99], v[152:155], v[244:247], v[96:99]
  v_mfma_f32_16x16x32_bf16 v[124:127], v[152:155], v[248:251], v[124:127]
  buffer_load_dwordx4 v[152:155], v17, s[40:43], s17 offen offset:0 sc1
  buffer_load_dwordx4 v13, s[44:47], s16 offen offset:1024  lds
  v_mfma_f32_16x16x32_bf16 v[44:47], v[156:159], v[236:239], v[44:47]
  v_mfma_f32_16x16x32_bf16 v[72:75], v[156:159], v[240:243], v[72:75]
  v_mfma_f32_16x16x32_bf16 v[100:103], v[156:159], v[244:247], v[100:103]
  v_mfma_f32_16x16x32_bf16 v[128:131], v[156:159], v[248:251], v[128:131]
  buffer_load_dwordx4 v[156:159], v17, s[40:43], s17 offen offset:1024 sc1
  s_add_u32 m0, s15, 14336
  s_nop 0
  buffer_load_dwordx4 v14, s[44:47], s16 offen offset:0  lds
  v_mfma_f32_16x16x32_bf16 v[48:51], v[160:163], v[236:239], v[48:51]
  v_mfma_f32_16x16x32_bf16 v[76:79], v[160:163], v[240:243], v[76:79]
  v_mfma_f32_16x16x32_bf16 v[104:107], v[160:163], v[244:247], v[104:107]
  v_mfma_f32_16x16x32_bf16 v[132:135], v[160:163], v[248:251], v[132:135]
  buffer_load_dwordx4 v[160:163], v17, s[40:43], s17 offen offset:2048 sc1
  buffer_load_dwordx4 v15, s[44:47], s16 offen offset:1024  lds
  s_waitcnt lgkmcnt(0)
  v_mfma_f32_16x16x32_bf16 v[24:27], v[164:167], v[220:223], v[24:27]
  v_mfma_f32_16x16x32_bf16 v[52:55], v[164:167], v[224:227], v[52:55]
  v_mfma_f32_16x16x32_bf16 v[80:83], v[164:167], v[228:231], v[80:83]
  v_mfma_f32_16x16x32_bf16 v[108:111], v[164:167], v[232:235], v[108:111]
  buffer_load_dwordx4 v[164:167], v16, s[40:43], s18 offen offset:0 sc1
  v_mfma_f32_16x16x32_bf16 v[28:31], v[168:171], v[220:223], v[28:31]
  v_mfma_f32_16x16x32_bf16 v[56:59], v[168:171], v[224:227], v[56:59]
  v_mfma_f32_16x16x32_bf16 v[84:87], v[168:171], v[228:231], v[84:87]
  v_mfma_f32_16x16x32_bf16 v[112:115], v[168:171], v[232:235], v[112:115]
  buffer_load_dwordx4 v[168:171], v16, s[40:43], s18 offen offset:1024 sc1
  v_mfma_f32_16x16x32_bf16 v[32:35], v[172:175], v[220:223], v[32:35]
  v_mfma_f32_16x16x32_bf16 v[60:63], v[172:175], v[224:227], v[60:63]
  v_mfma_f32_16x16x32_bf16 v[88:91], v[172:175], v[228:231], v[88:91]
  v_mfma_f32_16x16x32_bf16 v[116:119], v[172:175], v[232:235], v[116:119]
  buffer_load_dwordx4 v[172:175], v16, s[40:43], s18 offen offset:2048 sc1
  ds_read_b128 v[236:239], v19 offset:0
  ds_read_b128 v[240:243], v19 offset:2048
  ds_read_b128 v[244:247], v19 offset:4096
  ds_read_b128 v[248:251], v19 offset:6144
  v_mfma_f32_16x16x32_bf16 v[36:39], v[176:179], v[220:223], v[36:39]
  v_mfma_f32_16x16x32_bf16 v[64:67], v[176:179], v[224:227], v[64:67]
  v_mfma_f32_16x16x32_bf16 v[92:95], v[176:179], v[228:231], v[92:95]
  v_mfma_f32_16x16x32_bf16 v[120:123], v[176:179], v[232:235], v[120:123]
  buffer_load_dwordx4 v[176:179], v16, s[40:43], s18 offen offset:3072 sc1
  v_mfma_f32_16x16x32_bf16 v[40:43], v[180:183], v[220:223], v[40:43]
  v_mfma_f32_16x16x32_bf16 v[68:71], v[180:183], v[224:227], v[68:71]
  v_mfma_f32_16x16x32_bf16 v[96:99], v[180:183], v[228:231], v[96:99]
  v_mfma_f32_16x16x32_bf16 v[124:127], v[180:183], v[232:235], v[124:127]
  buffer_load_dwordx4 v[180:183], v17, s[40:43], s18 offen offset:0 sc1
  v_mfma_f32_16x16x32_bf16 v[44:47], v[184:187], v[220:223], v[44:47]
  v_mfma_f32_16x16x32_bf16 v[72:75], v[184:187], v[224:227], v[72:75]
  v_mfma_f32_16x16x32_bf16 v[100:103], v[184:187], v[228:231], v[100:103]
  v_mfma_f32_16x16x32_bf16 v[128:131], v[184:187], v[232:235], v[128:131]
  buffer_load_dwordx4 v[184:187], v17, s[40:43], s18 offen offset:1024 sc1
  v_mfma_f32_16x16x32_bf16 v[48:51], v[188:191], v[220:223], v[48:51]
  v_mfma_f32_16x16x32_bf16 v[76:79], v[188:191], v[224:227], v[76:79]
  v_mfma_f32_16x16x32_bf16 v[104:107], v[188:191], v[228:231], v[104:107]
  v_mfma_f32_16x16x32_bf16 v[132:135], v[188:191], v[232:235], v[132:135]
  buffer_load_dwordx4 v[188:191], v17, s[40:43], s18 offen offset:2048 sc1
  s_waitcnt lgkmcnt(0)
  s_xor_b32 s17, s12, 4
  s_mul_i32 s17, s17, 114688
  s_add_u32 s17, s17, s14
  s_add_u32 s18, s17, 57344
  s_xor_b32 s16, s12, 4
  s_lshl_b32 s16, s16, 7
  s_add_u32 s16, s16, s13
  s_waitcnt vmcnt(28)
  v_mfma_f32_16x16x32_bf16 v[24:27], v[192:195], v[236:239], v[24:27]
  v_mfma_f32_16x16x32_bf16 v[52:55], v[192:195], v[240:243], v[52:55]
  v_mfma_f32_16x16x32_bf16 v[80:83], v[192:195], v[244:247], v[80:83]
  v_mfma_f32_16x16x32_bf16 v[108:111], v[192:195], v[248:251], v[108:111]
  buffer_load_dwordx4 v[192:195], v16, s[40:43], s17 offen offset:0 sc1
  s_add_u32 m0, s15, 0
  s_nop 0
  buffer_load_dwordx4 v8, s[44:47], s16 offen offset:0  lds
  buffer_load_dwordx4 v9, s[44:47], s16 offen offset:1024  lds
  s_waitcnt vmcnt(30)
  v_mfma_f32_16x16x32_bf16 v[28:31], v[196:199], v[236:239], v[28:31]
  v_mfma_f32_16x16x32_bf16 v[56:59], v[196:199], v[240:243], v[56:59]
  v_mfma_f32_16x16x32_bf16 v[84:87], v[196:199], v[244:247], v[84:87]
  v_mfma_f32_16x16x32_bf16 v[112:115], v[196:199], v[248:251], v[112:115]
  buffer_load_dwordx4 v[196:199], v16, s[40:43], s17 offen offset:1024 sc1
  s_add_u32 m0, s15, 2048
  s_nop 0
  buffer_load_dwordx4 v10, s[44:47], s16 offen offset:0  lds
  s_waitcnt vmcnt(31)
  v_mfma_f32_16x16x32_bf16 v[32:35], v[200:203], v[236:239], v[32:35]
  v_mfma_f32_16x16x32_bf16 v[60:63], v[200:203], v[240:243], v[60:63]
  v_mfma_f32_16x16x32_bf16 v[88:91], v[200:203], v[244:247], v[88:91]
  v_mfma_f32_16x16x32_bf16 v[116:119], v[200:203], v[248:251], v[116:119]
  buffer_load_dwordx4 v[200:203], v16, s[40:43], s17 offen offset:2048 sc1
  buffer_load_dwordx4 v11, s[44:47], s16 offen offset:1024  lds
  s_waitcnt vmcnt(14)
  ds_read_b128 v[220:223], v18 offset:8192
  ds_read_b128 v[224:227], v18 offset:10240
  ds_read_b128 v[228:231], v18 offset:12288
  ds_read_b128 v[232:235], v18 offset:14336
  v_mfma_f32_16x16x32_bf16 v[36:39], v[204:207], v[236:239], v[36:39]
  v_mfma_f32_16x16x32_bf16 v[64:67], v[204:207], v[240:243], v[64:67]
  v_mfma_f32_16x16x32_bf16 v[92:95], v[204:207], v[244:247], v[92:95]
  v_mfma_f32_16x16x32_bf16 v[120:123], v[204:207], v[248:251], v[120:123]
  buffer_load_dwordx4 v[204:207], v16, s[40:43], s17 offen offset:3072 sc1
  s_add_u32 m0, s15, 4096
  s_nop 0
  buffer_load_dwordx4 v12, s[44:47], s16 offen offset:0  lds
  v_mfma_f32_16x16x32_bf16 v[40:43], v[208:211], v[236:239], v[40:43]
  v_mfma_f32_16x16x32_bf16 v[68:71], v[208:211], v[240:243], v[68:71]
  v_mfma_f32_16x16x32_bf16 v[96:99], v[208:211], v[244:247], v[96:99]
  v_mfma_f32_16x16x32_bf16 v[124:127], v[208:211], v[248:251], v[124:127]
  buffer_load_dwordx4 v[208:211], v17, s[40:43], s17 offen offset:0 sc1
  buffer_load_dwordx4 v13, s[44:47], s16 offen offset:1024  lds
  v_mfma_f32_16x16x32_bf16 v[44:47], v[212:215], v[236:239], v[44:47]
  v_mfma_f32_16x16x32_bf16 v[72:75], v[212:215], v[240:243], v[72:75]
  v_mfma_f32_16x16x32_bf16 v[100:103], v[212:215], v[244:247], v[100:103]
  v_mfma_f32_16x16x32_bf16 v[128:131], v[212:215], v[248:251], v[128:131]
  buffer_load_dwordx4 v[212:215], v17, s[40:43], s17 offen offset:1024 sc1
  s_add_u32 m0, s15, 6144
  s_nop 0
  buffer_load_dwordx4 v14, s[44:47], s16 offen offset:0  lds
  v_mfma_f32_16x16x32_bf16 v[48:51], v[216:219], v[236:239], v[48:51]
  v_mfma_f32_16x16x32_bf16 v[76:79], v[216:219], v[240:243], v[76:79]
  v_mfma_f32_16x16x32_bf16 v[104:107], v[216:219], v[244:247], v[104:107]
  v_mfma_f32_16x16x32_bf16 v[132:135], v[216:219], v[248:251], v[132:135]
  buffer_load_dwordx4 v[216:219], v17, s[40:43], s17 offen offset:2048 sc1
  buffer_load_dwordx4 v15, s[44:47], s16 offen offset:1024  lds
  s_waitcnt lgkmcnt(0)
  v_mfma_f32_16x16x32_bf16 v[24:27], v[136:139], v[220:223], v[24:27]
  v_mfma_f32_16x16x32_bf16 v[52:55], v[136:139], v[224:227], v[52:55]
  v_mfma_f32_16x16x32_bf16 v[80:83], v[136:139], v[228:231], v[80:83]
  v_mfma_f32_16x16x32_bf16 v[108:111], v[136:139], v[232:235], v[108:111]
  buffer_load_dwordx4 v[136:139], v16, s[40:43], s18 offen offset:0 sc1
  v_mfma_f32_16x16x32_bf16 v[28:31], v[140:143], v[220:223], v[28:31]
  v_mfma_f32_16x16x32_bf16 v[56:59], v[140:143], v[224:227], v[56:59]
  v_mfma_f32_16x16x32_bf16 v[84:87], v[140:143], v[228:231], v[84:87]
  v_mfma_f32_16x16x32_bf16 v[112:115], v[140:143], v[232:235], v[112:115]
  buffer_load_dwordx4 v[140:143], v16, s[40:43], s18 offen offset:1024 sc1
  v_mfma_f32_16x16x32_bf16 v[32:35], v[144:147], v[220:223], v[32:35]
  v_mfma_f32_16x16x32_bf16 v[60:63], v[144:147], v[224:227], v[60:63]
  v_mfma_f32_16x16x32_bf16 v[88:91], v[144:147], v[228:231], v[88:91]
  v_mfma_f32_16x16x32_bf16 v[116:119], v[144:147], v[232:235], v[116:119]
  buffer_load_dwordx4 v[144:147], v16, s[40:43], s18 offen offset:2048 sc1
  ds_read_b128 v[236:239], v19 offset:8192
  ds_read_b128 v[240:243], v19 offset:10240
  ds_read_b128 v[244:247], v19 offset:12288
  ds_read_b128 v[248:251], v19 offset:14336
  v_mfma_f32_16x16x32_bf16 v[36:39], v[148:151], v[220:223], v[36:39]
  v_mfma_f32_16x16x32_bf16 v[64:67], v[148:151], v[224:227], v[64:67]
  v_mfma_f32_16x16x32_bf16 v[92:95], v[148:151], v[228:231], v[92:95]
  v_mfma_f32_16x16x32_bf16 v[120:123], v[148:151], v[232:235], v[120:123]
  buffer_load_dwordx4 v[148:151], v16, s[40:43], s18 offen offset:3072 sc1
  v_mfma_f32_16x16x32_bf16 v[40:43], v[152:155], v[220:223], v[40:43]
  v_mfma_f32_16x16x32_bf16 v[68:71], v[152:155], v[224:227], v[68:71]
  v_mfma_f32_16x16x32_bf16 v[96:99], v[152:155], v[228:231], v[96:99]
  v_mfma_f32_16x16x32_bf16 v[124:127], v[152:155], v[232:235], v[124:127]
  buffer_load_dwordx4 v[152:155], v17, s[40:43], s18 offen offset:0 sc1
  v_mfma_f32_16x16x32_bf16 v[44:47], v[156:159], v[220:223], v[44:47]
  v_mfma_f32_16x16x32_bf16 v[72:75], v[156:159], v[224:227], v[72:75]
  v_mfma_f32_16x16x32_bf16 v[100:103], v[156:159], v[228:231], v[100:103]
  v_mfma_f32_16x16x32_bf16 v[128:131], v[156:159], v[232:235], v[128:131]
  buffer_load_dwordx4 v[156:159], v17, s[40:43], s18 offen offset:1024 sc1
  v_mfma_f32_16x16x32_bf16 v[48:51], v[160:163], v[220:223], v[48:51]
  v_mfma_f32_16x16x32_bf16 v[76:79], v[160:163], v[224:227], v[76:79]
  v_mfma_f32_16x16x32_bf16 v[104:107], v[160:163], v[228:231], v[104:107]
  v_mfma_f32_16x16x32_bf16 v[132:135], v[160:163], v[232:235], v[132:135]
  buffer_load_dwordx4 v[160:163], v17, s[40:43], s18 offen offset:2048 sc1
  s_waitcnt lgkmcnt(0)
  s_xor_b32 s17, s12, 5
  s_mul_i32 s17, s17, 114688
  s_add_u32 s17, s17, s14
  s_add_u32 s18, s17, 57344
  s_xor_b32 s16, s12, 5
  s_lshl_b32 s16, s16, 7
  s_add_u32 s16, s16, s13
  s_waitcnt vmcnt(28)
  v_mfma_f32_16x16x32_bf16 v[24:27], v[164:167], v[236:239], v[24:27]
  v_mfma_f32_16x16x32_bf16 v[52:55], v[164:167], v[240:243], v[52:55]
  v_mfma_f32_16x16x32_bf16 v[80:83], v[164:167], v[244:247], v[80:83]
  v_mfma_f32_16x16x32_bf16 v[108:111], v[164:167], v[248:251], v[108:111]
  buffer_load_dwordx4 v[164:167], v16, s[40:43], s17 offen offset:0 sc1
  s_add_u32 m0, s15, 8192
  s_nop 0
  buffer_load_dwordx4 v8, s[44:47], s16 offen offset:0  lds
  buffer_load_dwordx4 v9, s[44:47], s16 offen offset:1024  lds
  s_waitcnt vmcnt(30)
  v_mfma_f32_16x16x32_bf16 v[28:31], v[168:171], v[236:239], v[28:31]
  v_mfma_f32_16x16x32_bf16 v[56:59], v[168:171], v[240:243], v[56:59]
  v_mfma_f32_16x16x32_bf16 v[84:87], v[168:171], v[244:247], v[84:87]
  v_mfma_f32_16x16x32_bf16 v[112:115], v[168:171], v[248:251], v[112:115]
  buffer_load_dwordx4 v[168:171], v16, s[40:43], s17 offen offset:1024 sc1
  s_add_u32 m0, s15, 10240
  s_nop 0
  buffer_load_dwordx4 v10, s[44:47], s16 offen offset:0  lds
  s_waitcnt vmcnt(31)
  v_mfma_f32_16x16x32_bf16 v[32:35], v[172:175], v[236:239], v[32:35]
  v_mfma_f32_16x16x32_bf16 v[60:63], v[172:175], v[240:243], v[60:63]
  v_mfma_f32_16x16x32_bf16 v[88:91], v[172:175], v[244:247], v[88:91]
  v_mfma_f32_16x16x32_bf16 v[116:119], v[172:175], v[248:251], v[116:119]
  buffer_load_dwordx4 v[172:175], v16, s[40:43], s17 offen offset:2048 sc1
  buffer_load_dwordx4 v11, s[44:47], s16 offen offset:1024  lds
  s_waitcnt vmcnt(14)
  ds_read_b128 v[220:223], v18 offset:0
  ds_read_b128 v[224:227], v18 offset:2048
  ds_read_b128 v[228:231], v18 offset:4096
  ds_read_b128 v[232:235], v18 offset:6144
  v_mfma_f32_16x16x32_bf16 v[36:39], v[176:179], v[236:239], v[36:39]
  v_mfma_f32_16x16x32_bf16 v[64:67], v[176:179], v[240:243], v[64:67]
  v_mfma_f32_16x16x32_bf16 v[92:95], v[176:179], v[244:247], v[92:95]
  v_mfma_f32_16x16x32_bf16 v[120:123], v[176:179], v[248:251], v[120:123]
  buffer_load_dwordx4 v[176:179], v16, s[40:43], s17 offen offset:3072 sc1
  s_add_u32 m0, s15, 12288
  s_nop 0
  buffer_load_dwordx4 v12, s[44:47], s16 offen offset:0  lds
  v_mfma_f32_16x16x32_bf16 v[40:43], v[180:183], v[236:239], v[40:43]
  v_mfma_f32_16x16x32_bf16 v[68:71], v[180:183], v[240:243], v[68:71]
  v_mfma_f32_16x16x32_bf16 v[96:99], v[180:183], v[244:247], v[96:99]
  v_mfma_f32_16x16x32_bf16 v[124:127], v[180:183], v[248:251], v[124:127]
  buffer_load_dwordx4 v[180:183], v17, s[40:43], s17 offen offset:0 sc1
  buffer_load_dwordx4 v13, s[44:47], s16 offen offset:1024  lds
  v_mfma_f32_16x16x32_bf16 v[44:47], v[184:187], v[236:239], v[44:47]
  v_mfma_f32_16x16x32_bf16 v[72:75], v[184:187], v[240:243], v[72:75]
  v_mfma_f32_16x16x32_bf16 v[100:103], v[184:187], v[244:247], v[100:103]
  v_mfma_f32_16x16x32_bf16 v[128:131], v[184:187], v[248:251], v[128:131]
  buffer_load_dwordx4 v[184:187], v17, s[40:43], s17 offen offset:1024 sc1
  s_add_u32 m0, s15, 14336
  s_nop 0
  buffer_load_dwordx4 v14, s[44:47], s16 offen offset:0  lds
  v_mfma_f32_16x16x32_bf16 v[48:51], v[188:191], v[236:239], v[48:51]
  v_mfma_f32_16x16x32_bf16 v[76:79], v[188:191], v[240:243], v[76:79]
  v_mfma_f32_16x16x32_bf16 v[104:107], v[188:191], v[244:247], v[104:107]
  v_mfma_f32_16x16x32_bf16 v[132:135], v[188:191], v[248:251], v[132:135]
  buffer_load_dwordx4 v[188:191], v17, s[40:43], s17 offen offset:2048 sc1
  buffer_load_dwordx4 v15, s[44:47], s16 offen offset:1024  lds
  s_waitcnt lgkmcnt(0)
  v_mfma_f32_16x16x32_bf16 v[24:27], v[192:195], v[220:223], v[24:27]
  v_mfma_f32_16x16x32_bf16 v[52:55], v[192:195], v[224:227], v[52:55]
  v_mfma_f32_16x16x32_bf16 v[80:83], v[192:195], v[228:231], v[80:83]
  v_mfma_f32_16x16x32_bf16 v[108:111], v[192:195], v[232:235], v[108:111]
  buffer_load_dwordx4 v[192:195], v16, s[40:43], s18 offen offset:0 sc1
  v_mfma_f32_16x16x32_bf16 v[28:31], v[196:199], v[220:223], v[28:31]
  v_mfma_f32_16x16x32_bf16 v[56:59], v[196:199], v[224:227], v[56:59]
  v_mfma_f32_16x16x32_bf16 v[84:87], v[196:199], v[228:231], v[84:87]
  v_mfma_f32_16x16x32_bf16 v[112:115], v[196:199], v[232:235], v[112:115]
  buffer_load_dwordx4 v[196:199], v16, s[40:43], s18 offen offset:1024 sc1
  v_mfma_f32_16x16x32_bf16 v[32:35], v[200:203], v[220:223], v[32:35]
  v_mfma_f32_16x16x32_bf16 v[60:63], v[200:203], v[224:227], v[60:63]
  v_mfma_f32_16x16x32_bf16 v[88:91], v[200:203], v[228:231], v[88:91]
  v_mfma_f32_16x16x32_bf16 v[116:119], v[200:203], v[232:235], v[116:119]
  buffer_load_dwordx4 v[200:203], v16, s[40:43], s18 offen offset:2048 sc1
  ds_read_b128 v[236:239], v19 offset:0
  ds_read_b128 v[240:243], v19 offset:2048
  ds_read_b128 v[244:247], v19 offset:4096
  ds_read_b128 v[248:251], v19 offset:6144
  v_mfma_f32_16x16x32_bf16 v[36:39], v[204:207], v[220:223], v[36:39]
  v_mfma_f32_16x16x32_bf16 v[64:67], v[204:207], v[224:227], v[64:67]
  v_mfma_f32_16x16x32_bf16 v[92:95], v[204:207], v[228:231], v[92:95]
  v_mfma_f32_16x16x32_bf16 v[120:123], v[204:207], v[232:235], v[120:123]
  buffer_load_dwordx4 v[204:207], v16, s[40:43], s18 offen offset:3072 sc1
  v_mfma_f32_16x16x32_bf16 v[40:43], v[208:211], v[220:223], v[40:43]
  v_mfma_f32_16x16x32_bf16 v[68:71], v[208:211], v[224:227], v[68:71]
  v_mfma_f32_16x16x32_bf16 v[96:99], v[208:211], v[228:231], v[96:99]
  v_mfma_f32_16x16x32_bf16 v[124:127], v[208:211], v[232:235], v[124:127]
  buffer_load_dwordx4 v[208:211], v17, s[40:43], s18 offen offset:0 sc1
  v_mfma_f32_16x16x32_bf16 v[44:47], v[212:215], v[220:223], v[44:47]
  v_mfma_f32_16x16x32_bf16 v[72:75], v[212:215], v[224:227], v[72:75]
  v_mfma_f32_16x16x32_bf16 v[100:103], v[212:215], v[228:231], v[100:103]
  v_mfma_f32_16x16x32_bf16 v[128:131], v[212:215], v[232:235], v[128:131]
  buffer_load_dwordx4 v[212:215], v17, s[40:43], s18 offen offset:1024 sc1
  v_mfma_f32_16x16x32_bf16 v[48:51], v[216:219], v[220:223], v[48:51]
  v_mfma_f32_16x16x32_bf16 v[76:79], v[216:219], v[224:227], v[76:79]
  v_mfma_f32_16x16x32_bf16 v[104:107], v[216:219], v[228:231], v[104:107]
  v_mfma_f32_16x16x32_bf16 v[132:135], v[216:219], v[232:235], v[132:135]
  buffer_load_dwordx4 v[216:219], v17, s[40:43], s18 offen offset:2048 sc1
  s_waitcnt lgkmcnt(0)
  s_xor_b32 s17, s12, 6
  s_mul_i32 s17, s17, 114688
  s_add_u32 s17, s17, s14
  s_add_u32 s18, s17, 57344
  s_xor_b32 s16, s12, 6
  s_lshl_b32 s16, s16, 7
  s_add_u32 s16, s16, s13
  s_waitcnt vmcnt(28)
  v_mfma_f32_16x16x32_bf16 v[24:27], v[136:139], v[236:239], v[24:27]
  v_mfma_f32_16x16x32_bf16 v[52:55], v[136:139], v[240:243], v[52:55]
  v_mfma_f32_16x16x32_bf16 v[80:83], v[136:139], v[244:247], v[80:83]
  v_mfma_f32_16x16x32_bf16 v[108:111], v[136:139], v[248:251], v[108:111]
  buffer_load_dwordx4 v[136:139], v16, s[40:43], s17 offen offset:0 sc1
  s_add_u32 m0, s15, 0
  s_nop 0
  buffer_load_dwordx4 v8, s[44:47], s16 offen offset:0  lds
  buffer_load_dwordx4 v9, s[44:47], s16 offen offset:1024  lds
  s_waitcnt vmcnt(30)
  v_mfma_f32_16x16x32_bf16 v[28:31], v[140:143], v[236:239], v[28:31]
  v_mfma_f32_16x16x32_bf16 v[56:59], v[140:143], v[240:243], v[56:59]
  v_mfma_f32_16x16x32_bf16 v[84:87], v[140:143], v[244:247], v[84:87]
  v_mfma_f32_16x16x32_bf16 v[112:115], v[140:143], v[248:251], v[112:115]
  buffer_load_dwordx4 v[140:143], v16, s[40:43], s17 offen offset:1024 sc1
  s_add_u32 m0, s15, 2048
  s_nop 0
  buffer_load_dwordx4 v10, s[44:47], s16 offen offset:0  lds
  s_waitcnt vmcnt(31)
  v_mfma_f32_16x16x32_bf16 v[32:35], v[144:147], v[236:239], v[32:35]
  v_mfma_f32_16x16x32_bf16 v[60:63], v[144:147], v[240:243], v[60:63]
  v_mfma_f32_16x16x32_bf16 v[88:91], v[144:147], v[244:247], v[88:91]
  v_mfma_f32_16x16x32_bf16 v[116:119], v[144:147], v[248:251], v[116:119]
  buffer_load_dwordx4 v[144:147], v16, s[40:43], s17 offen offset:2048 sc1
  buffer_load_dwordx4 v11, s[44:47], s16 offen offset:1024  lds
  s_waitcnt vmcnt(14)
  ds_read_b128 v[220:223], v18 offset:8192
  ds_read_b128 v[224:227], v18 offset:10240
  ds_read_b128 v[228:231], v18 offset:12288
  ds_read_b128 v[232:235], v18 offset:14336
  v_mfma_f32_16x16x32_bf16 v[36:39], v[148:151], v[236:239], v[36:39]
  v_mfma_f32_16x16x32_bf16 v[64:67], v[148:151], v[240:243], v[64:67]
  v_mfma_f32_16x16x32_bf16 v[92:95], v[148:151], v[244:247], v[92:95]
  v_mfma_f32_16x16x32_bf16 v[120:123], v[148:151], v[248:251], v[120:123]
  buffer_load_dwordx4 v[148:151], v16, s[40:43], s17 offen offset:3072 sc1
  s_add_u32 m0, s15, 4096
  s_nop 0
  buffer_load_dwordx4 v12, s[44:47], s16 offen offset:0  lds
  v_mfma_f32_16x16x32_bf16 v[40:43], v[152:155], v[236:239], v[40:43]
  v_mfma_f32_16x16x32_bf16 v[68:71], v[152:155], v[240:243], v[68:71]
  v_mfma_f32_16x16x32_bf16 v[96:99], v[152:155], v[244:247], v[96:99]
  v_mfma_f32_16x16x32_bf16 v[124:127], v[152:155], v[248:251], v[124:127]
  buffer_load_dwordx4 v[152:155], v17, s[40:43], s17 offen offset:0 sc1
  buffer_load_dwordx4 v13, s[44:47], s16 offen offset:1024  lds
  v_mfma_f32_16x16x32_bf16 v[44:47], v[156:159], v[236:239], v[44:47]
  v_mfma_f32_16x16x32_bf16 v[72:75], v[156:159], v[240:243], v[72:75]
  v_mfma_f32_16x16x32_bf16 v[100:103], v[156:159], v[244:247], v[100:103]
  v_mfma_f32_16x16x32_bf16 v[128:131], v[156:159], v[248:251], v[128:131]
  buffer_load_dwordx4 v[156:159], v17, s[40:43], s17 offen offset:1024 sc1
  s_add_u32 m0, s15, 6144
  s_nop 0
  buffer_load_dwordx4 v14, s[44:47], s16 offen offset:0  lds
  v_mfma_f32_16x16x32_bf16 v[48:51], v[160:163], v[236:239], v[48:51]
  v_mfma_f32_16x16x32_bf16 v[76:79], v[160:163], v[240:243], v[76:79]
  v_mfma_f32_16x16x32_bf16 v[104:107], v[160:163], v[244:247], v[104:107]
  v_mfma_f32_16x16x32_bf16 v[132:135], v[160:163], v[248:251], v[132:135]
  buffer_load_dwordx4 v[160:163], v17, s[40:43], s17 offen offset:2048 sc1
  buffer_load_dwordx4 v15, s[44:47], s16 offen offset:1024  lds
  s_waitcnt lgkmcnt(0)
  v_mfma_f32_16x16x32_bf16 v[24:27], v[164:167], v[220:223], v[24:27]
  v_mfma_f32_16x16x32_bf16 v[52:55], v[164:167], v[224:227], v[52:55]
  v_mfma_f32_16x16x32_bf16 v[80:83], v[164:167], v[228:231], v[80:83]
  v_mfma_f32_16x16x32_bf16 v[108:111], v[164:167], v[232:235], v[108:111]
  buffer_load_dwordx4 v[164:167], v16, s[40:43], s18 offen offset:0 sc1
  v_mfma_f32_16x16x32_bf16 v[28:31], v[168:171], v[220:223], v[28:31]
  v_mfma_f32_16x16x32_bf16 v[56:59], v[168:171], v[224:227], v[56:59]
  v_mfma_f32_16x16x32_bf16 v[84:87], v[168:171], v[228:231], v[84:87]
  v_mfma_f32_16x16x32_bf16 v[112:115], v[168:171], v[232:235], v[112:115]
  buffer_load_dwordx4 v[168:171], v16, s[40:43], s18 offen offset:1024 sc1
  v_mfma_f32_16x16x32_bf16 v[32:35], v[172:175], v[220:223], v[32:35]
  v_mfma_f32_16x16x32_bf16 v[60:63], v[172:175], v[224:227], v[60:63]
  v_mfma_f32_16x16x32_bf16 v[88:91], v[172:175], v[228:231], v[88:91]
  v_mfma_f32_16x16x32_bf16 v[116:119], v[172:175], v[232:235], v[116:119]
  buffer_load_dwordx4 v[172:175], v16, s[40:43], s18 offen offset:2048 sc1
  ds_read_b128 v[236:239], v19 offset:8192
  ds_read_b128 v[240:243], v19 offset:10240
  ds_read_b128 v[244:247], v19 offset:12288
  ds_read_b128 v[248:251], v19 offset:14336
  v_mfma_f32_16x16x32_bf16 v[36:39], v[176:179], v[220:223], v[36:39]
  v_mfma_f32_16x16x32_bf16 v[64:67], v[176:179], v[224:227], v[64:67]
  v_mfma_f32_16x16x32_bf16 v[92:95], v[176:179], v[228:231], v[92:95]
  v_mfma_f32_16x16x32_bf16 v[120:123], v[176:179], v[232:235], v[120:123]
  buffer_load_dwordx4 v[176:179], v16, s[40:43], s18 offen offset:3072 sc1
  v_mfma_f32_16x16x32_bf16 v[40:43], v[180:183], v[220:223], v[40:43]
  v_mfma_f32_16x16x32_bf16 v[68:71], v[180:183], v[224:227], v[68:71]
  v_mfma_f32_16x16x32_bf16 v[96:99], v[180:183], v[228:231], v[96:99]
  v_mfma_f32_16x16x32_bf16 v[124:127], v[180:183], v[232:235], v[124:127]
  buffer_load_dwordx4 v[180:183], v17, s[40:43], s18 offen offset:0 sc1
  v_mfma_f32_16x16x32_bf16 v[44:47], v[184:187], v[220:223], v[44:47]
  v_mfma_f32_16x16x32_bf16 v[72:75], v[184:187], v[224:227], v[72:75]
  v_mfma_f32_16x16x32_bf16 v[100:103], v[184:187], v[228:231], v[100:103]
  v_mfma_f32_16x16x32_bf16 v[128:131], v[184:187], v[232:235], v[128:131]
  buffer_load_dwordx4 v[184:187], v17, s[40:43], s18 offen offset:1024 sc1
  v_mfma_f32_16x16x32_bf16 v[48:51], v[188:191], v[220:223], v[48:51]
  v_mfma_f32_16x16x32_bf16 v[76:79], v[188:191], v[224:227], v[76:79]
  v_mfma_f32_16x16x32_bf16 v[104:107], v[188:191], v[228:231], v[104:107]
  v_mfma_f32_16x16x32_bf16 v[132:135], v[188:191], v[232:235], v[132:135]
  buffer_load_dwordx4 v[188:191], v17, s[40:43], s18 offen offset:2048 sc1
  s_waitcnt lgkmcnt(0)
  s_xor_b32 s17, s12, 7
  s_mul_i32 s17, s17, 114688
  s_add_u32 s17, s17, s14
  s_add_u32 s18, s17, 57344
  s_xor_b32 s16, s12, 7
  s_lshl_b32 s16, s16, 7
  s_add_u32 s16, s16, s13
  s_waitcnt vmcnt(28)
  v_mfma_f32_16x16x32_bf16 v[24:27], v[192:195], v[236:239], v[24:27]
  v_mfma_f32_16x16x32_bf16 v[52:55], v[192:195], v[240:243], v[52:55]
  v_mfma_f32_16x16x32_bf16 v[80:83], v[192:195], v[244:247], v[80:83]
  v_mfma_f32_16x16x32_bf16 v[108:111], v[192:195], v[248:251], v[108:111]
  buffer_load_dwordx4 v[192:195], v16, s[40:43], s17 offen offset:0 sc1
  s_add_u32 m0, s15, 8192
  s_nop 0
  buffer_load_dwordx4 v8, s[44:47], s16 offen offset:0  lds
  buffer_load_dwordx4 v9, s[44:47], s16 offen offset:1024  lds
  s_waitcnt vmcnt(30)
  v_mfma_f32_16x16x32_bf16 v[28:31], v[196:199], v[236:239], v[28:31]
  v_mfma_f32_16x16x32_bf16 v[56:59], v[196:199], v[240:243], v[56:59]
  v_mfma_f32_16x16x32_bf16 v[84:87], v[196:199], v[244:247], v[84:87]
  v_mfma_f32_16x16x32_bf16 v[112:115], v[196:199], v[248:251], v[112:115]
  buffer_load_dwordx4 v[196:199], v16, s[40:43], s17 offen offset:1024 sc1
  s_add_u32 m0, s15, 10240
  s_nop 0
  buffer_load_dwordx4 v10, s[44:47], s16 offen offset:0  lds
  s_waitcnt vmcnt(31)
  v_mfma_f32_16x16x32_bf16 v[32:35], v[200:203], v[236:239], v[32:35]
  v_mfma_f32_16x16x32_bf16 v[60:63], v[200:203], v[240:243], v[60:63]
  v_mfma_f32_16x16x32_bf16 v[88:91], v[200:203], v[244:247], v[88:91]
  v_mfma_f32_16x16x32_bf16 v[116:119], v[200:203], v[248:251], v[116:119]
  buffer_load_dwordx4 v[200:203], v16, s[40:43], s17 offen offset:2048 sc1
  buffer_load_dwordx4 v11, s[44:47], s16 offen offset:1024  lds
  s_waitcnt vmcnt(14)
  ds_read_b128 v[220:223], v18 offset:0
  ds_read_b128 v[224:227], v18 offset:2048
  ds_read_b128 v[228:231], v18 offset:4096
  ds_read_b128 v[232:235], v18 offset:6144
  v_mfma_f32_16x16x32_bf16 v[36:39], v[204:207], v[236:239], v[36:39]
  v_mfma_f32_16x16x32_bf16 v[64:67], v[204:207], v[240:243], v[64:67]
  v_mfma_f32_16x16x32_bf16 v[92:95], v[204:207], v[244:247], v[92:95]
  v_mfma_f32_16x16x32_bf16 v[120:123], v[204:207], v[248:251], v[120:123]
  buffer_load_dwordx4 v[204:207], v16, s[40:43], s17 offen offset:3072 sc1
  s_add_u32 m0, s15, 12288
  s_nop 0
  buffer_load_dwordx4 v12, s[44:47], s16 offen offset:0  lds
  v_mfma_f32_16x16x32_bf16 v[40:43], v[208:211], v[236:239], v[40:43]
  v_mfma_f32_16x16x32_bf16 v[68:71], v[208:211], v[240:243], v[68:71]
  v_mfma_f32_16x16x32_bf16 v[96:99], v[208:211], v[244:247], v[96:99]
  v_mfma_f32_16x16x32_bf16 v[124:127], v[208:211], v[248:251], v[124:127]
  buffer_load_dwordx4 v[208:211], v17, s[40:43], s17 offen offset:0 sc1
  buffer_load_dwordx4 v13, s[44:47], s16 offen offset:1024  lds
  v_mfma_f32_16x16x32_bf16 v[44:47], v[212:215], v[236:239], v[44:47]
  v_mfma_f32_16x16x32_bf16 v[72:75], v[212:215], v[240:243], v[72:75]
  v_mfma_f32_16x16x32_bf16 v[100:103], v[212:215], v[244:247], v[100:103]
  v_mfma_f32_16x16x32_bf16 v[128:131], v[212:215], v[248:251], v[128:131]
  buffer_load_dwordx4 v[212:215], v17, s[40:43], s17 offen offset:1024 sc1
  s_add_u32 m0, s15, 14336
  s_nop 0
  buffer_load_dwordx4 v14, s[44:47], s16 offen offset:0  lds
  v_mfma_f32_16x16x32_bf16 v[48:51], v[216:219], v[236:239], v[48:51]
  v_mfma_f32_16x16x32_bf16 v[76:79], v[216:219], v[240:243], v[76:79]
  v_mfma_f32_16x16x32_bf16 v[104:107], v[216:219], v[244:247], v[104:107]
  v_mfma_f32_16x16x32_bf16 v[132:135], v[216:219], v[248:251], v[132:135]
  buffer_load_dwordx4 v[216:219], v17, s[40:43], s17 offen offset:2048 sc1
  buffer_load_dwordx4 v15, s[44:47], s16 offen offset:1024  lds
  s_waitcnt lgkmcnt(0)
  buffer_load_dword v253, v252, s[40:43], 0 offen sc1
  v_mfma_f32_16x16x32_bf16 v[24:27], v[136:139], v[220:223], v[24:27]
  v_mfma_f32_16x16x32_bf16 v[52:55], v[136:139], v[224:227], v[52:55]
  v_mfma_f32_16x16x32_bf16 v[80:83], v[136:139], v[228:231], v[80:83]
  v_mfma_f32_16x16x32_bf16 v[108:111], v[136:139], v[232:235], v[108:111]
  buffer_load_dwordx4 v[136:139], v16, s[40:43], s18 offen offset:0 sc1
  v_mfma_f32_16x16x32_bf16 v[28:31], v[140:143], v[220:223], v[28:31]
  v_mfma_f32_16x16x32_bf16 v[56:59], v[140:143], v[224:227], v[56:59]
  v_mfma_f32_16x16x32_bf16 v[84:87], v[140:143], v[228:231], v[84:87]
  v_mfma_f32_16x16x32_bf16 v[112:115], v[140:143], v[232:235], v[112:115]
  buffer_load_dwordx4 v[140:143], v16, s[40:43], s18 offen offset:1024 sc1
  v_mfma_f32_16x16x32_bf16 v[32:35], v[144:147], v[220:223], v[32:35]
  v_mfma_f32_16x16x32_bf16 v[60:63], v[144:147], v[224:227], v[60:63]
  v_mfma_f32_16x16x32_bf16 v[88:91], v[144:147], v[228:231], v[88:91]
  v_mfma_f32_16x16x32_bf16 v[116:119], v[144:147], v[232:235], v[116:119]
  buffer_load_dwordx4 v[144:147], v16, s[40:43], s18 offen offset:2048 sc1
  ds_read_b128 v[236:239], v19 offset:0
  ds_read_b128 v[240:243], v19 offset:2048
  ds_read_b128 v[244:247], v19 offset:4096
  ds_read_b128 v[248:251], v19 offset:6144
  v_mfma_f32_16x16x32_bf16 v[36:39], v[148:151], v[220:223], v[36:39]
  v_mfma_f32_16x16x32_bf16 v[64:67], v[148:151], v[224:227], v[64:67]
  v_mfma_f32_16x16x32_bf16 v[92:95], v[148:151], v[228:231], v[92:95]
  v_mfma_f32_16x16x32_bf16 v[120:123], v[148:151], v[232:235], v[120:123]
  buffer_load_dwordx4 v[148:151], v16, s[40:43], s18 offen offset:3072 sc1
  v_mfma_f32_16x16x32_bf16 v[40:43], v[152:155], v[220:223], v[40:43]
  v_mfma_f32_16x16x32_bf16 v[68:71], v[152:155], v[224:227], v[68:71]
  v_mfma_f32_16x16x32_bf16 v[96:99], v[152:155], v[228:231], v[96:99]
  v_mfma_f32_16x16x32_bf16 v[124:127], v[152:155], v[232:235], v[124:127]
  buffer_load_dwordx4 v[152:155], v17, s[40:43], s18 offen offset:0 sc1
  v_mfma_f32_16x16x32_bf16 v[44:47], v[156:159], v[220:223], v[44:47]
  v_mfma_f32_16x16x32_bf16 v[72:75], v[156:159], v[224:227], v[72:75]
  v_mfma_f32_16x16x32_bf16 v[100:103], v[156:159], v[228:231], v[100:103]
  v_mfma_f32_16x16x32_bf16 v[128:131], v[156:159], v[232:235], v[128:131]
  buffer_load_dwordx4 v[156:159], v17, s[40:43], s18 offen offset:1024 sc1
  v_mfma_f32_16x16x32_bf16 v[48:51], v[160:163], v[220:223], v[48:51]
  v_mfma_f32_16x16x32_bf16 v[76:79], v[160:163], v[224:227], v[76:79]
  v_mfma_f32_16x16x32_bf16 v[104:107], v[160:163], v[228:231], v[104:107]
  v_mfma_f32_16x16x32_bf16 v[132:135], v[160:163], v[232:235], v[132:135]
  buffer_load_dwordx4 v[160:163], v17, s[40:43], s18 offen offset:2048 sc1
  s_waitcnt lgkmcnt(0)
  s_waitcnt vmcnt(29)
  v_mfma_f32_16x16x32_bf16 v[24:27], v[164:167], v[236:239], v[24:27]
  v_mfma_f32_16x16x32_bf16 v[52:55], v[164:167], v[240:243], v[52:55]
  v_mfma_f32_16x16x32_bf16 v[80:83], v[164:167], v[244:247], v[80:83]
  v_mfma_f32_16x16x32_bf16 v[108:111], v[164:167], v[248:251], v[108:111]
  s_waitcnt vmcnt(28)
  v_mfma_f32_16x16x32_bf16 v[28:31], v[168:171], v[236:239], v[28:31]
  v_mfma_f32_16x16x32_bf16 v[56:59], v[168:171], v[240:243], v[56:59]
  v_mfma_f32_16x16x32_bf16 v[84:87], v[168:171], v[244:247], v[84:87]
  v_mfma_f32_16x16x32_bf16 v[112:115], v[168:171], v[248:251], v[112:115]
  s_waitcnt vmcnt(27)
  v_mfma_f32_16x16x32_bf16 v[32:35], v[172:175], v[236:239], v[32:35]
  v_mfma_f32_16x16x32_bf16 v[60:63], v[172:175], v[240:243], v[60:63]
  v_mfma_f32_16x16x32_bf16 v[88:91], v[172:175], v[244:247], v[88:91]
  v_mfma_f32_16x16x32_bf16 v[116:119], v[172:175], v[248:251], v[116:119]
  s_waitcnt vmcnt(8)
  ds_read_b128 v[220:223], v18 offset:8192
  ds_read_b128 v[224:227], v18 offset:10240
  ds_read_b128 v[228:231], v18 offset:12288
  ds_read_b128 v[232:235], v18 offset:14336
  v_mfma_f32_16x16x32_bf16 v[36:39], v[176:179], v[236:239], v[36:39]
  v_mfma_f32_16x16x32_bf16 v[64:67], v[176:179], v[240:243], v[64:67]
  v_mfma_f32_16x16x32_bf16 v[92:95], v[176:179], v[244:247], v[92:95]
  v_mfma_f32_16x16x32_bf16 v[120:123], v[176:179], v[248:251], v[120:123]
  v_mfma_f32_16x16x32_bf16 v[40:43], v[180:183], v[236:239], v[40:43]
  v_mfma_f32_16x16x32_bf16 v[68:71], v[180:183], v[240:243], v[68:71]
  v_mfma_f32_16x16x32_bf16 v[96:99], v[180:183], v[244:247], v[96:99]
  v_mfma_f32_16x16x32_bf16 v[124:127], v[180:183], v[248:251], v[124:127]
  v_mfma_f32_16x16x32_bf16 v[44:47], v[184:187], v[236:239], v[44:47]
  v_mfma_f32_16x16x32_bf16 v[72:75], v[184:187], v[240:243], v[72:75]
  v_mfma_f32_16x16x32_bf16 v[100:103], v[184:187], v[244:247], v[100:103]
  v_mfma_f32_16x16x32_bf16 v[128:131], v[184:187], v[248:251], v[128:131]
  v_mfma_f32_16x16x32_bf16 v[48:51], v[188:191], v[236:239], v[48:51]
  v_mfma_f32_16x16x32_bf16 v[76:79], v[188:191], v[240:243], v[76:79]
  v_mfma_f32_16x16x32_bf16 v[104:107], v[188:191], v[244:247], v[104:107]
  v_mfma_f32_16x16x32_bf16 v[132:135], v[188:191], v[248:251], v[132:135]
  s_waitcnt lgkmcnt(0)
  s_waitcnt vmcnt(7)
  v_cmp_ne_u32 vcc, v253, v2
  s_cmp_eq_u64 vcc, 0
  s_cbranch_scc0 p2_z_s
p2_z_b:
  s_lshl_b32 s19, s10, 2
  s_add_u32 s19, s19, s4
  s_lshl_b32 s5, s19, 5
  s_mul_i32 s19, s19, 28
  s_mul_i32 s6, s11, 7
  s_lshr_b32 s6, s6, 1
  s_add_u32 s19, s19, s6
  s_lshl_b32 s19, s19, 10
  s_add_u32 s6, s19, 4194304
  buffer_load_dwordx4 v[164:167], v16, s[40:43], s6 offen offset:0 sc1
  buffer_load_dwordx4 v[168:171], v16, s[40:43], s6 offen offset:1024 sc1
  buffer_load_dwordx4 v[172:175], v16, s[40:43], s6 offen offset:2048 sc1
  buffer_load_dwordx4 v[176:179], v16, s[40:43], s6 offen offset:3072 sc1
  v_and_b32 v3, 15, v1
  v_lshlrev_b32 v3, 1, v3
  buffer_load_ushort v15, v3, s[48:51], s5 offen
  v_mfma_f32_16x16x32_bf16 v[24:27], v[192:195], v[220:223], v[24:27]
  v_mfma_f32_16x16x32_bf16 v[52:55], v[192:195], v[224:227], v[52:55]
  v_mfma_f32_16x16x32_bf16 v[80:83], v[192:195], v[228:231], v[80:83]
  v_mfma_f32_16x16x32_bf16 v[108:111], v[192:195], v[232:235], v[108:111]
  v_mfma_f32_16x16x32_bf16 v[28:31], v[196:199], v[220:223], v[28:31]
  v_mfma_f32_16x16x32_bf16 v[56:59], v[196:199], v[224:227], v[56:59]
  v_mfma_f32_16x16x32_bf16 v[84:87], v[196:199], v[228:231], v[84:87]
  v_mfma_f32_16x16x32_bf16 v[112:115], v[196:199], v[232:235], v[112:115]
  v_mfma_f32_16x16x32_bf16 v[32:35], v[200:203], v[220:223], v[32:35]
  v_mfma_f32_16x16x32_bf16 v[60:63], v[200:203], v[224:227], v[60:63]
  v_mfma_f32_16x16x32_bf16 v[88:91], v[200:203], v[228:231], v[88:91]
  v_mfma_f32_16x16x32_bf16 v[116:119], v[200:203], v[232:235], v[116:119]
  ds_read_b128 v[236:239], v19 offset:8192
  ds_read_b128 v[240:243], v19 offset:10240
  ds_read_b128 v[244:247], v19 offset:12288
  ds_read_b128 v[248:251], v19 offset:14336
  v_mfma_f32_16x16x32_bf16 v[36:39], v[204:207], v[220:223], v[36:39]
  v_mfma_f32_16x16x32_bf16 v[64:67], v[204:207], v[224:227], v[64:67]
  v_mfma_f32_16x16x32_bf16 v[92:95], v[204:207], v[228:231], v[92:95]
  v_mfma_f32_16x16x32_bf16 v[120:123], v[204:207], v[232:235], v[120:123]
  v_mfma_f32_16x16x32_bf16 v[40:43], v[208:211], v[220:223], v[40:43]
  v_mfma_f32_16x16x32_bf16 v[68:71], v[208:211], v[224:227], v[68:71]
  v_mfma_f32_16x16x32_bf16 v[96:99], v[208:211], v[228:231], v[96:99]
  v_mfma_f32_16x16x32_bf16 v[124:127], v[208:211], v[232:235], v[124:127]
  v_mfma_f32_16x16x32_bf16 v[44:47], v[212:215], v[220:223], v[44:47]
  v_mfma_f32_16x16x32_bf16 v[72:75], v[212:215], v[224:227], v[72:75]
  v_mfma_f32_16x16x32_bf16 v[100:103], v[212:215], v[228:231], v[100:103]
  v_mfma_f32_16x16x32_bf16 v[128:131], v[212:215], v[232:235], v[128:131]
  v_mfma_f32_16x16x32_bf16 v[48:51], v[216:219], v[220:223], v[48:51]
  v_mfma_f32_16x16x32_bf16 v[76:79], v[216:219], v[224:227], v[76:79]
  v_mfma_f32_16x16x32_bf16 v[104:107], v[216:219], v[228:231], v[104:107]
  v_mfma_f32_16x16x32_bf16 v[132:135], v[216:219], v[232:235], v[132:135]
  s_waitcnt lgkmcnt(0)
  v_add_u32 v8, s15, v16
  s_mul_i32 s5, s4, 5120
  s_add_u32 s5, s5, 141312
  v_add_u32 v9, s5, v16
  s_add_u32 s5, s4, 3
  s_and_b32 s5, s5, 3
  s_lshl_b32 s5, s5, 14
  v_add_u32 v10, s5, v16
  s_add_u32 s5, s4, 2
  s_and_b32 s5, s5, 3
  s_lshl_b32 s5, s5, 14
  v_add_u32 v11, s5, v16
  s_add_u32 s5, s4, 1
  s_and_b32 s5, s5, 3
  s_mul_i32 s6, s5, 5120
  s_add_u32 s6, s6, 141312
  v_add_u32 v13, s6, v16
  s_lshl_b32 s5, s5, 14
  v_add_u32 v12, s5, v16
  s_waitcnt vmcnt(11)
  v_mfma_f32_16x16x32_bf16 v[52:55], v[136:139], v[240:243], v[52:55]
  s_waitcnt vmcnt(10)
  v_mfma_f32_16x16x32_bf16 v[56:59], v[140:143], v[240:243], v[56:59]
  s_waitcnt vmcnt(9)
  v_mfma_f32_16x16x32_bf16 v[60:63], v[144:147], v[240:243], v[60:63]
  s_waitcnt vmcnt(8)
  v_mfma_f32_16x16x32_bf16 v[64:67], v[148:151], v[240:243], v[64:67]
  s_waitcnt vmcnt(7)
  v_mfma_f32_16x16x32_bf16 v[68:71], v[152:155], v[240:243], v[68:71]
  s_waitcnt vmcnt(6)
  v_mfma_f32_16x16x32_bf16 v[72:75], v[156:159], v[240:243], v[72:75]
  s_waitcnt vmcnt(5)
  v_mfma_f32_16x16x32_bf16 v[76:79], v[160:163], v[240:243], v[76:79]
  v_mfma_f32_16x16x32_bf16 v[80:83], v[136:139], v[244:247], v[80:83]
  ds_write_b128 v8, v[52:55] offset:0
  v_mfma_f32_16x16x32_bf16 v[84:87], v[140:143], v[244:247], v[84:87]
  ds_write_b128 v8, v[56:59] offset:1024
  v_mfma_f32_16x16x32_bf16 v[88:91], v[144:147], v[244:247], v[88:91]
  ds_write_b128 v8, v[60:63] offset:2048
  v_mfma_f32_16x16x32_bf16 v[92:95], v[148:151], v[244:247], v[92:95]
  ds_write_b128 v8, v[64:67] offset:3072
  v_mfma_f32_16x16x32_bf16 v[96:99], v[152:155], v[244:247], v[96:99]
  ds_write_b128 v8, v[68:71] offset:4096
  v_mfma_f32_16x16x32_bf16 v[100:103], v[156:159], v[244:247], v[100:103]
  ds_write_b128 v8, v[72:75] offset:5120
  v_mfma_f32_16x16x32_bf16 v[104:107], v[160:163], v[244:247], v[104:107]
  ds_write_b128 v8, v[76:79] offset:6144
  v_mfma_f32_16x16x32_bf16 v[108:111], v[136:139], v[248:251], v[108:111]
  ds_write_b128 v8, v[80:83] offset:7168
  v_mfma_f32_16x16x32_bf16 v[112:115], v[140:143], v[248:251], v[112:115]
  ds_write_b128 v8, v[84:87] offset:8192
  v_mfma_f32_16x16x32_bf16 v[116:119], v[144:147], v[248:251], v[116:119]
  ds_write_b128 v8, v[88:91] offset:9216
  v_mfma_f32_16x16x32_bf16 v[120:123], v[148:151], v[248:251], v[120:123]
  ds_write_b128 v8, v[92:95] offset:10240
  v_mfma_f32_16x16x32_bf16 v[124:127], v[152:155], v[248:251], v[124:127]
  ds_write_b128 v8, v[96:99] offset:11264
  v_mfma_f32_16x16x32_bf16 v[128:131], v[156:159], v[248:251], v[128:131]
  ds_write_b128 v8, v[100:103] offset:12288
  v_mfma_f32_16x16x32_bf16 v[132:135], v[160:163], v[248:251], v[132:135]
  ds_write_b128 v8, v[104:107] offset:13312
  v_mfma_f32_16x16x32_bf16 v[24:27], v[136:139], v[236:239], v[24:27]
  ds_write_b128 v8, v[108:111] offset:14336
  v_mfma_f32_16x16x32_bf16 v[28:31], v[140:143], v[236:239], v[28:31]
  ds_write_b128 v8, v[112:115] offset:15360
  v_mfma_f32_16x16x32_bf16 v[32:35], v[144:147], v[236:239], v[32:35]
  ds_write_b128 v9, v[116:119] offset:0
  v_mfma_f32_16x16x32_bf16 v[36:39], v[148:151], v[236:239], v[36:39]
  ds_write_b128 v9, v[120:123] offset:1024
  v_mfma_f32_16x16x32_bf16 v[40:43], v[152:155], v[236:239], v[40:43]
  ds_write_b128 v9, v[124:127] offset:2048
  v_mfma_f32_16x16x32_bf16 v[44:47], v[156:159], v[236:239], v[44:47]
  ds_write_b128 v9, v[128:131] offset:3072
  v_mfma_f32_16x16x32_bf16 v[48:51], v[160:163], v[236:239], v[48:51]
  ds_write_b128 v9, v[132:135] offset:4096
  s_waitcnt lgkmcnt(0)
  v_mov_b32 v3, 1
  ds_write_b32 v20, v3
  v_mov_b32 v20, 162576
p2_xw:
  ds_read_b128 v[220:223], v20
  s_waitcnt lgkmcnt(0)
  v_and_b32 v220, v220, v221
  v_and_b32 v222, v222, v223
  v_and_b32 v220, v220, v222
  s_nop 0
  v_readfirstlane_b32 s5, v220
  s_cmp_eq_u32 s5, 1
  s_cbranch_scc1 p2_xg
  s_add_u32 s53, s53, 1
  s_cmp_ge_u32 s53, 2097152
  s_cbranch_scc1 p2_xg
  s_branch p2_xw
p2_xg:
  ds_read_b128 v[192:195], v10 offset:0
  ds_read_b128 v[80:83], v11 offset:7168
  ds_read_b128 v[220:223], v12 offset:14336
  ds_read_b128 v[196:199], v10 offset:1024
  ds_read_b128 v[84:87], v11 offset:8192
  ds_read_b128 v[224:227], v12 offset:15360
  ds_read_b128 v[200:203], v10 offset:2048
  ds_read_b128 v[88:91], v11 offset:9216
  ds_read_b128 v[228:231], v13 offset:0
  ds_read_b128 v[204:207], v10 offset:3072
  ds_read_b128 v[92:95], v11 offset:10240
  ds_read_b128 v[232:235], v13 offset:1024
  ds_read_b128 v[208:211], v10 offset:4096
  ds_read_b128 v[96:99], v11 offset:11264
  ds_read_b128 v[236:239], v13 offset:2048
  ds_read_b128 v[212:215], v10 offset:5120
  ds_read_b128 v[100:103], v11 offset:12288
  ds_read_b128 v[240:243], v13 offset:3072
  ds_read_b128 v[216:219], v10 offset:6144
  ds_read_b128 v[104:107], v11 offset:13312
  ds_read_b128 v[244:247], v13 offset:4096
  s_waitcnt vmcnt(0)
  v_lshlrev_b32 v15, 16, v15
  s_add_u32 s19, s19, 8388608
  v_mov_b32 v14, v15
  s_and_b32 s5, s11, 1
  s_cmp_eq_u32 s5, 1
  s_cbranch_scc1 p2_odd
  s_waitcnt lgkmcnt(15)
  v_pk_add_f32 v[192:193], v[192:193], v[80:81]
  v_pk_add_f32 v[24:25], v[24:25], v[220:221]
  v_lshlrev_b32 v52, 16, v164
  v_and_b32 v53, 0xffff0000, v164
  v_pk_add_f32 v[194:195], v[194:195], v[82:83]
  v_pk_add_f32 v[26:27], v[26:27], v[222:223]
  v_lshlrev_b32 v56, 16, v165
  v_and_b32 v57, 0xffff0000, v165
  v_pk_add_f32 v[24:25], v[24:25], v[192:193]
  v_pk_add_f32 v[26:27], v[26:27], v[194:195]
  v_pk_add_f32 v[24:25], v[24:25], v[14:15]
  v_pk_add_f32 v[26:27], v[26:27], v[14:15]
  v_pk_mul_f32 v[24:25], v[24:25], v[52:53]
  v_pk_mul_f32 v[26:27], v[26:27], v[56:57]
  v_cvt_pk_bf16_f32 v60, v24, v25
  v_cvt_pk_bf16_f32 v61, v26, v27
  v_pk_add_f32 v[196:197], v[196:197], v[84:85]
  v_pk_add_f32 v[28:29], v[28:29], v[224:225]
  v_lshlrev_b32 v52, 16, v166
  v_and_b32 v53, 0xffff0000, v166
  v_pk_add_f32 v[198:199], v[198:199], v[86:87]
  v_pk_add_f32 v[30:31], v[30:31], v[226:227]
  v_lshlrev_b32 v56, 16, v167
  v_and_b32 v57, 0xffff0000, v167
  v_pk_add_f32 v[28:29], v[28:29], v[196:197]
  v_pk_add_f32 v[30:31], v[30:31], v[198:199]
  v_pk_add_f32 v[28:29], v[28:29], v[14:15]
  v_pk_add_f32 v[30:31], v[30:31], v[14:15]
  v_pk_mul_f32 v[28:29], v[28:29], v[52:53]
  v_pk_mul_f32 v[30:31], v[30:31], v[56:57]
  v_cvt_pk_bf16_f32 v62, v28, v29
  v_cvt_pk_bf16_f32 v63, v30, v31
  buffer_store_dwordx4 v[60:63], v16, s[40:43], s19 offen offset:0 sc1
  s_waitcnt lgkmcnt(12)
  v_pk_add_f32 v[200:201], v[200:201], v[88:89]
  v_pk_add_f32 v[32:33], v[32:33], v[228:229]
  v_lshlrev_b32 v52, 16, v168
  v_and_b32 v53, 0xffff0000, v168
  v_pk_add_f32 v[202:203], v[202:203], v[90:91]
  v_pk_add_f32 v[34:35], v[34:35], v[230:231]
  v_lshlrev_b32 v56, 16, v169
  v_and_b32 v57, 0xffff0000, v169
  v_pk_add_f32 v[32:33], v[32:33], v[200:201]
  v_pk_add_f32 v[34:35], v[34:35], v[202:203]
  v_pk_add_f32 v[32:33], v[32:33], v[14:15]
  v_pk_add_f32 v[34:35], v[34:35], v[14:15]
  v_pk_mul_f32 v[32:33], v[32:33], v[52:53]
  v_pk_mul_f32 v[34:35], v[34:35], v[56:57]
  v_cvt_pk_bf16_f32 v64, v32, v33
  v_cvt_pk_bf16_f32 v65, v34, v35
  s_waitcnt lgkmcnt(9)
  v_pk_add_f32 v[204:205], v[204:205], v[92:93]
  v_pk_add_f32 v[36:37], v[36:37], v[232:233]
  v_lshlrev_b32 v52, 16, v170
  v_and_b32 v53, 0xffff0000, v170
  v_pk_add_f32 v[206:207], v[206:207], v[94:95]
  v_pk_add_f32 v[38:39], v[38:39], v[234:235]
  v_lshlrev_b32 v56, 16, v171
  v_and_b32 v57, 0xffff0000, v171
  v_pk_add_f32 v[36:37], v[36:37], v[204:205]
  v_pk_add_f32 v[38:39], v[38:39], v[206:207]
  v_pk_add_f32 v[36:37], v[36:37], v[14:15]
  v_pk_add_f32 v[38:39], v[38:39], v[14:15]
  v_pk_mul_f32 v[36:37], v[36:37], v[52:53]
  v_pk_mul_f32 v[38:39], v[38:39], v[56:57]
  v_cvt_pk_bf16_f32 v66, v36, v37
  v_cvt_pk_bf16_f32 v67, v38, v39
  buffer_store_dwordx4 v[64:67], v16, s[40:43], s19 offen offset:1024 sc1
  s_waitcnt lgkmcnt(6)
  v_pk_add_f32 v[208:209], v[208:209], v[96:97]
  v_pk_add_f32 v[40:41], v[40:41], v[236:237]
  v_lshlrev_b32 v52, 16, v172
  v_and_b32 v53, 0xffff0000, v172
  v_pk_add_f32 v[210:211], v[210:211], v[98:99]
  v_pk_add_f32 v[42:43], v[42:43], v[238:239]
  v_lshlrev_b32 v56, 16, v173
  v_and_b32 v57, 0xffff0000, v173
  v_pk_add_f32 v[40:41], v[40:41], v[208:209]
  v_pk_add_f32 v[42:43], v[42:43], v[210:211]
  v_pk_add_f32 v[40:41], v[40:41], v[14:15]
  v_pk_add_f32 v[42:43], v[42:43], v[14:15]
  v_pk_mul_f32 v[40:41], v[40:41], v[52:53]
  v_pk_mul_f32 v[42:43], v[42:43], v[56:57]
  v_cvt_pk_bf16_f32 v68, v40, v41
  v_cvt_pk_bf16_f32 v69, v42, v43
  s_waitcnt lgkmcnt(3)
  v_pk_add_f32 v[212:213], v[212:213], v[100:101]
  v_pk_add_f32 v[44:45], v[44:45], v[240:241]
  v_lshlrev_b32 v52, 16, v174
  v_and_b32 v53, 0xffff0000, v174
  v_pk_add_f32 v[214:215], v[214:215], v[102:103]
  v_pk_add_f32 v[46:47], v[46:47], v[242:243]
  v_lshlrev_b32 v56, 16, v175
  v_and_b32 v57, 0xffff0000, v175
  v_pk_add_f32 v[44:45], v[44:45], v[212:213]
  v_pk_add_f32 v[46:47], v[46:47], v[214:215]
  v_pk_add_f32 v[44:45], v[44:45], v[14:15]
  v_pk_add_f32 v[46:47], v[46:47], v[14:15]
  v_pk_mul_f32 v[44:45], v[44:45], v[52:53]
  v_pk_mul_f32 v[46:47], v[46:47], v[56:57]
  v_cvt_pk_bf16_f32 v70, v44, v45
  v_cvt_pk_bf16_f32 v71, v46, v47
  buffer_store_dwordx4 v[68:71], v16, s[40:43], s19 offen offset:2048 sc1
  s_waitcnt lgkmcnt(0)
  v_pk_add_f32 v[216:217], v[216:217], v[104:105]
  v_pk_add_f32 v[48:49], v[48:49], v[244:245]
  v_lshlrev_b32 v52, 16, v176
  v_and_b32 v53, 0xffff0000, v176
  v_pk_add_f32 v[218:219], v[218:219], v[106:107]
  v_pk_add_f32 v[50:51], v[50:51], v[246:247]
  v_lshlrev_b32 v56, 16, v177
  v_and_b32 v57, 0xffff0000, v177
  v_pk_add_f32 v[48:49], v[48:49], v[216:217]
  v_pk_add_f32 v[50:51], v[50:51], v[218:219]
  v_pk_add_f32 v[48:49], v[48:49], v[14:15]
  v_pk_add_f32 v[50:51], v[50:51], v[14:15]
  v_pk_mul_f32 v[48:49], v[48:49], v[52:53]
  v_pk_mul_f32 v[50:51], v[50:51], v[56:57]
  v_cvt_pk_bf16_f32 v72, v48, v49
  v_cvt_pk_bf16_f32 v73, v50, v51
  buffer_store_dwordx2 v[72:73], v16, s[40:43], s19 offen offset:3072 sc1
  s_branch p3_begin
p2_odd:
  s_waitcnt lgkmcnt(15)
  v_pk_add_f32 v[192:193], v[192:193], v[80:81]
  v_pk_add_f32 v[24:25], v[24:25], v[220:221]
  v_lshlrev_b32 v52, 16, v166
  v_and_b32 v53, 0xffff0000, v166
  v_pk_add_f32 v[194:195], v[194:195], v[82:83]
  v_pk_add_f32 v[26:27], v[26:27], v[222:223]
  v_lshlrev_b32 v56, 16, v167
  v_and_b32 v57, 0xffff0000, v167
  v_pk_add_f32 v[24:25], v[24:25], v[192:193]
  v_pk_add_f32 v[26:27], v[26:27], v[194:195]
  v_pk_add_f32 v[24:25], v[24:25], v[14:15]
  v_pk_add_f32 v[26:27], v[26:27], v[14:15]
  v_pk_mul_f32 v[24:25], v[24:25], v[52:53]
  v_pk_mul_f32 v[26:27], v[26:27], v[56:57]
  v_cvt_pk_bf16_f32 v62, v24, v25
  v_cvt_pk_bf16_f32 v63, v26, v27
  buffer_store_dwordx2 v[62:63], v16, s[40:43], s19 offen offset:8 sc1
  v_pk_add_f32 v[196:197], v[196:197], v[84:85]
  v_pk_add_f32 v[28:29], v[28:29], v[224:225]
  v_lshlrev_b32 v52, 16, v168
  v_and_b32 v53, 0xffff0000, v168
  v_pk_add_f32 v[198:199], v[198:199], v[86:87]
  v_pk_add_f32 v[30:31], v[30:31], v[226:227]
  v_lshlrev_b32 v56, 16, v169
  v_and_b32 v57, 0xffff0000, v169
  v_pk_add_f32 v[28:29], v[28:29], v[196:197]
  v_pk_add_f32 v[30:31], v[30:31], v[198:199]
  v_pk_add_f32 v[28:29], v[28:29], v[14:15]
  v_pk_add_f32 v[30:31], v[30:31], v[14:15]
  v_pk_mul_f32 v[28:29], v[28:29], v[52:53]
  v_pk_mul_f32 v[30:31], v[30:31], v[56:57]
  v_cvt_pk_bf16_f32 v64, v28, v29
  v_cvt_pk_bf16_f32 v65, v30, v31
  s_waitcnt lgkmcnt(12)
  v_pk_add_f32 v[200:201], v[200:201], v[88:89]
  v_pk_add_f32 v[32:33], v[32:33], v[228:229]
  v_lshlrev_b32 v52, 16, v170
  v_and_b32 v53, 0xffff0000, v170
  v_pk_add_f32 v[202:203], v[202:203], v[90:91]
  v_pk_add_f32 v[34:35], v[34:35], v[230:231]
  v_lshlrev_b32 v56, 16, v171
  v_and_b32 v57, 0xffff0000, v171
  v_pk_add_f32 v[32:33], v[32:33], v[200:201]
  v_pk_add_f32 v[34:35], v[34:35], v[202:203]
  v_pk_add_f32 v[32:33], v[32:33], v[14:15]
  v_pk_add_f32 v[34:35], v[34:35], v[14:15]
  v_pk_mul_f32 v[32:33], v[32:33], v[52:53]
  v_pk_mul_f32 v[34:35], v[34:35], v[56:57]
  v_cvt_pk_bf16_f32 v66, v32, v33
  v_cvt_pk_bf16_f32 v67, v34, v35
  buffer_store_dwordx4 v[64:67], v16, s[40:43], s19 offen offset:1024 sc1
  s_waitcnt lgkmcnt(9)
  v_pk_add_f32 v[204:205], v[204:205], v[92:93]
  v_pk_add_f32 v[36:37], v[36:37], v[232:233]
  v_lshlrev_b32 v52, 16, v172
  v_and_b32 v53, 0xffff0000, v172
  v_pk_add_f32 v[206:207], v[206:207], v[94:95]
  v_pk_add_f32 v[38:39], v[38:39], v[234:235]
  v_lshlrev_b32 v56, 16, v173
  v_and_b32 v57, 0xffff0000, v173
  v_pk_add_f32 v[36:37], v[36:37], v[204:205]
  v_pk_add_f32 v[38:39], v[38:39], v[206:207]
  v_pk_add_f32 v[36:37], v[36:37], v[14:15]
  v_pk_add_f32 v[38:39], v[38:39], v[14:15]
  v_pk_mul_f32 v[36:37], v[36:37], v[52:53]
  v_pk_mul_f32 v[38:39], v[38:39], v[56:57]
  v_cvt_pk_bf16_f32 v68, v36, v37
  v_cvt_pk_bf16_f32 v69, v38, v39
  s_waitcnt lgkmcnt(6)
  v_pk_add_f32 v[208:209], v[208:209], v[96:97]
  v_pk_add_f32 v[40:41], v[40:41], v[236:237]
  v_lshlrev_b32 v52, 16, v174
  v_and_b32 v53, 0xffff0000, v174
  v_pk_add_f32 v[210:211], v[210:211], v[98:99]
  v_pk_add_f32 v[42:43], v[42:43], v[238:239]
  v_lshlrev_b32 v56, 16, v175
  v_and_b32 v57, 0xffff0000, v175
  v_pk_add_f32 v[40:41], v[40:41], v[208:209]
  v_pk_add_f32 v[42:43], v[42:43], v[210:211]
  v_pk_add_f32 v[40:41], v[40:41], v[14:15]
  v_pk_add_f32 v[42:43], v[42:43], v[14:15]
  v_pk_mul_f32 v[40:41], v[40:41], v[52:53]
  v_pk_mul_f32 v[42:43], v[42:43], v[56:57]
  v_cvt_pk_bf16_f32 v70, v40, v41
  v_cvt_pk_bf16_f32 v71, v42, v43
  buffer_store_dwordx4 v[68:71], v16, s[40:43], s19 offen offset:2048 sc1
  s_waitcnt lgkmcnt(3)
  v_pk_add_f32 v[212:213], v[212:213], v[100:101]
  v_pk_add_f32 v[44:45], v[44:45], v[240:241]
  v_lshlrev_b32 v52, 16, v176
  v_and_b32 v53, 0xffff0000, v176
  v_pk_add_f32 v[214:215], v[214:215], v[102:103]
  v_pk_add_f32 v[46:47], v[46:47], v[242:243]
  v_lshlrev_b32 v56, 16, v177
  v_and_b32 v57, 0xffff0000, v177
  v_pk_add_f32 v[44:45], v[44:45], v[212:213]
  v_pk_add_f32 v[46:47], v[46:47], v[214:215]
  v_pk_add_f32 v[44:45], v[44:45], v[14:15]
  v_pk_add_f32 v[46:47], v[46:47], v[14:15]
  v_pk_mul_f32 v[44:45], v[44:45], v[52:53]
  v_pk_mul_f32 v[46:47], v[46:47], v[56:57]
  v_cvt_pk_bf16_f32 v72, v44, v45
  v_cvt_pk_bf16_f32 v73, v46, v47
  s_waitcnt lgkmcnt(0)
  v_pk_add_f32 v[216:217], v[216:217], v[104:105]
  v_pk_add_f32 v[48:49], v[48:49], v[244:245]
  v_lshlrev_b32 v52, 16, v178
  v_and_b32 v53, 0xffff0000, v178
  v_pk_add_f32 v[218:219], v[218:219], v[106:107]
  v_pk_add_f32 v[50:51], v[50:51], v[246:247]
  v_lshlrev_b32 v56, 16, v179
  v_and_b32 v57, 0xffff0000, v179
  v_pk_add_f32 v[48:49], v[48:49], v[216:217]
  v_pk_add_f32 v[50:51], v[50:51], v[218:219]
  v_pk_add_f32 v[48:49], v[48:49], v[14:15]
  v_pk_add_f32 v[50:51], v[50:51], v[14:15]
  v_pk_mul_f32 v[48:49], v[48:49], v[52:53]
  v_pk_mul_f32 v[50:51], v[50:51], v[56:57]
  v_cvt_pk_bf16_f32 v74, v48, v49
  v_cvt_pk_bf16_f32 v75, v50, v51
  buffer_store_dwordx4 v[72:75], v16, s[40:43], s19 offen offset:3072 sc1
p3_begin:
  s_setprio 0
  s_mov_b32 s44, s30
  s_mov_b32 s45, s31
  s_mov_b32 s46, 917504
  s_mov_b32 s47, 0x20000
  s_mov_b32 s48, s34
  s_mov_b32 s49, s35
  s_mov_b32 s50, 2097152
  s_mov_b32 s51, 0x20000
  s_lshl_b32 s10, s54, 2
  s_and_b32 s6, s55, 3
  s_add_u32 s10, s10, s6
  s_lshr_b32 s11, s55, 2
  s_mul_i32 s12, s4, 28672
  s_mul_i32 s13, s4, 229376
  s_lshl_b32 s5, s11, 7
  s_add_u32 s13, s13, s5
  v_lshrrev_b32 v3, 3, v1
  v_lshrrev_b32 v4, 4, v1
  v_lshlrev_b32 v4, 1, v4
  v_and_b32 v5, 7, v1
  v_xor_b32 v5, v5, v4
  v_lshlrev_b32 v5, 4, v5
  v_lshl_add_u32 v7, v3, 10, v5
  v_add_u32 v8, 7168, v7
  v_add_u32 v9, 14336, v7
  v_add_u32 v10, 21504, v7
  v_lshl_add_u32 v13, v3, 12, v5
  v_add_u32 v14, 31744, v13
  s_waitcnt vmcnt(0)
  v_mov_b32 v3, 1
  v_mov_b32 v4, 162600
  s_mov_b64 exec, 1
  ds_add_rtn_u32 v5, v4, v3
  s_lshl_b32 s5, s2, 7
  s_add_u32 s5, s5, 17440768
  s_waitcnt lgkmcnt(0)
  v_readfirstlane_b32 s6, v5
  s_mov_b64 exec, -1
  s_cmp_eq_u32 s6, 3
  s_cselect_b32 s5, s5, 1073741824
  buffer_store_dword v2, off, s[40:43], s5 sc1
  s_barrier
  s_add_u32 m0, s12, 0
  s_nop 0
  buffer_load_dwordx4 v7, s[44:47], s13 offen offset:0 lds
  buffer_load_dwordx4 v8, s[44:47], s13 offen offset:1024 lds
  buffer_load_dwordx4 v9, s[44:47], s13 offen offset:2048 lds
  buffer_load_dwordx4 v10, s[44:47], s13 offen offset:3072 lds
  s_add_u32 m0, s12, 4096
  s_add_u32 s13, s13, 32768
  buffer_load_dwordx4 v7, s[44:47], s13 offen offset:0 lds
  buffer_load_dwordx4 v8, s[44:47], s13 offen offset:1024 lds
  buffer_load_dwordx4 v9, s[44:47], s13 offen offset:2048 lds
  buffer_load_dwordx4 v10, s[44:47], s13 offen offset:3072 lds
  s_add_u32 m0, s12, 8192
  s_add_u32 s13, s13, 32768
  buffer_load_dwordx4 v7, s[44:47], s13 offen offset:0 lds
  buffer_load_dwordx4 v8, s[44:47], s13 offen offset:1024 lds
  buffer_load_dwordx4 v9, s[44:47], s13 offen offset:2048 lds
  buffer_load_dwordx4 v10, s[44:47], s13 offen offset:3072 lds
  s_add_u32 m0, s12, 12288
  s_add_u32 s13, s13, 32768
  buffer_load_dwordx4 v7, s[44:47], s13 offen offset:0 lds
  buffer_load_dwordx4 v8, s[44:47], s13 offen offset:1024 lds
  buffer_load_dwordx4 v9, s[44:47], s13 offen offset:2048 lds
  buffer_load_dwordx4 v10, s[44:47], s13 offen offset:3072 lds
  s_add_u32 m0, s12, 16384
  s_add_u32 s13, s13, 32768
  buffer_load_dwordx4 v7, s[44:47], s13 offen offset:0 lds
  buffer_load_dwordx4 v8, s[44:47], s13 offen offset:1024 lds
  buffer_load_dwordx4 v9, s[44:47], s13 offen offset:2048 lds
  buffer_load_dwordx4 v10, s[44:47], s13 offen offset:3072 lds
  s_add_u32 m0, s12, 20480
  s_add_u32 s13, s13, 32768
  buffer_load_dwordx4 v7, s[44:47], s13 offen offset:0 lds
  buffer_load_dwordx4 v8, s[44:47], s13 offen offset:1024 lds
  buffer_load_dwordx4 v9, s[44:47], s13 offen offset:2048 lds
  buffer_load_dwordx4 v10, s[44:47], s13 offen offset:3072 lds
  s_add_u32 m0, s12, 24576
  s_add_u32 s13, s13, 32768
  buffer_load_dwordx4 v7, s[44:47], s13 offen offset:0 lds
  buffer_load_dwordx4 v8, s[44:47], s13 offen offset:1024 lds
  buffer_load_dwordx4 v9, s[44:47], s13 offen offset:2048 lds
  buffer_load_dwordx4 v10, s[44:47], s13 offen offset:3072 lds
  s_add_u32 s5, s4, 0
  s_and_b32 s5, s5, 3
  s_lshl_b32 s6, s10, 2
  s_add_u32 s5, s5, s6
  s_mul_i32 s5, s5, 28
  s_mul_i32 s6, s4, 7
  s_add_u32 s5, s5, s6
  s_lshl_b32 s5, s5, 10
  s_add_u32 s18, s5, 8388608
  s_add_u32 s5, s4, 1
  s_and_b32 s5, s5, 3
  s_lshl_b32 s6, s10, 2
  s_add_u32 s5, s5, s6
  s_mul_i32 s5, s5, 28
  s_mul_i32 s6, s4, 7
  s_add_u32 s5, s5, s6
  s_lshl_b32 s5, s5, 10
  s_add_u32 s19, s5, 8388608
  s_add_u32 s5, s4, 2
  s_and_b32 s5, s5, 3
  s_lshl_b32 s6, s10, 2
  s_add_u32 s5, s5, s6
  s_mul_i32 s5, s5, 28
  s_mul_i32 s6, s4, 7
  s_add_u32 s5, s5, s6
  s_lshl_b32 s5, s5, 10
  s_add_u32 s20, s5, 8388608
  s_add_u32 s5, s4, 3
  s_and_b32 s5, s5, 3
  s_lshl_b32 s6, s10, 2
  s_add_u32 s5, s5, s6
  s_mul_i32 s5, s5, 28
  s_mul_i32 s6, s4, 7
  s_add_u32 s5, s5, s6
  s_lshl_b32 s5, s5, 10
  s_add_u32 s21, s5, 8388608
  v_lshlrev_b32 v11, 4, v1
  v_add_u32 v12, 4096, v11
  s_lshl_b32 s5, s4, 11
  s_add_u32 s16, s5, 114688
  s_lshl_b32 s5, s11, 2
  s_add_u32 s5, s5, s4
  s_lshl_b32 s5, s5, 16
  s_lshl_b32 s6, s10, 7
  s_add_u32 s5, s5, s6
  s_add_u32 s14, s5, 14680064
  s_lshl_b32 s5, s10, 2
  s_add_u32 s5, s5, s4
  s_lshl_b32 s6, s5, 6
  s_add_u32 s15, s6, 16777216
  v_and_b32 v3, 15, v1
  v_lshlrev_b32 v25, 2, v3
  s_lshl_b32 s17, s5, 14
  s_lshl_b32 s5, s11, 7
  s_add_u32 s17, s17, s5
  v_lshlrev_b32 v24, 10, v3
  v_bfe_u32 v3, v1, 4, 1
  v_lshl_add_u32 v24, v3, 5, v24
  v_lshrrev_b32 v3, 5, v1
  v_lshl_add_u32 v24, v3, 4, v24
  v_lshrrev_b32 v3, 2, v1
  v_lshlrev_b32 v3, 7, v3
  v_bfe_u32 v4, v1, 3, 2
  v_lshl_add_u32 v3, v4, 5, v3
  v_and_b32 v4, 3, v1
  v_lshl_add_u32 v3, v4, 3, v3
  v_add_u32 v15, s12, v3
  v_xor_b32 v16, 32, v15
  v_xor_b32 v17, 64, v15
  v_xor_b32 v18, 96, v15
  s_lshl_b32 s5, s4, 5
  v_xor_b32 v3, s5, v3
  v_add_u32 v19, 114688, v3
  v_add_u32 v20, s12, v11
  s_add_u32 s5, s4, 3
  s_and_b32 s5, s5, 3
  s_mul_i32 s5, s5, 28672
  v_add_u32 v21, s5, v11
  s_add_u32 s5, s4, 2
  s_and_b32 s5, s5, 3
  s_mul_i32 s5, s5, 28672
  v_add_u32 v22, s5, v11
  s_add_u32 s5, s4, 1
  s_and_b32 s5, s5, 3
  s_mul_i32 s5, s5, 28672
  v_add_u32 v23, s5, v11
  v_and_b32 v3, 1, v1
  s_lshl_b32 s5, s4, 1
  v_add_u32 v3, s5, v3
  v_lshrrev_b32 v4, 2, v3
  v_and_b32 v3, 3, v3
  v_lshlrev_b32 v3, 6, v3
  v_add_u32 v3, v3, v4
  s_and_b32 s5, s10, 7
  s_lshl_b32 s5, s5, 3
  s_lshr_b32 s6, s10, 3
  s_lshl_b32 s6, s6, 1
  s_add_u32 s5, s5, s6
  v_add_u32 v3, s5, v3
  v_lshlrev_b32 v144, 7, v3
  v_add_u32 v144, 17440768, v144
  s_lshl_b32 s5, s11, 5
  v_add_u32 v3, s5, v1
  v_subrev_u32 v4, 32, v1
  v_min_u32 v4, 6, v4
  s_and_b32 s5, s10, 3
  s_mul_i32 s5, s5, 7
  v_add_u32 v4, s5, v4
  v_lshlrev_b32 v4, 3, v4
  s_lshr_b32 s5, s10, 2
  v_add_u32 v4, s5, v4
  v_cmp_gt_u32 vcc, 32, v1
  s_nop 1
  v_cndmask_b32 v3, v4, v3, vcc
  v_lshlrev_b32 v3, 7, v3
  v_add_u32 v145, 17473536, v3
p3_s_w:
  buffer_load_dword v148, v144, s[40:43], 0 offen sc1
  buffer_load_dword v149, v145, s[40:43], 0 offen sc1
  s_waitcnt vmcnt(0)
  v_xor_b32 v148, v148, v2
  v_xor_b32 v149, v149, v2
  v_or_b32 v148, v148, v149
  v_cmp_ne_u32 vcc, 0, v148
  s_cmp_eq_u64 vcc, 0
  s_cbranch_scc1 p3_s_g
  s_add_u32 s53, s53, 1
  s_cmp_ge_u32 s53, 131072
  s_cbranch_scc1 p3_s_g
  s_sleep 2
  s_branch p3_s_w
p3_s_g:
  buffer_load_dwordx4 v[36:39], v11, s[40:43], s19 offen offset:0 sc1
  buffer_load_dwordx4 v[40:43], v11, s[40:43], s20 offen offset:0 sc1
  buffer_load_dwordx4 v[44:47], v11, s[40:43], s21 offen offset:0 sc1
  buffer_load_dwordx4 v[32:35], v11, s[40:43], s18 offen offset:0 sc1
  buffer_load_dwordx4 v[52:55], v11, s[40:43], s19 offen offset:1024 sc1
  buffer_load_dwordx4 v[56:59], v11, s[40:43], s20 offen offset:1024 sc1
  buffer_load_dwordx4 v[60:63], v11, s[40:43], s21 offen offset:1024 sc1
  buffer_load_dwordx4 v[48:51], v11, s[40:43], s18 offen offset:1024 sc1
  buffer_load_dwordx4 v[68:71], v11, s[40:43], s19 offen offset:2048 sc1
  buffer_load_dwordx4 v[72:75], v11, s[40:43], s20 offen offset:2048 sc1
  buffer_load_dwordx4 v[76:79], v11, s[40:43], s21 offen offset:2048 sc1
  buffer_load_dwordx4 v[64:67], v11, s[40:43], s18 offen offset:2048 sc1
  ds_read_b64_tr_b16 v[208:209], v15 offset:0
  ds_read_b64_tr_b16 v[210:211], v15 offset:2048
  ds_read_b64_tr_b16 v[212:213], v16 offset:0
  ds_read_b64_tr_b16 v[214:215], v16 offset:2048
  ds_read_b64_tr_b16 v[216:217], v17 offset:0
  ds_read_b64_tr_b16 v[218:219], v17 offset:2048
  ds_read_b64_tr_b16 v[220:221], v18 offset:0
  ds_read_b64_tr_b16 v[222:223], v18 offset:2048
  s_waitcnt lgkmcnt(0)
  s_waitcnt vmcnt(11)
  v_mfma_f32_16x16x32_bf16 v[160:163], v[208:211], v[36:39], 0
  v_mfma_f32_16x16x32_bf16 v[164:167], v[212:215], v[36:39], 0
  v_mfma_f32_16x16x32_bf16 v[168:171], v[216:219], v[36:39], 0
  v_mfma_f32_16x16x32_bf16 v[172:175], v[220:223], v[36:39], 0
  buffer_load_dwordx4 v[84:87], v11, s[40:43], s19 offen offset:3072 sc1
  s_waitcnt vmcnt(11)
  v_mfma_f32_16x16x32_bf16 v[176:179], v[208:211], v[40:43], 0
  v_mfma_f32_16x16x32_bf16 v[180:183], v[212:215], v[40:43], 0
  v_mfma_f32_16x16x32_bf16 v[184:187], v[216:219], v[40:43], 0
  v_mfma_f32_16x16x32_bf16 v[188:191], v[220:223], v[40:43], 0
  buffer_load_dwordx4 v[88:91], v11, s[40:43], s20 offen offset:3072 sc1
  ds_read_b64_tr_b16 v[224:225], v15 offset:4096
  ds_read_b64_tr_b16 v[226:227], v15 offset:6144
  ds_read_b64_tr_b16 v[228:229], v16 offset:4096
  ds_read_b64_tr_b16 v[230:231], v16 offset:6144
  ds_read_b64_tr_b16 v[232:233], v17 offset:4096
  ds_read_b64_tr_b16 v[234:235], v17 offset:6144
  ds_read_b64_tr_b16 v[236:237], v18 offset:4096
  ds_read_b64_tr_b16 v[238:239], v18 offset:6144
  s_waitcnt vmcnt(11)
  v_mfma_f32_16x16x32_bf16 v[192:195], v[208:211], v[44:47], 0
  v_mfma_f32_16x16x32_bf16 v[196:199], v[212:215], v[44:47], 0
  v_mfma_f32_16x16x32_bf16 v[200:203], v[216:219], v[44:47], 0
  v_mfma_f32_16x16x32_bf16 v[204:207], v[220:223], v[44:47], 0
  buffer_load_dwordx4 v[92:95], v11, s[40:43], s21 offen offset:3072 sc1
  s_waitcnt vmcnt(11)
  v_mfma_f32_16x16x32_bf16 v[144:147], v[208:211], v[32:35], 0
  v_mfma_f32_16x16x32_bf16 v[148:151], v[212:215], v[32:35], 0
  v_mfma_f32_16x16x32_bf16 v[152:155], v[216:219], v[32:35], 0
  v_mfma_f32_16x16x32_bf16 v[156:159], v[220:223], v[32:35], 0
  buffer_load_dwordx4 v[80:83], v11, s[40:43], s18 offen offset:3072 sc1
  s_waitcnt lgkmcnt(0)
  s_waitcnt vmcnt(11)
  v_mfma_f32_16x16x32_bf16 v[160:163], v[224:227], v[52:55], v[160:163]
  v_mfma_f32_16x16x32_bf16 v[164:167], v[228:231], v[52:55], v[164:167]
  v_mfma_f32_16x16x32_bf16 v[168:171], v[232:235], v[52:55], v[168:171]
  v_mfma_f32_16x16x32_bf16 v[172:175], v[236:239], v[52:55], v[172:175]
  buffer_load_dwordx4 v[100:103], v12, s[40:43], s19 offen offset:0 sc1
  s_waitcnt vmcnt(11)
  v_mfma_f32_16x16x32_bf16 v[176:179], v[224:227], v[56:59], v[176:179]
  v_mfma_f32_16x16x32_bf16 v[180:183], v[228:231], v[56:59], v[180:183]
  v_mfma_f32_16x16x32_bf16 v[184:187], v[232:235], v[56:59], v[184:187]
  v_mfma_f32_16x16x32_bf16 v[188:191], v[236:239], v[56:59], v[188:191]
  buffer_load_dwordx4 v[104:107], v12, s[40:43], s20 offen offset:0 sc1
  ds_read_b64_tr_b16 v[208:209], v15 offset:8192
  ds_read_b64_tr_b16 v[210:211], v15 offset:10240
  ds_read_b64_tr_b16 v[212:213], v16 offset:8192
  ds_read_b64_tr_b16 v[214:215], v16 offset:10240
  ds_read_b64_tr_b16 v[216:217], v17 offset:8192
  ds_read_b64_tr_b16 v[218:219], v17 offset:10240
  ds_read_b64_tr_b16 v[220:221], v18 offset:8192
  ds_read_b64_tr_b16 v[222:223], v18 offset:10240
  s_waitcnt vmcnt(11)
  v_mfma_f32_16x16x32_bf16 v[192:195], v[224:227], v[60:63], v[192:195]
  v_mfma_f32_16x16x32_bf16 v[196:199], v[228:231], v[60:63], v[196:199]
  v_mfma_f32_16x16x32_bf16 v[200:203], v[232:235], v[60:63], v[200:203]
  v_mfma_f32_16x16x32_bf16 v[204:207], v[236:239], v[60:63], v[204:207]
  buffer_load_dwordx4 v[108:111], v12, s[40:43], s21 offen offset:0 sc1
  s_waitcnt vmcnt(11)
  v_mfma_f32_16x16x32_bf16 v[144:147], v[224:227], v[48:51], v[144:147]
  v_mfma_f32_16x16x32_bf16 v[148:151], v[228:231], v[48:51], v[148:151]
  v_mfma_f32_16x16x32_bf16 v[152:155], v[232:235], v[48:51], v[152:155]
  v_mfma_f32_16x16x32_bf16 v[156:159], v[236:239], v[48:51], v[156:159]
  buffer_load_dwordx4 v[96:99], v12, s[40:43], s18 offen offset:0 sc1
  s_waitcnt lgkmcnt(0)
  s_waitcnt vmcnt(11)
  v_mfma_f32_16x16x32_bf16 v[160:163], v[208:211], v[68:71], v[160:163]
  v_mfma_f32_16x16x32_bf16 v[164:167], v[212:215], v[68:71], v[164:167]
  v_mfma_f32_16x16x32_bf16 v[168:171], v[216:219], v[68:71], v[168:171]
  v_mfma_f32_16x16x32_bf16 v[172:175], v[220:223], v[68:71], v[172:175]
  buffer_load_dwordx4 v[116:119], v12, s[40:43], s19 offen offset:1024 sc1
  s_waitcnt vmcnt(11)
  v_mfma_f32_16x16x32_bf16 v[176:179], v[208:211], v[72:75], v[176:179]
  v_mfma_f32_16x16x32_bf16 v[180:183], v[212:215], v[72:75], v[180:183]
  v_mfma_f32_16x16x32_bf16 v[184:187], v[216:219], v[72:75], v[184:187]
  v_mfma_f32_16x16x32_bf16 v[188:191], v[220:223], v[72:75], v[188:191]
  buffer_load_dwordx4 v[120:123], v12, s[40:43], s20 offen offset:1024 sc1
  ds_read_b64_tr_b16 v[224:225], v15 offset:12288
  ds_read_b64_tr_b16 v[226:227], v15 offset:14336
  ds_read_b64_tr_b16 v[228:229], v16 offset:12288
  ds_read_b64_tr_b16 v[230:231], v16 offset:14336
  ds_read_b64_tr_b16 v[232:233], v17 offset:12288
  ds_read_b64_tr_b16 v[234:235], v17 offset:14336
  ds_read_b64_tr_b16 v[236:237], v18 offset:12288
  ds_read_b64_tr_b16 v[238:239], v18 offset:14336
  s_waitcnt vmcnt(11)
  v_mfma_f32_16x16x32_bf16 v[192:195], v[208:211], v[76:79], v[192:195]
  v_mfma_f32_16x16x32_bf16 v[196:199], v[212:215], v[76:79], v[196:199]
  v_mfma_f32_16x16x32_bf16 v[200:203], v[216:219], v[76:79], v[200:203]
  v_mfma_f32_16x16x32_bf16 v[204:207], v[220:223], v[76:79], v[204:207]
  buffer_load_dwordx4 v[124:127], v12, s[40:43], s21 offen offset:1024 sc1
  s_waitcnt vmcnt(11)
  v_mfma_f32_16x16x32_bf16 v[144:147], v[208:211], v[64:67], v[144:147]
  v_mfma_f32_16x16x32_bf16 v[148:151], v[212:215], v[64:67], v[148:151]
  v_mfma_f32_16x16x32_bf16 v[152:155], v[216:219], v[64:67], v[152:155]
  v_mfma_f32_16x16x32_bf16 v[156:159], v[220:223], v[64:67], v[156:159]
  buffer_load_dwordx4 v[112:115], v12, s[40:43], s18 offen offset:1024 sc1
  s_waitcnt lgkmcnt(0)
  s_waitcnt vmcnt(11)
  v_mfma_f32_16x16x32_bf16 v[160:163], v[224:227], v[84:87], v[160:163]
  v_mfma_f32_16x16x32_bf16 v[164:167], v[228:231], v[84:87], v[164:167]
  v_mfma_f32_16x16x32_bf16 v[168:171], v[232:235], v[84:87], v[168:171]
  v_mfma_f32_16x16x32_bf16 v[172:175], v[236:239], v[84:87], v[172:175]
  buffer_load_dwordx4 v[132:135], v12, s[40:43], s19 offen offset:2048 sc1
  s_waitcnt vmcnt(11)
  v_mfma_f32_16x16x32_bf16 v[176:179], v[224:227], v[88:91], v[176:179]
  v_mfma_f32_16x16x32_bf16 v[180:183], v[228:231], v[88:91], v[180:183]
  v_mfma_f32_16x16x32_bf16 v[184:187], v[232:235], v[88:91], v[184:187]
  v_mfma_f32_16x16x32_bf16 v[188:191], v[236:239], v[88:91], v[188:191]
  buffer_load_dwordx4 v[136:139], v12, s[40:43], s20 offen offset:2048 sc1
  ds_read_b64_tr_b16 v[208:209], v15 offset:16384
  ds_read_b64_tr_b16 v[210:211], v15 offset:18432
  ds_read_b64_tr_b16 v[212:213], v16 offset:16384
  ds_read_b64_tr_b16 v[214:215], v16 offset:18432
  ds_read_b64_tr_b16 v[216:217], v17 offset:16384
  ds_read_b64_tr_b16 v[218:219], v17 offset:18432
  ds_read_b64_tr_b16 v[220:221], v18 offset:16384
  ds_read_b64_tr_b16 v[222:223], v18 offset:18432
  s_waitcnt vmcnt(11)
  v_mfma_f32_16x16x32_bf16 v[192:195], v[224:227], v[92:95], v[192:195]
  v_mfma_f32_16x16x32_bf16 v[196:199], v[228:231], v[92:95], v[196:199]
  v_mfma_f32_16x16x32_bf16 v[200:203], v[232:235], v[92:95], v[200:203]
  v_mfma_f32_16x16x32_bf16 v[204:207], v[236:239], v[92:95], v[204:207]
  buffer_load_dwordx4 v[140:143], v12, s[40:43], s21 offen offset:2048 sc1
  s_waitcnt vmcnt(11)
  v_mfma_f32_16x16x32_bf16 v[144:147], v[224:227], v[80:83], v[144:147]
  v_mfma_f32_16x16x32_bf16 v[148:151], v[228:231], v[80:83], v[148:151]
  v_mfma_f32_16x16x32_bf16 v[152:155], v[232:235], v[80:83], v[152:155]
  v_mfma_f32_16x16x32_bf16 v[156:159], v[236:239], v[80:83], v[156:159]
  buffer_load_dwordx4 v[128:131], v12, s[40:43], s18 offen offset:2048 sc1
  s_waitcnt lgkmcnt(0)
  s_waitcnt vmcnt(11)
  v_mfma_f32_16x16x32_bf16 v[160:163], v[208:211], v[100:103], v[160:163]
  v_mfma_f32_16x16x32_bf16 v[164:167], v[212:215], v[100:103], v[164:167]
  v_mfma_f32_16x16x32_bf16 v[168:171], v[216:219], v[100:103], v[168:171]
  v_mfma_f32_16x16x32_bf16 v[172:175], v[220:223], v[100:103], v[172:175]
  s_mov_b32 m0, s16
  s_nop 0
  buffer_load_dwordx4 v13, s[40:43], s14 offen sc1 lds
  s_waitcnt vmcnt(11)
  v_mfma_f32_16x16x32_bf16 v[176:179], v[208:211], v[104:107], v[176:179]
  v_mfma_f32_16x16x32_bf16 v[180:183], v[212:215], v[104:107], v[180:183]
  v_mfma_f32_16x16x32_bf16 v[184:187], v[216:219], v[104:107], v[184:187]
  v_mfma_f32_16x16x32_bf16 v[188:191], v[220:223], v[104:107], v[188:191]
  buffer_load_dwordx4 v14, s[40:43], s14 offen offset:1024 sc1 lds
  ds_read_b64_tr_b16 v[224:225], v15 offset:20480
  ds_read_b64_tr_b16 v[226:227], v15 offset:22528
  ds_read_b64_tr_b16 v[228:229], v16 offset:20480
  ds_read_b64_tr_b16 v[230:231], v16 offset:22528
  ds_read_b64_tr_b16 v[232:233], v17 offset:20480
  ds_read_b64_tr_b16 v[234:235], v17 offset:22528
  ds_read_b64_tr_b16 v[236:237], v18 offset:20480
  ds_read_b64_tr_b16 v[238:239], v18 offset:22528
  s_waitcnt vmcnt(11)
  v_mfma_f32_16x16x32_bf16 v[192:195], v[208:211], v[108:111], v[192:195]
  v_mfma_f32_16x16x32_bf16 v[196:199], v[212:215], v[108:111], v[196:199]
  v_mfma_f32_16x16x32_bf16 v[200:203], v[216:219], v[108:111], v[200:203]
  v_mfma_f32_16x16x32_bf16 v[204:207], v[220:223], v[108:111], v[204:207]
  buffer_load_dword v26, v25, s[40:43], s15 offen sc1
  s_waitcnt vmcnt(11)
  v_mfma_f32_16x16x32_bf16 v[144:147], v[208:211], v[96:99], v[144:147]
  v_mfma_f32_16x16x32_bf16 v[148:151], v[212:215], v[96:99], v[148:151]
  v_mfma_f32_16x16x32_bf16 v[152:155], v[216:219], v[96:99], v[152:155]
  v_mfma_f32_16x16x32_bf16 v[156:159], v[220:223], v[96:99], v[156:159]
  s_waitcnt lgkmcnt(0)
  s_waitcnt vmcnt(10)
  v_mfma_f32_16x16x32_bf16 v[160:163], v[224:227], v[116:119], v[160:163]
  v_mfma_f32_16x16x32_bf16 v[164:167], v[228:231], v[116:119], v[164:167]
  v_mfma_f32_16x16x32_bf16 v[168:171], v[232:235], v[116:119], v[168:171]
  v_mfma_f32_16x16x32_bf16 v[172:175], v[236:239], v[116:119], v[172:175]
  s_waitcnt vmcnt(9)
  v_mfma_f32_16x16x32_bf16 v[176:179], v[224:227], v[120:123], v[176:179]
  v_mfma_f32_16x16x32_bf16 v[180:183], v[228:231], v[120:123], v[180:183]
  v_mfma_f32_16x16x32_bf16 v[184:187], v[232:235], v[120:123], v[184:187]
  v_mfma_f32_16x16x32_bf16 v[188:191], v[236:239], v[120:123], v[188:191]
  ds_read_b64_tr_b16 v[208:209], v15 offset:24576
  ds_read_b64_tr_b16 v[210:211], v15 offset:26624
  ds_read_b64_tr_b16 v[212:213], v16 offset:24576
  ds_read_b64_tr_b16 v[214:215], v16 offset:26624
  ds_read_b64_tr_b16 v[216:217], v17 offset:24576
  ds_read_b64_tr_b16 v[218:219], v17 offset:26624
  ds_read_b64_tr_b16 v[220:221], v18 offset:24576
  ds_read_b64_tr_b16 v[222:223], v18 offset:26624
  s_waitcnt vmcnt(8)
  v_mfma_f32_16x16x32_bf16 v[192:195], v[224:227], v[124:127], v[192:195]
  v_mfma_f32_16x16x32_bf16 v[196:199], v[228:231], v[124:127], v[196:199]
  v_mfma_f32_16x16x32_bf16 v[200:203], v[232:235], v[124:127], v[200:203]
  v_mfma_f32_16x16x32_bf16 v[204:207], v[236:239], v[124:127], v[204:207]
  s_waitcnt vmcnt(7)
  v_mfma_f32_16x16x32_bf16 v[144:147], v[224:227], v[112:115], v[144:147]
  v_mfma_f32_16x16x32_bf16 v[148:151], v[228:231], v[112:115], v[148:151]
  v_mfma_f32_16x16x32_bf16 v[152:155], v[232:235], v[112:115], v[152:155]
  v_mfma_f32_16x16x32_bf16 v[156:159], v[236:239], v[112:115], v[156:159]
  s_waitcnt lgkmcnt(0)
  s_waitcnt vmcnt(6)
  v_mfma_f32_16x16x32_bf16 v[160:163], v[208:211], v[132:135], v[160:163]
  v_mfma_f32_16x16x32_bf16 v[164:167], v[212:215], v[132:135], v[164:167]
  v_mfma_f32_16x16x32_bf16 v[168:171], v[216:219], v[132:135], v[168:171]
  v_mfma_f32_16x16x32_bf16 v[172:175], v[220:223], v[132:135], v[172:175]
  s_waitcnt vmcnt(5)
  v_mfma_f32_16x16x32_bf16 v[176:179], v[208:211], v[136:139], v[176:179]
  s_nop 2
  ds_write_b128 v20, v[160:163] offset:0
  v_mfma_f32_16x16x32_bf16 v[180:183], v[212:215], v[136:139], v[180:183]
  ds_write_b128 v20, v[164:167] offset:1024
  v_mfma_f32_16x16x32_bf16 v[184:187], v[216:219], v[136:139], v[184:187]
  ds_write_b128 v20, v[168:171] offset:2048
  v_mfma_f32_16x16x32_bf16 v[188:191], v[220:223], v[136:139], v[188:191]
  ds_write_b128 v20, v[172:175] offset:3072
  s_waitcnt vmcnt(4)
  v_mfma_f32_16x16x32_bf16 v[192:195], v[208:211], v[140:143], v[192:195]
  ds_write_b128 v20, v[176:179] offset:4096
  v_mfma_f32_16x16x32_bf16 v[196:199], v[212:215], v[140:143], v[196:199]
  ds_write_b128 v20, v[180:183] offset:5120
  v_mfma_f32_16x16x32_bf16 v[200:203], v[216:219], v[140:143], v[200:203]
  ds_write_b128 v20, v[184:187] offset:6144
  v_mfma_f32_16x16x32_bf16 v[204:207], v[220:223], v[140:143], v[204:207]
  ds_write_b128 v20, v[188:191] offset:7168
  s_waitcnt vmcnt(3)
  v_mfma_f32_16x16x32_bf16 v[144:147], v[208:211], v[128:131], v[144:147]
  ds_write_b128 v20, v[192:195] offset:8192
  v_mfma_f32_16x16x32_bf16 v[148:151], v[212:215], v[128:131], v[148:151]
  ds_write_b128 v20, v[196:199] offset:9216
  v_mfma_f32_16x16x32_bf16 v[152:155], v[216:219], v[128:131], v[152:155]
  ds_write_b128 v20, v[200:203] offset:10240
  v_mfma_f32_16x16x32_bf16 v[156:159], v[220:223], v[128:131], v[156:159]
  ds_write_b128 v20, v[204:207] offset:11264
  s_waitcnt vmcnt(0) lgkmcnt(0)
  s_barrier
  ds_read_b128 v[32:35], v21 offset:0
  ds_read_b128 v[48:51], v22 offset:4096
  ds_read_b128 v[64:67], v23 offset:8192
  ds_read_b64_tr_b16 v[80:81], v19 offset:0
  ds_read_b128 v[36:39], v21 offset:1024
  ds_read_b128 v[52:55], v22 offset:5120
  ds_read_b128 v[68:71], v23 offset:9216
  ds_read_b64_tr_b16 v[82:83], v19 offset:2048
  ds_read_b128 v[40:43], v21 offset:2048
  ds_read_b128 v[56:59], v22 offset:6144
  ds_read_b128 v[72:75], v23 offset:10240
  ds_read_b64_tr_b16 v[84:85], v19 offset:4096
  ds_read_b128 v[44:47], v21 offset:3072
  ds_read_b128 v[60:63], v22 offset:7168
  ds_read_b128 v[76:79], v23 offset:11264
  ds_read_b64_tr_b16 v[86:87], v19 offset:6144
  v_mov_b32 v28, v26
  v_mov_b32 v29, v26
  v_sub_f32 v26, 1.0, v26
  v_cvt_pk_bf16_f32 v26, v26, v26
  v_lshlrev_b32 v26, 16, v26
  v_mov_b32 v27, v26
  s_waitcnt lgkmcnt(12)
  v_pk_add_f32 v[32:33], v[32:33], v[48:49]
  v_pk_add_f32 v[144:145], v[144:145], v[64:65]
  v_lshlrev_b32 v96, 16, v80
  v_and_b32 v97, 0xffff0000, v80
  v_pk_add_f32 v[34:35], v[34:35], v[50:51]
  v_pk_add_f32 v[146:147], v[146:147], v[66:67]
  v_lshlrev_b32 v98, 16, v81
  v_and_b32 v99, 0xffff0000, v81
  v_pk_add_f32 v[144:145], v[144:145], v[32:33]
  v_pk_add_f32 v[146:147], v[146:147], v[34:35]
  v_pk_mul_f32 v[96:97], v[96:97], v[28:29]
  v_pk_mul_f32 v[98:99], v[98:99], v[28:29]
  v_pk_fma_f32 v[144:145], v[144:145], v[26:27], v[96:97]
  v_pk_fma_f32 v[146:147], v[146:147], v[26:27], v[98:99]
  v_cvt_pk_bf16_f32 v88, v144, v145
  v_cvt_pk_bf16_f32 v89, v146, v147
  s_waitcnt lgkmcnt(8)
  v_pk_add_f32 v[36:37], v[36:37], v[52:53]
  v_pk_add_f32 v[148:149], v[148:149], v[68:69]
  v_lshlrev_b32 v96, 16, v82
  v_and_b32 v97, 0xffff0000, v82
  v_pk_add_f32 v[38:39], v[38:39], v[54:55]
  v_pk_add_f32 v[150:151], v[150:151], v[70:71]
  v_lshlrev_b32 v98, 16, v83
  v_and_b32 v99, 0xffff0000, v83
  v_pk_add_f32 v[148:149], v[148:149], v[36:37]
  v_pk_add_f32 v[150:151], v[150:151], v[38:39]
  v_pk_mul_f32 v[96:97], v[96:97], v[28:29]
  v_pk_mul_f32 v[98:99], v[98:99], v[28:29]
  v_pk_fma_f32 v[148:149], v[148:149], v[26:27], v[96:97]
  v_pk_fma_f32 v[150:151], v[150:151], v[26:27], v[98:99]
  v_cvt_pk_bf16_f32 v90, v148, v149
  v_cvt_pk_bf16_f32 v91, v150, v151
  s_nop 0
  v_permlane16_swap_b32 v88, v90
  v_permlane16_swap_b32 v89, v91
  buffer_store_dwordx4 v[88:91], v24, s[48:51], s17 offen offset:0
  s_waitcnt lgkmcnt(4)
  v_pk_add_f32 v[40:41], v[40:41], v[56:57]
  v_pk_add_f32 v[152:153], v[152:153], v[72:73]
  v_lshlrev_b32 v96, 16, v84
  v_and_b32 v97, 0xffff0000, v84
  v_pk_add_f32 v[42:43], v[42:43], v[58:59]
  v_pk_add_f32 v[154:155], v[154:155], v[74:75]
  v_lshlrev_b32 v98, 16, v85
  v_and_b32 v99, 0xffff0000, v85
  v_pk_add_f32 v[152:153], v[152:153], v[40:41]
  v_pk_add_f32 v[154:155], v[154:155], v[42:43]
  v_pk_mul_f32 v[96:97], v[96:97], v[28:29]
  v_pk_mul_f32 v[98:99], v[98:99], v[28:29]
  v_pk_fma_f32 v[152:153], v[152:153], v[26:27], v[96:97]
  v_pk_fma_f32 v[154:155], v[154:155], v[26:27], v[98:99]
  v_cvt_pk_bf16_f32 v92, v152, v153
  v_cvt_pk_bf16_f32 v93, v154, v155
  s_waitcnt lgkmcnt(0)
  v_pk_add_f32 v[44:45], v[44:45], v[60:61]
  v_pk_add_f32 v[156:157], v[156:157], v[76:77]
  v_lshlrev_b32 v96, 16, v86
  v_and_b32 v97, 0xffff0000, v86
  v_pk_add_f32 v[46:47], v[46:47], v[62:63]
  v_pk_add_f32 v[158:159], v[158:159], v[78:79]
  v_lshlrev_b32 v98, 16, v87
  v_and_b32 v99, 0xffff0000, v87
  v_pk_add_f32 v[156:157], v[156:157], v[44:45]
  v_pk_add_f32 v[158:159], v[158:159], v[46:47]
  v_pk_mul_f32 v[96:97], v[96:97], v[28:29]
  v_pk_mul_f32 v[98:99], v[98:99], v[28:29]
  v_pk_fma_f32 v[156:157], v[156:157], v[26:27], v[96:97]
  v_pk_fma_f32 v[158:159], v[158:159], v[26:27], v[98:99]
  v_cvt_pk_bf16_f32 v94, v156, v157
  v_cvt_pk_bf16_f32 v95, v158, v159
  s_nop 0
  v_permlane16_swap_b32 v92, v94
  v_permlane16_swap_b32 v93, v95
  buffer_store_dwordx4 v[92:95], v24, s[48:51], s17 offen offset:64
  s_xor_b32 s5, s2, 224
  s_or_b32 s5, s5, s4
  s_cmp_eq_u32 s5, 0
  s_cselect_b32 s5, 17367040, 1073741824
  s_cmp_ge_u32 s53, 131072
  s_cselect_b32 s5, 1073741824, s5
  s_add_u32 s6, s52, 1
  v_mov_b32 v3, s6
  buffer_store_dword v3, off, s[40:43], s5 sc1
  s_endpgm
pk_spare:
  s_lshl_b32 s12, s54, 2
  s_add_u32 s12, s12, s55
  s_sub_u32 s12, s12, 28
  s_mov_b32 s13, 7
  s_mov_b32 s14, 0
  v_lshrrev_b32 v3, 3, v1
  v_lshrrev_b32 v4, 4, v1
  v_and_b32 v5, 7, v1
  v_xor_b32 v5, v5, v4
  v_lshlrev_b32 v3, 10, v3
  v_lshl_add_u32 v7, v5, 4, v3
  v_xor_b32 v8, 64, v7
  v_add_u32 v8, 7168, v8
  s_lshl_b32 s17, s12, 16
  s_lshl_b32 s5, s4, 14
  s_add_u32 s17, s17, s5
  s_add_u32 s17, s17, 896
  s_waitcnt lgkmcnt(0)
  s_mov_b32 s40, s38
  s_mov_b32 s41, s39
  s_mov_b32 s44, s8
  s_mov_b32 s45, s9
  s_mov_b32 s46, 2097152
  s_mov_b32 s47, 0x20000
  s_barrier
  s_lshl_b32 m0, s4, 11
  s_mov_b32 s5, 17367040
  buffer_load_dwordx4 v7, s[44:47], s17 offen offset:0 lds
  buffer_load_dwordx4 v8, s[44:47], s17 offen offset:1024 lds
  buffer_load_dword v9, off, s[40:43], s5 sc1
  s_getpc_b64 s[56:57]
p1s_pc:
  s_sub_u32 s56, s56, p1s_pc-code_begin
  s_subb_u32 s57, s57, 0
  s_mov_b32 s58, code_end-code_begin
  s_mov_b32 s59, 0x20000
  v_lshlrev_b32 v4, 7, v1
  s_lshl_b32 s5, s4, 14
  buffer_load_dword v6, v4, s[56:59], s5 offen
  s_add_u32 s5, s5, 8192
  buffer_load_dword v6, v4, s[56:59], s5 offen
  s_waitcnt vmcnt(2)
  v_readfirstlane_b32 s52, v9
  s_mul_i32 s5, s52, 0x9e3779b1
  s_add_u32 s5, s5, 0x7f4a7c15
  v_mov_b32 v2, s5
  s_barrier
  v_lshrrev_b32 v3, 4, v1
  v_bfe_u32 v4, v1, 2, 2
  v_lshl_add_u32 v5, v3, 3, v4
  v_lshlrev_b32 v12, 7, v5
  v_lshrrev_b32 v4, 1, v4
  v_and_b32 v5, 1, v3
  v_lshl_add_u32 v4, v5, 2, v4
  v_bfe_u32 v5, v1, 1, 1
  v_xor_b32 v4, v4, v5
  s_lshl_b32 s5, s4, 1
  v_xor_b32 v4, s5, v4
  v_lshl_add_u32 v12, v4, 4, v12
  v_and_b32 v4, 1, v1
  v_lshl_add_u32 v12, v4, 3, v12
  v_xor_b32 v13, 32, v12
  v_add_u32 v12, s14, v12
  v_add_u32 v13, s14, v13
  ds_read_b64_tr_b16 v[16:17], v12 offset:0
  ds_read_b64_tr_b16 v[18:19], v13 offset:512
  ds_read_b64_tr_b16 v[20:21], v12 offset:4096
  ds_read_b64_tr_b16 v[22:23], v13 offset:4608
  v_and_b32 v4, 15, v1
  v_lshlrev_b32 v4, 12, v4
  v_lshl_add_u32 v14, v3, 4, v4
  s_lshl_b32 s5, s13, 2
  s_add_u32 s5, s5, s4
  s_lshl_b32 s5, s5, 16
  s_lshl_b32 s6, s12, 7
  s_add_u32 s5, s5, s6
  s_add_u32 s5, s5, 12582912
  s_waitcnt lgkmcnt(0)
  buffer_store_dwordx4 v[16:19], v14, s[40:43], s5 offen offset:0 sc1
  buffer_store_dwordx4 v[20:23], v14, s[40:43], s5 offen offset:64 sc1
  s_barrier
  s_barrier
  s_barrier
  s_barrier
  s_barrier
  s_barrier
  s_barrier
  s_barrier
  s_barrier
  s_barrier
  s_barrier
  s_barrier
  s_barrier
  s_barrier
  s_barrier
  s_barrier
  s_lshl_b32 s22, s13, 5
  s_add_u32 s22, s22, s12
  s_lshl_b32 s22, s22, 2
  s_add_u32 s22, s22, s4
  s_waitcnt vmcnt(0)
  s_lshl_b32 s5, s22, 2
  s_add_u32 s5, s5, 17408000
  buffer_store_dword v2, off, s[40:43], s5 sc1
  s_mov_b32 s44, s26
  s_mov_b32 s45, s27
  s_mov_b32 s46, 8388608
  s_mov_b32 s47, 0x20000
  s_lshl_b32 s5, s12, 18
  s_lshl_b32 s6, s4, 10
  s_add_u32 s5, s5, s6
  v_lshrrev_b32 v4, 2, v1
  v_lshlrev_b32 v4, 12, v4
  v_and_b32 v5, 3, v1
  v_lshl_add_u32 v4, v5, 7, v4
  s_add_u32 s6, s5, 0
  buffer_load_dword v6, v4, s[44:47], s6 offen
  s_add_u32 s6, s5, 65536
  buffer_load_dword v6, v4, s[44:47], s6 offen
  s_add_u32 s6, s5, 131072
  buffer_load_dword v6, v4, s[44:47], s6 offen
  s_add_u32 s6, s5, 196608
  buffer_load_dword v6, v4, s[44:47], s6 offen
  s_add_u32 s6, s5, 512
  buffer_load_dword v6, v4, s[44:47], s6 offen
  s_add_u32 s6, s5, 66048
  buffer_load_dword v6, v4, s[44:47], s6 offen
  s_add_u32 s6, s5, 131584
  buffer_load_dword v6, v4, s[44:47], s6 offen
  s_add_u32 s6, s5, 197120
  buffer_load_dword v6, v4, s[44:47], s6 offen
  s_mov_b32 s22, 8251840
  s_branch p2_setup
pk_conv:
  s_setprio 2
  s_load_dwordx2 s[44:45], s[0:1], 8
  s_load_dwordx2 s[48:49], s[0:1], 16
  s_load_dwordx2 s[56:57], s[0:1], 24
  s_load_dwordx2 s[92:93], s[0:1], 32
  s_load_dwordx2 s[24:25], s[0:1], 40
  s_load_dwordx2 s[32:33], s[0:1], 48
  s_load_dwordx2 s[40:41], s[0:1], 120
  s_load_dwordx2 s[30:31], s[0:1], 88
  s_load_dwordx2 s[96:97], s[0:1], 96
  s_mov_b32 s46, 131072
  s_mov_b32 s47, 0x20000
  s_mov_b32 s50, 131072
  s_mov_b32 s51, 0x20000
  s_mov_b32 s58, 131072
  s_mov_b32 s59, 0x20000
  s_mov_b32 s94, 131072
  s_mov_b32 s95, 0x20000
  s_mov_b32 s26, 1024
  s_mov_b32 s27, 0x20000
  s_mov_b32 s34, 1024
  s_mov_b32 s35, 0x20000
  s_sub_u32 s10, s4, 4
  s_and_b32 s9, s4, 1
  s_lshr_b32 s22, s10, 1
  s_lshl_b32 s8, s2, 1
  s_add_u32 s8, s8, s22
  v_lshlrev_b32 v3, 1, v1
  s_lshl_b32 s5, s8, 8
  s_lshl_b32 s6, s9, 7
  s_add_u32 s5, s5, s6
  s_lshl_b32 s6, s8, 1
  s_waitcnt lgkmcnt(0)
  buffer_load_ushort v11, off, s[24:27], s6
  buffer_load_ushort v7, v3, s[44:47], s5 offen
  buffer_load_ushort v8, v3, s[48:51], s5 offen
  buffer_load_ushort v9, v3, s[56:59], s5 offen
  buffer_load_ushort v10, v3, s[92:95], s5 offen
  buffer_load_ushort v12, off, s[32:35], s6
  s_mov_b32 s5, 17367040
  buffer_load_dword v13, off, s[40:43], s5 sc1
  s_mul_i32 s14, s55, 37
  s_lshr_b32 s14, s14, 8
  s_lshl_b32 s12, s54, 2
  s_add_u32 s12, s12, s14
  s_mul_i32 s13, s14, 7
  s_sub_u32 s13, s55, s13
  s_lshl_b32 s14, s14, 1
  s_add_u32 s14, s14, s13
  s_mov_b32 s98, 1024
  s_mov_b32 s99, 0x20000
  v_lshrrev_b32 v3, 3, v1
  v_add_u32 v3, s14, v3
  v_and_b32 v3, 7, v3
  v_and_b32 v4, 7, v1
  v_lshlrev_b32 v4, 4, v4
  v_lshl_add_u32 v3, v3, 7, v4
  buffer_load_dwordx4 v[252:255], v3, s[96:99], 0 offen
  s_mul_i32 s23, s22, 33280
  s_add_u32 s23, s23, 65536
  s_mul_i32 s28, s9, 13328
  s_add_u32 s28, s28, s23
  s_add_u32 s28, s28, 4160
  s_mul_i32 s29, s22, 4576
  s_add_u32 s29, s29, 132096
  v_lshlrev_b32 v14, 4, v1
  v_lshrrev_b32 v18, 4, v1
  v_and_b32 v19, 15, v1
  v_mov_b32 v20, 0
  v_mov_b32 v21, 0
  v_mov_b32 v22, 0
  v_mov_b32 v23, 0
  s_lshl_b32 s5, s10, 2
  s_add_u32 s5, s5, 162560
  v_mov_b32 v15, s5
  v_xor_b32 v16, 4, v15
  ds_write_b32 v15, v20
  ds_write_b32 v15, v20 offset:16
  ds_write_b32 v15, v20 offset:32
  s_waitcnt lgkmcnt(0)
  s_barrier
  s_setprio 0
  v_lshl_add_u32 v32, v1, 2, s28
  v_mul_u32_u24 v5, 272, v19
  v_lshl_add_u32 v5, v18, 4, v5
  s_add_u32 s5, s28, 8976
  v_add_u32 v33, s5, v5
  v_lshl_add_u32 v5, v18, 4, s28
  v_sub_u32 v24, 15, v19
  v_mul_u32_u24 v24, 272, v24
  v_add_u32 v24, v24, v5
  v_sub_u32 v25, 31, v19
  v_mul_u32_u24 v25, 272, v25
  v_add_u32 v25, v25, v5
  v_sub_u32 v26, 15, v19
  v_bfe_u32 v3, v26, 1, 1
  v_add3_u32 v26, v26, 0, v3
  v_lshrrev_b32 v26, 1, v26
  v_mul_u32_u24 v26, 544, v26
  v_add_u32 v26, v26, v5
  v_sub_u32 v27, 31, v19
  v_bfe_u32 v3, v27, 1, 1
  v_add3_u32 v27, v27, 0, v3
  v_lshrrev_b32 v27, 1, v27
  v_mul_u32_u24 v27, 544, v27
  v_add_u32 v27, v27, v5
  v_sub_u32 v28, 15, v19
  v_bfe_u32 v3, v28, 2, 1
  v_add3_u32 v28, v28, 1, v3
  v_lshrrev_b32 v28, 2, v28
  v_mul_u32_u24 v28, 1088, v28
  v_add_u32 v28, v28, v5
  v_sub_u32 v29, 31, v19
  v_bfe_u32 v3, v29, 2, 1
  v_add3_u32 v29, v29, 1, v3
  v_lshrrev_b32 v29, 2, v29
  v_mul_u32_u24 v29, 1088, v29
  v_add_u32 v29, v29, v5
  v_sub_u32 v30, 15, v19
  v_bfe_u32 v3, v30, 3, 1
  v_add3_u32 v30, v30, 3, v3
  v_lshrrev_b32 v30, 3, v30
  v_mul_u32_u24 v30, 2176, v30
  v_add_u32 v30, v30, v5
  v_sub_u32 v31, 31, v19
  v_bfe_u32 v3, v31, 3, 1
  v_add3_u32 v31, v31, 3, v3
  v_lshrrev_b32 v31, 3, v31
  v_mul_u32_u24 v31, 2176, v31
  v_add_u32 v31, v31, v5
  v_add_u32 v34, s28, v14
  s_mul_i32 s5, s9, 26656
  s_sub_u32 s5, 13328, s5
  v_add_u32 v35, s5, v34
  v_lshlrev_b32 v3, 6, v19
  v_lshlrev_b32 v4, 3, v18
  v_sub_u32 v3, v4, v3
  s_add_u32 s5, s23, 960
  v_add_u32 v36, s5, v3
  v_and_b32 v3, 7, v19
  v_sub_u32 v3, 7, v3
  v_mul_u32_u24 v3, 4160, v3
  v_lshrrev_b32 v4, 3, v19
  v_sub_u32 v4, v18, v4
  v_lshl_add_u32 v3, v4, 4, v3
  s_add_u32 s5, s23, 16
  v_add_u32 v37, s5, v3
  v_lshlrev_b32 v3, 5, v19
  v_lshl_add_u32 v4, v18, 4, v3
  v_add_u32 v38, s29, v4
  v_add_u32 v40, v3, v4
  v_lshl_add_u32 v41, v18, 3, v3
  s_add_u32 s5, s29, 480
  v_add_u32 v42, s5, v41
  s_lshl_b32 s5, s9, 11
  s_add_u32 s5, s5, s23
  v_add_u32 v39, s5, v14
  s_mov_b32 s37, 0x3fb8aa3b
  s_waitcnt vmcnt(0)
  v_readfirstlane_b32 s52, v13
  s_mul_i32 s5, s52, 0x9e3779b1
  s_add_u32 s5, s5, 0x7f4a7c15
  v_mov_b32 v2, s5
  s_mov_b32 s34, 0x00ff00ff
  s_mov_b32 s35, 0x00ff00ff
  v_lshlrev_b32 v7, 16, v7
  v_lshlrev_b32 v8, 16, v8
  v_lshlrev_b32 v9, 16, v9
  v_lshlrev_b32 v10, 16, v10
  v_lshlrev_b32 v11, 16, v11
  v_lshlrev_b32 v12, 16, v12
  v_mul_f32 v51, s37, v11
  v_fma_f32 v52, v11, s37, -v51
  v_fmamk_f32 v52, v11, 0x32a57060, v52
  v_exp_f32 v11, v51
  v_mul_f32 v52, 0x3f317218, v52
  v_fma_f32 v11, v11, v52, v11
  v_cvt_pk_bf16_f32 v11, v11, v11
  v_lshlrev_b32 v11, 16, v11
  v_mul_f32 v51, s37, v7
  v_fma_f32 v52, v7, s37, -v51
  v_fmamk_f32 v52, v7, 0x32a57060, v52
  v_exp_f32 v7, v51
  v_mul_f32 v52, 0x3f317218, v52
  v_fma_f32 v7, v7, v52, v7
  v_cvt_pk_bf16_f32 v7, v7, v7
  v_lshlrev_b32 v7, 16, v7
  v_mul_f32 v7, v7, v11
  v_mul_f32 v8, v8, v11
  v_mul_f32 v7, 0xbfb8aa3b, v7
  v_mul_f32 v8, 0.15915494, v8
  v_add_f32 v11, v11, v11
  v_mul_f32 v49, v9, v11
  v_mul_f32 v50, v10, v11
  v_mul_f32 v51, 0x3f800000, v7
  v_mul_f32 v52, 0x3f800000, v8
  v_exp_f32 v51, v51
  v_fract_f32 v52, v52
  v_cos_f32 v43, v52
  v_sin_f32 v44, v52
  v_mul_f32 v43, v43, v51
  v_mul_f32 v44, v44, v51
  v_mul_f32 v51, 0x42000000, v7
  v_mul_f32 v52, 0x42000000, v8
  v_exp_f32 v51, v51
  v_fract_f32 v52, v52
  v_cos_f32 v45, v52
  v_sin_f32 v46, v52
  v_mul_f32 v45, v45, v51
  v_mul_f32 v46, v46, v51
  s_cmp_ge_u32 s55, 28
  s_cbranch_scc1 c_idle
  s_barrier
  s_barrier
  s_barrier
  s_barrier
  s_barrier
  s_barrier
  s_barrier
  s_barrier
  s_barrier
  s_sub_u32 s15, s13, s14
  s_and_b32 s15, s15, 7
  s_lshl_b32 s15, s15, 13
  s_add_u32 s15, s15, 81920
  v_lshrrev_b32 v3, 4, v1
  v_bfe_u32 v4, v1, 2, 2
  v_lshl_add_u32 v5, v3, 3, v4
  v_lshlrev_b32 v128, 7, v5
  v_lshrrev_b32 v4, 1, v4
  v_and_b32 v5, 1, v3
  v_lshl_add_u32 v4, v5, 2, v4
  v_bfe_u32 v5, v1, 1, 1
  v_xor_b32 v4, v4, v5
  s_lshl_b32 s5, s10, 1
  v_xor_b32 v4, s5, v4
  v_lshl_add_u32 v128, v4, 4, v128
  v_and_b32 v4, 1, v1
  v_lshl_add_u32 v128, v4, 3, v128
  v_xor_b32 v129, 32, v128
  v_add_u32 v128, s15, v128
  v_add_u32 v129, s15, v129
  ds_read_b64_tr_b16 v[132:133], v128 offset:0
  ds_read_b64_tr_b16 v[134:135], v129 offset:512
  ds_read_b64_tr_b16 v[136:137], v128 offset:4096
  ds_read_b64_tr_b16 v[138:139], v129 offset:4608
  v_and_b32 v4, 15, v1
  v_lshlrev_b32 v4, 12, v4
  v_lshl_add_u32 v130, v3, 4, v4
  s_lshl_b32 s5, s13, 2
  s_add_u32 s5, s5, s10
  s_lshl_b32 s5, s5, 16
  s_lshl_b32 s6, s12, 7
  s_add_u32 s5, s5, s6
  s_add_u32 s5, s5, 12582912
  s_waitcnt lgkmcnt(0)
  buffer_store_dwordx4 v[132:135], v130, s[40:43], s5 offen offset:0 sc1
  buffer_store_dwordx4 v[136:139], v130, s[40:43], s5 offen offset:64 sc1
  s_lshl_b32 s15, s13, 2
  s_add_u32 s15, s15, s10
  v_lshrrev_b32 v3, 3, v1
  v_lshlrev_b32 v3, 13, v3
  v_and_b32 v4, 7, v1
  s_add_u32 s5, s15, 0
  s_min_u32 s5, s5, 63
  s_lshr_b32 s6, s5, 1
  s_and_b32 s6, s6, 7
  v_xor_b32 v5, s6, v4
  v_lshl_add_u32 v5, v5, 4, v3
  s_lshl_b32 s5, s5, 7
  s_add_u32 s5, s5, 81920
  v_add_u32 v5, s5, v5
  ds_read_b128 v[240:243], v5
  s_add_u32 s5, s15, 28
  s_min_u32 s5, s5, 63
  s_lshr_b32 s6, s5, 1
  s_and_b32 s6, s6, 7
  v_xor_b32 v5, s6, v4
  v_lshl_add_u32 v5, v5, 4, v3
  s_lshl_b32 s5, s5, 7
  s_add_u32 s5, s5, 81920
  v_add_u32 v5, s5, v5
  ds_read_b128 v[244:247], v5
  s_add_u32 s5, s15, 56
  s_min_u32 s5, s5, 63
  s_lshr_b32 s6, s5, 1
  s_and_b32 s6, s6, 7
  v_xor_b32 v5, s6, v4
  v_lshl_add_u32 v5, v5, 4, v3
  s_lshl_b32 s5, s5, 7
  s_add_u32 s5, s5, 81920
  v_add_u32 v5, s5, v5
  ds_read_b128 v[248:251], v5
  s_waitcnt lgkmcnt(0)
  s_barrier
  s_barrier
  s_barrier
  s_barrier
  s_barrier
  s_barrier
  s_barrier
  s_barrier
  s_waitcnt vmcnt(0)
  s_lshl_b32 s36, s13, 5
  s_add_u32 s36, s36, s12
  s_lshl_b32 s36, s36, 2
  s_add_u32 s36, s36, s10
  s_lshl_b32 s5, s36, 2
  s_add_u32 s5, s5, 17408000
  buffer_store_dword v2, off, s[40:43], s5 sc1
  s_branch c_gen
c_idle:
  s_barrier
  s_barrier
  s_barrier
  s_barrier
  s_barrier
  s_barrier
  s_barrier
  s_barrier
  s_barrier
  s_barrier
  s_barrier
  s_barrier
  s_barrier
  s_barrier
  s_barrier
  s_barrier
  s_barrier
c_gen:
  v_mov_b32 v55, 0x3f80
  ds_write_b32 v32, v55
  v_mov_b32 v47, v43
  v_mov_b32 v48, v44
  v_cvt_pk_bf16_f32 v55, v47, -v48
  ds_write_b32 v32, v55 offset:272
  v_cvt_pk_bf16_f32 v56, v49, v50
  v_mul_f32 v51, v48, v44
  v_mul_f32 v52, v48, v43
  ds_write_b32 v32, v56 offset:8976
  v_fma_f32 v48, v47, v44, v52
  v_fma_f32 v47, v47, v43, -v51
  v_mul_f32 v53, v50, v46
  v_cvt_pk_bf16_f32 v55, v47, -v48
  ds_write_b32 v32, v55 offset:544
  v_mul_f32 v54, v50, v45
  v_mul_f32 v51, v48, v44
  v_mul_f32 v52, v48, v43
  v_fma_f32 v50, v49, v46, v54
  v_fma_f32 v48, v47, v44, v52
  v_fma_f32 v47, v47, v43, -v51
  v_fma_f32 v49, v49, v45, -v53
  v_cvt_pk_bf16_f32 v55, v47, -v48
  ds_write_b32 v32, v55 offset:816
  v_cvt_pk_bf16_f32 v56, v49, v50
  v_mul_f32 v51, v48, v44
  v_mul_f32 v52, v48, v43
  ds_write_b32 v32, v56 offset:9248
  v_fma_f32 v48, v47, v44, v52
  v_fma_f32 v47, v47, v43, -v51
  v_mul_f32 v53, v50, v46
  v_cvt_pk_bf16_f32 v55, v47, -v48
  ds_write_b32 v32, v55 offset:1088
  v_mul_f32 v54, v50, v45
  v_mul_f32 v51, v48, v44
  v_mul_f32 v52, v48, v43
  v_fma_f32 v50, v49, v46, v54
  v_fma_f32 v48, v47, v44, v52
  v_fma_f32 v47, v47, v43, -v51
  v_fma_f32 v49, v49, v45, -v53
  v_cvt_pk_bf16_f32 v55, v47, -v48
  ds_write_b32 v32, v55 offset:1360
  v_cvt_pk_bf16_f32 v56, v49, v50
  v_mul_f32 v51, v48, v44
  v_mul_f32 v52, v48, v43
  ds_write_b32 v32, v56 offset:9520
  v_fma_f32 v48, v47, v44, v52
  v_fma_f32 v47, v47, v43, -v51
  v_mul_f32 v53, v50, v46
  v_cvt_pk_bf16_f32 v55, v47, -v48
  ds_write_b32 v32, v55 offset:1632
  v_mul_f32 v54, v50, v45
  v_mul_f32 v51, v48, v44
  v_mul_f32 v52, v48, v43
  v_fma_f32 v50, v49, v46, v54
  v_fma_f32 v48, v47, v44, v52
  v_fma_f32 v47, v47, v43, -v51
  v_fma_f32 v49, v49, v45, -v53
  v_cvt_pk_bf16_f32 v55, v47, -v48
  ds_write_b32 v32, v55 offset:1904
  v_cvt_pk_bf16_f32 v56, v49, v50
  v_mul_f32 v51, v48, v44
  v_mul_f32 v52, v48, v43
  ds_write_b32 v32, v56 offset:9792
  v_fma_f32 v48, v47, v44, v52
  v_fma_f32 v47, v47, v43, -v51
  v_mul_f32 v53, v50, v46
  v_cvt_pk_bf16_f32 v55, v47, -v48
  ds_write_b32 v32, v55 offset:2176
  v_mul_f32 v54, v50, v45
  v_mul_f32 v51, v48, v44
  v_mul_f32 v52, v48, v43
  v_fma_f32 v50, v49, v46, v54
  v_fma_f32 v48, v47, v44, v52
  v_fma_f32 v47, v47, v43, -v51
  v_fma_f32 v49, v49, v45, -v53
  v_cvt_pk_bf16_f32 v55, v47, -v48
  ds_write_b32 v32, v55 offset:2448
  v_cvt_pk_bf16_f32 v56, v49, v50
  v_mul_f32 v51, v48, v44
  v_mul_f32 v52, v48, v43
  ds_write_b32 v32, v56 offset:10064
  v_fma_f32 v48, v47, v44, v52
  v_fma_f32 v47, v47, v43, -v51
  v_mul_f32 v53, v50, v46
  v_cvt_pk_bf16_f32 v55, v47, -v48
  ds_write_b32 v32, v55 offset:2720
  v_mul_f32 v54, v50, v45
  v_mul_f32 v51, v48, v44
  v_mul_f32 v52, v48, v43
  v_fma_f32 v50, v49, v46, v54
  v_fma_f32 v48, v47, v44, v52
  v_fma_f32 v47, v47, v43, -v51
  v_fma_f32 v49, v49, v45, -v53
  v_cvt_pk_bf16_f32 v55, v47, -v48
  ds_write_b32 v32, v55 offset:2992
  v_cvt_pk_bf16_f32 v56, v49, v50
  v_mul_f32 v51, v48, v44
  v_mul_f32 v52, v48, v43
  ds_write_b32 v32, v56 offset:10336
  v_fma_f32 v48, v47, v44, v52
  v_fma_f32 v47, v47, v43, -v51
  v_mul_f32 v53, v50, v46
  v_cvt_pk_bf16_f32 v55, v47, -v48
  ds_write_b32 v32, v55 offset:3264
  v_mul_f32 v54, v50, v45
  v_mul_f32 v51, v48, v44
  v_mul_f32 v52, v48, v43
  v_fma_f32 v50, v49, v46, v54
  v_fma_f32 v48, v47, v44, v52
  v_fma_f32 v47, v47, v43, -v51
  v_fma_f32 v49, v49, v45, -v53
  v_cvt_pk_bf16_f32 v55, v47, -v48
  ds_write_b32 v32, v55 offset:3536
  v_cvt_pk_bf16_f32 v56, v49, v50
  v_mul_f32 v51, v48, v44
  v_mul_f32 v52, v48, v43
  ds_write_b32 v32, v56 offset:10608
  v_fma_f32 v48, v47, v44, v52
  v_fma_f32 v47, v47, v43, -v51
  v_mul_f32 v53, v50, v46
  v_cvt_pk_bf16_f32 v55, v47, -v48
  ds_write_b32 v32, v55 offset:3808
  v_mul_f32 v54, v50, v45
  v_mul_f32 v51, v48, v44
  v_mul_f32 v52, v48, v43
  v_fma_f32 v50, v49, v46, v54
  v_fma_f32 v48, v47, v44, v52
  v_fma_f32 v47, v47, v43, -v51
  v_fma_f32 v49, v49, v45, -v53
  v_cvt_pk_bf16_f32 v55, v47, -v48
  ds_write_b32 v32, v55 offset:4080
  v_cvt_pk_bf16_f32 v56, v49, v50
  v_mul_f32 v51, v48, v44
  v_mul_f32 v52, v48, v43
  ds_write_b32 v32, v56 offset:10880
  v_fma_f32 v48, v47, v44, v52
  v_fma_f32 v47, v47, v43, -v51
  v_mul_f32 v53, v50, v46
  v_cvt_pk_bf16_f32 v55, v47, -v48
  ds_write_b32 v32, v55 offset:4352
  v_mul_f32 v54, v50, v45
  v_mul_f32 v51, v48, v44
  v_mul_f32 v52, v48, v43
  v_fma_f32 v50, v49, v46, v54
  v_fma_f32 v48, v47, v44, v52
  v_fma_f32 v47, v47, v43, -v51
  v_fma_f32 v49, v49, v45, -v53
  v_cvt_pk_bf16_f32 v55, v47, -v48
  ds_write_b32 v32, v55 offset:4624
  v_cvt_pk_bf16_f32 v56, v49, v50
  v_mul_f32 v51, v48, v44
  v_mul_f32 v52, v48, v43
  ds_write_b32 v32, v56 offset:11152
  v_fma_f32 v48, v47, v44, v52
  v_fma_f32 v47, v47, v43, -v51
  v_mul_f32 v53, v50, v46
  v_cvt_pk_bf16_f32 v55, v47, -v48
  ds_write_b32 v32, v55 offset:4896
  v_mul_f32 v54, v50, v45
  v_mul_f32 v51, v48, v44
  v_mul_f32 v52, v48, v43
  v_fma_f32 v50, v49, v46, v54
  v_fma_f32 v48, v47, v44, v52
  v_fma_f32 v47, v47, v43, -v51
  v_fma_f32 v49, v49, v45, -v53
  v_cvt_pk_bf16_f32 v55, v47, -v48
  ds_write_b32 v32, v55 offset:5168
  v_cvt_pk_bf16_f32 v56, v49, v50
  v_mul_f32 v51, v48, v44
  v_mul_f32 v52, v48, v43
  ds_write_b32 v32, v56 offset:11424
  v_fma_f32 v48, v47, v44, v52
  v_fma_f32 v47, v47, v43, -v51
  v_mul_f32 v53, v50, v46
  v_cvt_pk_bf16_f32 v55, v47, -v48
  ds_write_b32 v32, v55 offset:5440
  v_mul_f32 v54, v50, v45
  v_mul_f32 v51, v48, v44
  v_mul_f32 v52, v48, v43
  v_fma_f32 v50, v49, v46, v54
  v_fma_f32 v48, v47, v44, v52
  v_fma_f32 v47, v47, v43, -v51
  v_fma_f32 v49, v49, v45, -v53
  v_cvt_pk_bf16_f32 v55, v47, -v48
  ds_write_b32 v32, v55 offset:5712
  v_cvt_pk_bf16_f32 v56, v49, v50
  v_mul_f32 v51, v48, v44
  v_mul_f32 v52, v48, v43
  ds_write_b32 v32, v56 offset:11696
  v_fma_f32 v48, v47, v44, v52
  v_fma_f32 v47, v47, v43, -v51
  v_mul_f32 v53, v50, v46
  v_cvt_pk_bf16_f32 v55, v47, -v48
  ds_write_b32 v32, v55 offset:5984
  v_mul_f32 v54, v50, v45
  v_mul_f32 v51, v48, v44
  v_mul_f32 v52, v48, v43
  v_fma_f32 v50, v49, v46, v54
  v_fma_f32 v48, v47, v44, v52
  v_fma_f32 v47, v47, v43, -v51
  v_fma_f32 v49, v49, v45, -v53
  v_cvt_pk_bf16_f32 v55, v47, -v48
  ds_write_b32 v32, v55 offset:6256
  v_cvt_pk_bf16_f32 v56, v49, v50
  v_mul_f32 v51, v48, v44
  v_mul_f32 v52, v48, v43
  ds_write_b32 v32, v56 offset:11968
  v_fma_f32 v48, v47, v44, v52
  v_fma_f32 v47, v47, v43, -v51
  v_mul_f32 v53, v50, v46
  v_cvt_pk_bf16_f32 v55, v47, -v48
  ds_write_b32 v32, v55 offset:6528
  v_mul_f32 v54, v50, v45
  v_mul_f32 v51, v48, v44
  v_mul_f32 v52, v48, v43
  v_fma_f32 v50, v49, v46, v54
  v_fma_f32 v48, v47, v44, v52
  v_fma_f32 v47, v47, v43, -v51
  v_fma_f32 v49, v49, v45, -v53
  v_cvt_pk_bf16_f32 v55, v47, -v48
  ds_write_b32 v32, v55 offset:6800
  v_cvt_pk_bf16_f32 v56, v49, v50
  v_mul_f32 v51, v48, v44
  v_mul_f32 v52, v48, v43
  ds_write_b32 v32, v56 offset:12240
  v_fma_f32 v48, v47, v44, v52
  v_fma_f32 v47, v47, v43, -v51
  v_mul_f32 v53, v50, v46
  v_cvt_pk_bf16_f32 v55, v47, -v48
  ds_write_b32 v32, v55 offset:7072
  v_mul_f32 v54, v50, v45
  v_mul_f32 v51, v48, v44
  v_mul_f32 v52, v48, v43
  v_fma_f32 v50, v49, v46, v54
  v_fma_f32 v48, v47, v44, v52
  v_fma_f32 v47, v47, v43, -v51
  v_fma_f32 v49, v49, v45, -v53
  v_cvt_pk_bf16_f32 v55, v47, -v48
  ds_write_b32 v32, v55 offset:7344
  v_cvt_pk_bf16_f32 v56, v49, v50
  v_mul_f32 v51, v48, v44
  v_mul_f32 v52, v48, v43
  ds_write_b32 v32, v56 offset:12512
  v_fma_f32 v48, v47, v44, v52
  v_fma_f32 v47, v47, v43, -v51
  v_mul_f32 v53, v50, v46
  v_cvt_pk_bf16_f32 v55, v47, -v48
  ds_write_b32 v32, v55 offset:7616
  v_mul_f32 v54, v50, v45
  v_mul_f32 v51, v48, v44
  v_mul_f32 v52, v48, v43
  v_fma_f32 v50, v49, v46, v54
  v_fma_f32 v48, v47, v44, v52
  v_fma_f32 v47, v47, v43, -v51
  v_fma_f32 v49, v49, v45, -v53
  v_cvt_pk_bf16_f32 v55, v47, -v48
  ds_write_b32 v32, v55 offset:7888
  v_cvt_pk_bf16_f32 v56, v49, v50
  v_mul_f32 v51, v48, v44
  v_mul_f32 v52, v48, v43
  ds_write_b32 v32, v56 offset:12784
  v_fma_f32 v48, v47, v44, v52
  v_fma_f32 v47, v47, v43, -v51
  v_mul_f32 v53, v50, v46
  v_cvt_pk_bf16_f32 v55, v47, -v48
  ds_write_b32 v32, v55 offset:8160
  v_mul_f32 v54, v50, v45
  v_mul_f32 v51, v48, v44
  v_mul_f32 v52, v48, v43
  v_fma_f32 v50, v49, v46, v54
  v_fma_f32 v48, v47, v44, v52
  v_fma_f32 v47, v47, v43, -v51
  v_fma_f32 v49, v49, v45, -v53
  v_cvt_pk_bf16_f32 v55, v47, -v48
  ds_write_b32 v32, v55 offset:8432
  v_cvt_pk_bf16_f32 v56, v49, v50
  v_mul_f32 v51, v48, v44
  v_mul_f32 v52, v48, v43
  ds_write_b32 v32, v56 offset:13056
  v_fma_f32 v48, v47, v44, v52
  v_fma_f32 v47, v47, v43, -v51
  v_mul_f32 v53, v50, v46
  v_cvt_pk_bf16_f32 v55, v47, -v48
  ds_write_b32 v32, v55 offset:8704
  v_mul_f32 v54, v50, v45
  v_fma_f32 v50, v49, v46, v54
  v_fma_f32 v49, v49, v45, -v53
  ds_read_b128 v[180:183], v33 offset:0
  ds_read_b128 v[184:187], v33 offset:64
  ds_read_b128 v[188:191], v33 offset:128
  ds_read_b128 v[192:195], v33 offset:192
  ds_read_b128 v[116:119], v24 offset:0
  ds_read_b128 v[120:123], v24 offset:64
  ds_read_b128 v[124:127], v24 offset:128
  ds_read_b128 v[128:131], v24 offset:192
  ds_read_b128 v[132:135], v25 offset:0
  ds_read_b128 v[136:139], v25 offset:64
  ds_read_b128 v[140:143], v25 offset:128
  ds_read_b128 v[144:147], v25 offset:192
  ds_read_b128 v[148:151], v26 offset:0
  ds_read_b128 v[152:155], v26 offset:64
  ds_read_b128 v[156:159], v26 offset:128
  ds_read_b128 v[160:163], v26 offset:192
  ds_read_b128 v[164:167], v27 offset:0
  ds_read_b128 v[168:171], v27 offset:64
  ds_read_b128 v[172:175], v27 offset:128
  ds_read_b128 v[176:179], v27 offset:192
  v_cvt_pk_bf16_f32 v56, v49, v50
  ds_write_b32 v32, v56 offset:8976
  v_mul_f32 v53, v50, v46
  v_mul_f32 v54, v50, v45
  v_fma_f32 v50, v49, v46, v54
  v_fma_f32 v49, v49, v45, -v53
  v_cvt_pk_bf16_f32 v56, v49, v50
  ds_write_b32 v32, v56 offset:9248
  v_mul_f32 v53, v50, v46
  v_mul_f32 v54, v50, v45
  v_fma_f32 v50, v49, v46, v54
  v_fma_f32 v49, v49, v45, -v53
  v_cvt_pk_bf16_f32 v56, v49, v50
  ds_write_b32 v32, v56 offset:9520
  v_mul_f32 v53, v50, v46
  v_mul_f32 v54, v50, v45
  v_fma_f32 v50, v49, v46, v54
  v_fma_f32 v49, v49, v45, -v53
  v_cvt_pk_bf16_f32 v56, v49, v50
  ds_write_b32 v32, v56 offset:9792
  v_mul_f32 v53, v50, v46
  v_mul_f32 v54, v50, v45
  v_fma_f32 v50, v49, v46, v54
  v_fma_f32 v49, v49, v45, -v53
  v_cvt_pk_bf16_f32 v56, v49, v50
  ds_write_b32 v32, v56 offset:10064
  v_mul_f32 v53, v50, v46
  v_mul_f32 v54, v50, v45
  v_fma_f32 v50, v49, v46, v54
  v_fma_f32 v49, v49, v45, -v53
  v_cvt_pk_bf16_f32 v56, v49, v50
  ds_write_b32 v32, v56 offset:10336
  v_mul_f32 v53, v50, v46
  v_mul_f32 v54, v50, v45
  v_fma_f32 v50, v49, v46, v54
  v_fma_f32 v49, v49, v45, -v53
  v_cvt_pk_bf16_f32 v56, v49, v50
  ds_write_b32 v32, v56 offset:10608
  v_mul_f32 v53, v50, v46
  v_mul_f32 v54, v50, v45
  v_fma_f32 v50, v49, v46, v54
  v_fma_f32 v49, v49, v45, -v53
  v_cvt_pk_bf16_f32 v56, v49, v50
  ds_write_b32 v32, v56 offset:10880
  v_mul_f32 v53, v50, v46
  v_mul_f32 v54, v50, v45
  v_fma_f32 v50, v49, v46, v54
  v_fma_f32 v49, v49, v45, -v53
  v_cvt_pk_bf16_f32 v56, v49, v50
  ds_write_b32 v32, v56 offset:11152
  v_mul_f32 v53, v50, v46
  v_mul_f32 v54, v50, v45
  v_fma_f32 v50, v49, v46, v54
  v_fma_f32 v49, v49, v45, -v53
  v_cvt_pk_bf16_f32 v56, v49, v50
  ds_write_b32 v32, v56 offset:11424
  v_mul_f32 v53, v50, v46
  v_mul_f32 v54, v50, v45
  v_fma_f32 v50, v49, v46, v54
  v_fma_f32 v49, v49, v45, -v53
  v_cvt_pk_bf16_f32 v56, v49, v50
  ds_write_b32 v32, v56 offset:11696
  v_mul_f32 v53, v50, v46
  v_mul_f32 v54, v50, v45
  v_fma_f32 v50, v49, v46, v54
  v_fma_f32 v49, v49, v45, -v53
  v_cvt_pk_bf16_f32 v56, v49, v50
  ds_write_b32 v32, v56 offset:11968
  v_mul_f32 v53, v50, v46
  v_mul_f32 v54, v50, v45
  v_fma_f32 v50, v49, v46, v54
  v_fma_f32 v49, v49, v45, -v53
  v_cvt_pk_bf16_f32 v56, v49, v50
  ds_write_b32 v32, v56 offset:12240
  v_mul_f32 v53, v50, v46
  v_mul_f32 v54, v50, v45
  v_fma_f32 v50, v49, v46, v54
  v_fma_f32 v49, v49, v45, -v53
  v_cvt_pk_bf16_f32 v56, v49, v50
  ds_write_b32 v32, v56 offset:12512
  v_mul_f32 v53, v50, v46
  v_mul_f32 v54, v50, v45
  v_fma_f32 v50, v49, v46, v54
  v_fma_f32 v49, v49, v45, -v53
  v_cvt_pk_bf16_f32 v56, v49, v50
  ds_write_b32 v32, v56 offset:12784
  v_mul_f32 v53, v50, v46
  v_mul_f32 v54, v50, v45
  v_fma_f32 v50, v49, v46, v54
  v_fma_f32 v49, v49, v45, -v53
  v_cvt_pk_bf16_f32 v56, v49, v50
  ds_write_b32 v32, v56 offset:13056
  v_mul_f32 v53, v50, v46
  v_mul_f32 v54, v50, v45
  v_fma_f32 v50, v49, v46, v54
  v_fma_f32 v49, v49, v45, -v53
  s_waitcnt lgkmcnt(15)
  v_mfma_f32_16x16x32_bf16 v[76:79], v[116:119], v[180:183], 0
  v_mfma_f32_16x16x32_bf16 v[80:83], v[132:135], v[180:183], 0
  v_mfma_f32_16x16x32_bf16 v[76:79], v[120:123], v[184:187], v[76:79]
  v_mfma_f32_16x16x32_bf16 v[80:83], v[136:139], v[184:187], v[80:83]
  v_mfma_f32_16x16x32_bf16 v[76:79], v[124:127], v[188:191], v[76:79]
  v_mfma_f32_16x16x32_bf16 v[80:83], v[140:143], v[188:191], v[80:83]
  v_mfma_f32_16x16x32_bf16 v[76:79], v[128:131], v[192:195], v[76:79]
  v_mfma_f32_16x16x32_bf16 v[80:83], v[144:147], v[192:195], v[80:83]
  v_mfma_f32_16x16x32_bf16 v[108:111], v[148:151], v[180:183], 0
  v_mfma_f32_16x16x32_bf16 v[112:115], v[164:167], v[180:183], 0
  v_mfma_f32_16x16x32_bf16 v[108:111], v[152:155], v[184:187], v[108:111]
  v_mfma_f32_16x16x32_bf16 v[112:115], v[168:171], v[184:187], v[112:115]
  v_mfma_f32_16x16x32_bf16 v[108:111], v[156:159], v[188:191], v[108:111]
  v_mfma_f32_16x16x32_bf16 v[112:115], v[172:175], v[188:191], v[112:115]
  v_mfma_f32_16x16x32_bf16 v[108:111], v[160:163], v[192:195], v[108:111]
  v_mfma_f32_16x16x32_bf16 v[112:115], v[176:179], v[192:195], v[112:115]
  ds_read_b128 v[180:183], v33 offset:0
  ds_read_b128 v[184:187], v33 offset:64
  ds_read_b128 v[188:191], v33 offset:128
  ds_read_b128 v[192:195], v33 offset:192
  ds_read_b128 v[116:119], v28 offset:0
  ds_read_b128 v[120:123], v28 offset:64
  ds_read_b128 v[124:127], v28 offset:128
  ds_read_b128 v[128:131], v28 offset:192
  ds_read_b128 v[132:135], v29 offset:0
  ds_read_b128 v[136:139], v29 offset:64
  ds_read_b128 v[140:143], v29 offset:128
  ds_read_b128 v[144:147], v29 offset:192
  v_cvt_pk_bf16_f32 v56, v49, v50
  ds_write_b32 v32, v56 offset:8976
  v_mul_f32 v53, v50, v46
  v_mul_f32 v54, v50, v45
  v_fma_f32 v50, v49, v46, v54
  v_fma_f32 v49, v49, v45, -v53
  v_cvt_pk_bf16_f32 v56, v49, v50
  ds_write_b32 v32, v56 offset:9248
  v_mul_f32 v53, v50, v46
  v_mul_f32 v54, v50, v45
  v_fma_f32 v50, v49, v46, v54
  v_fma_f32 v49, v49, v45, -v53
  v_cvt_pk_bf16_f32 v56, v49, v50
  ds_write_b32 v32, v56 offset:9520
  v_mul_f32 v53, v50, v46
  v_mul_f32 v54, v50, v45
  v_fma_f32 v50, v49, v46, v54
  v_fma_f32 v49, v49, v45, -v53
  v_cvt_pk_bf16_f32 v56, v49, v50
  ds_write_b32 v32, v56 offset:9792
  v_mul_f32 v53, v50, v46
  v_mul_f32 v54, v50, v45
  v_fma_f32 v50, v49, v46, v54
  v_fma_f32 v49, v49, v45, -v53
  v_cvt_pk_bf16_f32 v56, v49, v50
  ds_write_b32 v32, v56 offset:10064
  v_mul_f32 v53, v50, v46
  v_mul_f32 v54, v50, v45
  v_fma_f32 v50, v49, v46, v54
  v_fma_f32 v49, v49, v45, -v53
  v_cvt_pk_bf16_f32 v56, v49, v50
  ds_write_b32 v32, v56 offset:10336
  v_mul_f32 v53, v50, v46
  v_mul_f32 v54, v50, v45
  v_fma_f32 v50, v49, v46, v54
  v_fma_f32 v49, v49, v45, -v53
  v_cvt_pk_bf16_f32 v56, v49, v50
  ds_write_b32 v32, v56 offset:10608
  v_mul_f32 v53, v50, v46
  v_mul_f32 v54, v50, v45
  v_fma_f32 v50, v49, v46, v54
  v_fma_f32 v49, v49, v45, -v53
  v_cvt_pk_bf16_f32 v56, v49, v50
  ds_write_b32 v32, v56 offset:10880
  v_mul_f32 v53, v50, v46
  v_mul_f32 v54, v50, v45
  v_fma_f32 v50, v49, v46, v54
  v_fma_f32 v49, v49, v45, -v53
  v_cvt_pk_bf16_f32 v56, v49, v50
  ds_write_b32 v32, v56 offset:11152
  v_mul_f32 v53, v50, v46
  v_mul_f32 v54, v50, v45
  v_fma_f32 v50, v49, v46, v54
  v_fma_f32 v49, v49, v45, -v53
  v_cvt_pk_bf16_f32 v56, v49, v50
  ds_write_b32 v32, v56 offset:11424
  v_mul_f32 v53, v50, v46
  v_mul_f32 v54, v50, v45
  v_fma_f32 v50, v49, v46, v54
  v_fma_f32 v49, v49, v45, -v53
  v_cvt_pk_bf16_f32 v56, v49, v50
  ds_write_b32 v32, v56 offset:11696
  v_mul_f32 v53, v50, v46
  v_mul_f32 v54, v50, v45
  v_fma_f32 v50, v49, v46, v54
  v_fma_f32 v49, v49, v45, -v53
  v_cvt_pk_bf16_f32 v56, v49, v50
  ds_write_b32 v32, v56 offset:11968
  v_mul_f32 v53, v50, v46
  v_mul_f32 v54, v50, v45
  v_fma_f32 v50, v49, v46, v54
  v_fma_f32 v49, v49, v45, -v53
  v_cvt_pk_bf16_f32 v56, v49, v50
  ds_write_b32 v32, v56 offset:12240
  v_mul_f32 v53, v50, v46
  v_mul_f32 v54, v50, v45
  v_fma_f32 v50, v49, v46, v54
  v_fma_f32 v49, v49, v45, -v53
  v_cvt_pk_bf16_f32 v56, v49, v50
  ds_write_b32 v32, v56 offset:12512
  v_mul_f32 v53, v50, v46
  v_mul_f32 v54, v50, v45
  v_fma_f32 v50, v49, v46, v54
  v_fma_f32 v49, v49, v45, -v53
  v_cvt_pk_bf16_f32 v56, v49, v50
  ds_write_b32 v32, v56 offset:12784
  v_mul_f32 v53, v50, v46
  v_mul_f32 v54, v50, v45
  v_fma_f32 v50, v49, v46, v54
  v_fma_f32 v49, v49, v45, -v53
  v_cvt_pk_bf16_f32 v56, v49, v50
  ds_write_b32 v32, v56 offset:13056
  v_mul_f32 v53, v50, v46
  v_mul_f32 v54, v50, v45
  v_fma_f32 v50, v49, v46, v54
  v_fma_f32 v49, v49, v45, -v53
  s_waitcnt lgkmcnt(15)
  v_mfma_f32_16x16x32_bf16 v[84:87], v[116:119], v[180:183], 0
  v_mfma_f32_16x16x32_bf16 v[88:91], v[132:135], v[180:183], 0
  v_mfma_f32_16x16x32_bf16 v[84:87], v[120:123], v[184:187], v[84:87]
  v_mfma_f32_16x16x32_bf16 v[88:91], v[136:139], v[184:187], v[88:91]
  v_mfma_f32_16x16x32_bf16 v[84:87], v[124:127], v[188:191], v[84:87]
  v_mfma_f32_16x16x32_bf16 v[88:91], v[140:143], v[188:191], v[88:91]
  v_mfma_f32_16x16x32_bf16 v[84:87], v[128:131], v[192:195], v[84:87]
  v_mfma_f32_16x16x32_bf16 v[88:91], v[144:147], v[192:195], v[88:91]
  ds_read_b128 v[180:183], v33 offset:0
  ds_read_b128 v[184:187], v33 offset:64
  ds_read_b128 v[188:191], v33 offset:128
  ds_read_b128 v[192:195], v33 offset:192
  ds_read_b128 v[148:151], v30 offset:0
  ds_read_b128 v[152:155], v30 offset:64
  ds_read_b128 v[156:159], v30 offset:128
  ds_read_b128 v[160:163], v30 offset:192
  ds_read_b128 v[164:167], v31 offset:0
  ds_read_b128 v[168:171], v31 offset:64
  ds_read_b128 v[172:175], v31 offset:128
  ds_read_b128 v[176:179], v31 offset:192
  v_cvt_pk_bf16_f32 v56, v49, v50
  ds_write_b32 v32, v56 offset:8976
  v_mul_f32 v53, v50, v46
  v_mul_f32 v54, v50, v45
  v_fma_f32 v50, v49, v46, v54
  v_fma_f32 v49, v49, v45, -v53
  v_cvt_pk_bf16_f32 v56, v49, v50
  ds_write_b32 v32, v56 offset:9248
  v_mul_f32 v53, v50, v46
  v_mul_f32 v54, v50, v45
  v_fma_f32 v50, v49, v46, v54
  v_fma_f32 v49, v49, v45, -v53
  v_cvt_pk_bf16_f32 v56, v49, v50
  ds_write_b32 v32, v56 offset:9520
  v_mul_f32 v53, v50, v46
  v_mul_f32 v54, v50, v45
  v_fma_f32 v50, v49, v46, v54
  v_fma_f32 v49, v49, v45, -v53
  v_cvt_pk_bf16_f32 v56, v49, v50
  ds_write_b32 v32, v56 offset:9792
  v_mul_f32 v53, v50, v46
  v_mul_f32 v54, v50, v45
  v_fma_f32 v50, v49, v46, v54
  v_fma_f32 v49, v49, v45, -v53
  v_cvt_pk_bf16_f32 v56, v49, v50
  ds_write_b32 v32, v56 offset:10064
  v_mul_f32 v53, v50, v46
  v_mul_f32 v54, v50, v45
  v_fma_f32 v50, v49, v46, v54
  v_fma_f32 v49, v49, v45, -v53
  v_cvt_pk_bf16_f32 v56, v49, v50
  ds_write_b32 v32, v56 offset:10336
  v_mul_f32 v53, v50, v46
  v_mul_f32 v54, v50, v45
  v_fma_f32 v50, v49, v46, v54
  v_fma_f32 v49, v49, v45, -v53
  v_cvt_pk_bf16_f32 v56, v49, v50
  ds_write_b32 v32, v56 offset:10608
  v_mul_f32 v53, v50, v46
  v_mul_f32 v54, v50, v45
  v_fma_f32 v50, v49, v46, v54
  v_fma_f32 v49, v49, v45, -v53
  v_cvt_pk_bf16_f32 v56, v49, v50
  ds_write_b32 v32, v56 offset:10880
  v_mul_f32 v53, v50, v46
  v_mul_f32 v54, v50, v45
  v_fma_f32 v50, v49, v46, v54
  v_fma_f32 v49, v49, v45, -v53
  v_cvt_pk_bf16_f32 v56, v49, v50
  ds_write_b32 v32, v56 offset:11152
  v_mul_f32 v53, v50, v46
  v_mul_f32 v54, v50, v45
  v_fma_f32 v50, v49, v46, v54
  v_fma_f32 v49, v49, v45, -v53
  v_cvt_pk_bf16_f32 v56, v49, v50
  ds_write_b32 v32, v56 offset:11424
  v_mul_f32 v53, v50, v46
  v_mul_f32 v54, v50, v45
  v_fma_f32 v50, v49, v46, v54
  v_fma_f32 v49, v49, v45, -v53
  v_cvt_pk_bf16_f32 v56, v49, v50
  ds_write_b32 v32, v56 offset:11696
  v_mul_f32 v53, v50, v46
  v_mul_f32 v54, v50, v45
  v_fma_f32 v50, v49, v46, v54
  v_fma_f32 v49, v49, v45, -v53
  v_cvt_pk_bf16_f32 v56, v49, v50
  ds_write_b32 v32, v56 offset:11968
  v_mul_f32 v53, v50, v46
  v_mul_f32 v54, v50, v45
  v_fma_f32 v50, v49, v46, v54
  v_fma_f32 v49, v49, v45, -v53
  v_cvt_pk_bf16_f32 v56, v49, v50
  ds_write_b32 v32, v56 offset:12240
  v_mul_f32 v53, v50, v46
  v_mul_f32 v54, v50, v45
  v_fma_f32 v50, v49, v46, v54
  v_fma_f32 v49, v49, v45, -v53
  v_cvt_pk_bf16_f32 v56, v49, v50
  ds_write_b32 v32, v56 offset:12512
  v_mul_f32 v53, v50, v46
  v_mul_f32 v54, v50, v45
  v_fma_f32 v50, v49, v46, v54
  v_fma_f32 v49, v49, v45, -v53
  v_cvt_pk_bf16_f32 v56, v49, v50
  ds_write_b32 v32, v56 offset:12784
  v_mul_f32 v53, v50, v46
  v_mul_f32 v54, v50, v45
  v_fma_f32 v50, v49, v46, v54
  v_fma_f32 v49, v49, v45, -v53
  v_cvt_pk_bf16_f32 v56, v49, v50
  ds_write_b32 v32, v56 offset:13056
  s_waitcnt lgkmcnt(15)
  v_mfma_f32_16x16x32_bf16 v[92:95], v[148:151], v[180:183], 0
  v_mfma_f32_16x16x32_bf16 v[96:99], v[164:167], v[180:183], 0
  v_mfma_f32_16x16x32_bf16 v[92:95], v[152:155], v[184:187], v[92:95]
  v_mfma_f32_16x16x32_bf16 v[96:99], v[168:171], v[184:187], v[96:99]
  v_mfma_f32_16x16x32_bf16 v[92:95], v[156:159], v[188:191], v[92:95]
  v_mfma_f32_16x16x32_bf16 v[96:99], v[172:175], v[188:191], v[96:99]
  v_mfma_f32_16x16x32_bf16 v[92:95], v[160:163], v[192:195], v[92:95]
  v_mfma_f32_16x16x32_bf16 v[96:99], v[176:179], v[192:195], v[96:99]
  ds_read_b128 v[180:183], v33 offset:0
  ds_read_b128 v[184:187], v33 offset:64
  ds_read_b128 v[188:191], v33 offset:128
  ds_read_b128 v[192:195], v33 offset:192
  s_waitcnt lgkmcnt(0)
  v_mfma_f32_16x16x32_bf16 v[100:103], v[148:151], v[180:183], 0
  v_mfma_f32_16x16x32_bf16 v[104:107], v[164:167], v[180:183], 0
  v_mfma_f32_16x16x32_bf16 v[100:103], v[152:155], v[184:187], v[100:103]
  v_mfma_f32_16x16x32_bf16 v[104:107], v[168:171], v[184:187], v[104:107]
  v_mfma_f32_16x16x32_bf16 v[100:103], v[156:159], v[188:191], v[100:103]
  v_mfma_f32_16x16x32_bf16 v[104:107], v[172:175], v[188:191], v[104:107]
  v_mfma_f32_16x16x32_bf16 v[100:103], v[160:163], v[192:195], v[100:103]
  v_mfma_f32_16x16x32_bf16 v[104:107], v[176:179], v[192:195], v[104:107]
  v_cndmask_b32_e64 v76, v108, v76, s[34:35]
  v_cndmask_b32_e64 v77, v109, v77, s[34:35]
  v_cndmask_b32_e64 v78, v110, v78, s[34:35]
  v_cndmask_b32_e64 v79, v111, v79, s[34:35]
  v_cndmask_b32_e64 v80, v112, v80, s[34:35]
  v_cndmask_b32_e64 v81, v113, v81, s[34:35]
  v_cndmask_b32_e64 v82, v114, v82, s[34:35]
  v_cndmask_b32_e64 v83, v115, v83, s[34:35]
  s_cmp_eq_u32 s9, 1
  s_cselect_b32 s34, -1, 0
  s_mov_b32 s35, s34
  v_cndmask_b32_e64 v116, v92, v76, s[34:35]
  v_cndmask_b32_e64 v76, v76, v92, s[34:35]
  v_cndmask_b32_e64 v117, v93, v77, s[34:35]
  v_cndmask_b32_e64 v77, v77, v93, s[34:35]
  v_cndmask_b32_e64 v118, v94, v78, s[34:35]
  v_cndmask_b32_e64 v78, v78, v94, s[34:35]
  v_cndmask_b32_e64 v119, v95, v79, s[34:35]
  v_cndmask_b32_e64 v79, v79, v95, s[34:35]
  v_cndmask_b32_e64 v120, v96, v80, s[34:35]
  v_cndmask_b32_e64 v80, v80, v96, s[34:35]
  v_cndmask_b32_e64 v121, v97, v81, s[34:35]
  v_cndmask_b32_e64 v81, v81, v97, s[34:35]
  v_cndmask_b32_e64 v122, v98, v82, s[34:35]
  v_cndmask_b32_e64 v82, v82, v98, s[34:35]
  v_cndmask_b32_e64 v123, v99, v83, s[34:35]
  v_cndmask_b32_e64 v83, v83, v99, s[34:35]
  v_cndmask_b32_e64 v124, v100, v84, s[34:35]
  v_cndmask_b32_e64 v84, v84, v100, s[34:35]
  v_cndmask_b32_e64 v125, v101, v85, s[34:35]
  v_cndmask_b32_e64 v85, v85, v101, s[34:35]
  v_cndmask_b32_e64 v126, v102, v86, s[34:35]
  v_cndmask_b32_e64 v86, v86, v102, s[34:35]
  v_cndmask_b32_e64 v127, v103, v87, s[34:35]
  v_cndmask_b32_e64 v87, v87, v103, s[34:35]
  v_cndmask_b32_e64 v128, v104, v88, s[34:35]
  v_cndmask_b32_e64 v88, v88, v104, s[34:35]
  v_cndmask_b32_e64 v129, v105, v89, s[34:35]
  v_cndmask_b32_e64 v89, v89, v105, s[34:35]
  v_cndmask_b32_e64 v130, v106, v90, s[34:35]
  v_cndmask_b32_e64 v90, v90, v106, s[34:35]
  v_cndmask_b32_e64 v131, v107, v91, s[34:35]
  v_cndmask_b32_e64 v91, v91, v107, s[34:35]
  ds_write_b128 v34, v[116:119] offset:0
  ds_write_b128 v34, v[120:123] offset:1024
  ds_write_b128 v34, v[124:127] offset:2048
  ds_write_b128 v34, v[128:131] offset:3072
  s_lshl_b32 s5, s9, 11
  v_subrev_u32 v36, s5, v36
  s_waitcnt lgkmcnt(0)
  v_mov_b32 v17, 1
  ds_write_b32 v15, v17
c_x1_w:
  ds_read_b32 v17, v16
  s_waitcnt lgkmcnt(0)
  v_readfirstlane_b32 s36, v17
  s_cmp_ge_u32 s36, 1
  s_cbranch_scc1 c_x1_g
  s_add_u32 s53, s53, 1
  s_cmp_ge_u32 s53, 2097152
  s_cbranch_scc1 c_x1_g
  s_sleep 1
  s_branch c_x1_w
c_x1_g:
  ds_read_b128 v[116:119], v35 offset:0
  ds_read_b128 v[120:123], v35 offset:1024
  ds_read_b128 v[124:127], v35 offset:2048
  ds_read_b128 v[128:131], v35 offset:3072
  s_waitcnt lgkmcnt(3)
  v_add_f32 v76, v76, v116
  v_add_f32 v77, v77, v117
  v_add_f32 v78, v78, v118
  v_add_f32 v79, v79, v119
  v_cvt_pk_bf16_f32 v132, v76, v77
  v_cvt_pk_bf16_f32 v133, v78, v79
  ds_write_b64 v36, v[132:133] offset:3104
  s_waitcnt lgkmcnt(3)
  v_add_f32 v80, v80, v120
  v_add_f32 v81, v81, v121
  v_add_f32 v82, v82, v122
  v_add_f32 v83, v83, v123
  v_cvt_pk_bf16_f32 v134, v80, v81
  v_cvt_pk_bf16_f32 v135, v82, v83
  ds_write_b64 v36, v[134:135] offset:3072
  s_waitcnt lgkmcnt(3)
  v_add_f32 v84, v84, v124
  v_add_f32 v85, v85, v125
  v_add_f32 v86, v86, v126
  v_add_f32 v87, v87, v127
  v_cvt_pk_bf16_f32 v136, v84, v85
  v_cvt_pk_bf16_f32 v137, v86, v87
  ds_write_b64 v36, v[136:137] offset:2080
  s_waitcnt lgkmcnt(3)
  v_add_f32 v88, v88, v128
  v_add_f32 v89, v89, v129
  v_add_f32 v90, v90, v130
  v_add_f32 v91, v91, v131
  v_cvt_pk_bf16_f32 v138, v88, v89
  v_cvt_pk_bf16_f32 v139, v90, v91
  ds_write_b64 v36, v[138:139] offset:2048
  v_and_b32 v3, 7, v1
  v_lshl_add_u32 v3, v3, 3, s23
  ds_write_b64 v3, v[20:21] offset:4096
  s_waitcnt lgkmcnt(0)
  v_mov_b32 v17, 2
  ds_write_b32 v15, v17
c_x2_w:
  ds_read_b32 v17, v16
  s_waitcnt lgkmcnt(0)
  v_readfirstlane_b32 s36, v17
  s_cmp_ge_u32 s36, 2
  s_cbranch_scc1 c_x2_g
  s_add_u32 s53, s53, 1
  s_cmp_ge_u32 s53, 2097152
  s_cbranch_scc1 c_x2_g
  s_sleep 1
  s_branch c_x2_w
c_x2_g:
  ds_read_b128 v[116:119], v39 offset:0
  ds_read_b128 v[120:123], v39 offset:16
  s_waitcnt lgkmcnt(0)
  v_mov_b32 v124, v117
  v_mov_b32 v125, v118
  v_mov_b32 v126, v119
  v_mov_b32 v127, v120
  v_mov_b32 v128, v121
  v_mov_b32 v129, v122
  v_alignbit_b32 v132, v117, v116, 16
  v_alignbit_b32 v133, v118, v117, 16
  v_alignbit_b32 v134, v119, v118, 16
  v_alignbit_b32 v135, v120, v119, 16
  v_alignbit_b32 v136, v121, v120, 16
  v_alignbit_b32 v137, v122, v121, 16
  v_alignbit_b32 v138, v123, v122, 16
  v_alignbit_b32 v140, v118, v117, 16
  v_alignbit_b32 v141, v119, v118, 16
  v_alignbit_b32 v142, v120, v119, 16
  v_alignbit_b32 v143, v121, v120, 16
  v_alignbit_b32 v144, v122, v121, 16
  v_alignbit_b32 v145, v123, v122, 16
  ds_write_b128 v39, v[132:135] offset:4160
  ds_write_b128 v39, v[124:127] offset:8320
  ds_write_b128 v39, v[140:143] offset:12480
  ds_write_b128 v39, v[118:121] offset:16640
  ds_write_b128 v39, v[134:137] offset:20800
  ds_write_b128 v39, v[126:129] offset:24960
  ds_write_b128 v39, v[142:145] offset:29120
  ds_read_b128 v[116:119], v39 offset:1024
  ds_read_b128 v[120:123], v39 offset:1040
  s_waitcnt lgkmcnt(0)
  v_mov_b32 v124, v117
  v_mov_b32 v125, v118
  v_mov_b32 v126, v119
  v_mov_b32 v127, v120
  v_mov_b32 v128, v121
  v_mov_b32 v129, v122
  v_alignbit_b32 v132, v117, v116, 16
  v_alignbit_b32 v133, v118, v117, 16
  v_alignbit_b32 v134, v119, v118, 16
  v_alignbit_b32 v135, v120, v119, 16
  v_alignbit_b32 v136, v121, v120, 16
  v_alignbit_b32 v137, v122, v121, 16
  v_alignbit_b32 v138, v123, v122, 16
  v_alignbit_b32 v140, v118, v117, 16
  v_alignbit_b32 v141, v119, v118, 16
  v_alignbit_b32 v142, v120, v119, 16
  v_alignbit_b32 v143, v121, v120, 16
  v_alignbit_b32 v144, v122, v121, 16
  v_alignbit_b32 v145, v123, v122, 16
  ds_write_b128 v39, v[132:135] offset:5184
  ds_write_b128 v39, v[124:127] offset:9344
  ds_write_b128 v39, v[140:143] offset:13504
  ds_write_b128 v39, v[118:121] offset:17664
  ds_write_b128 v39, v[134:137] offset:21824
  ds_write_b128 v39, v[126:129] offset:25984
  ds_write_b128 v39, v[142:145] offset:30144
  v_and_b32 v3, 7, v1
  v_add_u32 v3, 1, v3
  v_min_u32 v3, 7, v3
  v_mul_u32_u24 v3, 4160, v3
  v_add_u32 v3, s23, v3
  ds_write_b128 v3, v[20:23] offset:4096
  v_min_u32 v4, 59, v1
  v_lshl_add_u32 v4, v4, 3, s29
  ds_write_b64 v4, v[20:21]
  s_lshr_b32 s5, s8, 6
  s_lshl_b32 s5, s5, 9
  s_add_u32 s5, s5, 17408000
  v_lshl_add_u32 v51, v1, 2, s5
  v_add_u32 v52, 256, v51
c_s_w:
  buffer_load_dword v53, v51, s[40:43], 0 offen sc1
  buffer_load_dword v54, v52, s[40:43], 0 offen sc1
  s_waitcnt vmcnt(0)
  v_xor_b32 v53, v53, v2
  v_xor_b32 v54, v54, v2
  v_or_b32 v53, v53, v54
  v_cmp_ne_u32 vcc, 0, v53
  s_cmp_eq_u64 vcc, 0
  s_cbranch_scc1 c_s_g
  s_add_u32 s53, s53, 1
  s_cmp_ge_u32 s53, 131072
  s_cbranch_scc1 c_s_g
  s_sleep 24
  s_branch c_s_w
c_s_g:
  s_lshl_b32 s5, s9, 11
  s_add_u32 s6, s29, s5
  s_add_u32 m0, s6, 480
  s_lshl_b32 s6, s8, 12
  s_add_u32 s5, s5, s6
  s_add_u32 s5, s5, 12582912
  buffer_load_dwordx4 v14, s[40:43], s5 offen offset:0 sc1 lds
  buffer_load_dwordx4 v14, s[40:43], s5 offen offset:1024 sc1 lds
  s_cmp_eq_u32 s9, 1
  s_cbranch_scc1 c_v1
  s_waitcnt vmcnt(0)
  s_waitcnt lgkmcnt(0)
  v_mov_b32 v17, 3
  ds_write_b32 v15, v17
  s_mov_b32 s48, s30
  s_mov_b32 s49, s31
  s_mov_b32 s50, 917504
  s_mov_b32 s51, 0x20000
  s_lshl_b32 s5, s55, 2
  s_add_u32 s5, s5, s10
  s_mul_i32 s5, s5, 7168
  v_min_u32 v3, 55, v1
  v_lshlrev_b32 v3, 7, v3
  buffer_load_dword v6, v3, s[48:51], s5 offen
c_y0_w:
  ds_read_b32 v17, v16
  s_waitcnt lgkmcnt(0)
  v_readfirstlane_b32 s36, v17
  s_cmp_ge_u32 s36, 3
  s_cbranch_scc1 c_y0_g
  s_add_u32 s53, s53, 1
  s_cmp_ge_u32 s53, 2097152
  s_cbranch_scc1 c_y0_g
  s_sleep 1
  s_branch c_y0_w
c_y0_g:
  ds_read_b128 v[76:79], v37 offset:4032
  ds_read_b128 v[80:83], v38 offset:4032
  ds_read_b128 v[84:87], v38 offset:3520
  ds_read_b128 v[88:91], v38 offset:960
  ds_read_b128 v[92:95], v38 offset:448
  ds_read_b128 v[96:99], v37 offset:3968
  ds_read_b128 v[100:103], v38 offset:3968
  ds_read_b128 v[104:107], v38 offset:3456
  ds_read_b128 v[108:111], v38 offset:896
  s_waitcnt lgkmcnt(7)
  v_mfma_f32_16x16x32_bf16 v[60:63], v[76:79], v[80:83], 0
  ds_read_b128 v[80:83], v38 offset:384
  s_waitcnt lgkmcnt(7)
  v_mfma_f32_16x16x32_bf16 v[64:67], v[76:79], v[84:87], 0
  ds_read_b128 v[112:115], v37 offset:3904
  ds_read_b128 v[116:119], v38 offset:3904
  s_waitcnt lgkmcnt(8)
  v_mfma_f32_16x16x32_bf16 v[68:71], v[76:79], v[88:91], 0
  ds_read_b128 v[120:123], v38 offset:3392
  s_waitcnt lgkmcnt(8)
  v_mfma_f32_16x16x32_bf16 v[72:75], v[76:79], v[92:95], 0
  ds_read_b128 v[76:79], v38 offset:832
  s_waitcnt lgkmcnt(7)
  v_mfma_f32_16x16x32_bf16 v[60:63], v[96:99], v[100:103], v[60:63]
  ds_read_b128 v[100:103], v38 offset:320
  s_waitcnt lgkmcnt(7)
  v_mfma_f32_16x16x32_bf16 v[64:67], v[96:99], v[104:107], v[64:67]
  ds_read_b128 v[124:127], v37 offset:3840
  ds_read_b128 v[128:131], v38 offset:3840
  s_waitcnt lgkmcnt(8)
  v_mfma_f32_16x16x32_bf16 v[68:71], v[96:99], v[108:111], v[68:71]
  ds_read_b128 v[132:135], v38 offset:3328
  s_waitcnt lgkmcnt(8)
  v_mfma_f32_16x16x32_bf16 v[72:75], v[96:99], v[80:83], v[72:75]
  ds_read_b128 v[96:99], v38 offset:768
  s_waitcnt lgkmcnt(7)
  v_mfma_f32_16x16x32_bf16 v[60:63], v[112:115], v[116:119], v[60:63]
  ds_read_b128 v[116:119], v38 offset:256
  s_waitcnt lgkmcnt(7)
  v_mfma_f32_16x16x32_bf16 v[64:67], v[112:115], v[120:123], v[64:67]
  ds_read_b128 v[136:139], v37 offset:3776
  ds_read_b128 v[140:143], v38 offset:3776
  s_waitcnt lgkmcnt(8)
  v_mfma_f32_16x16x32_bf16 v[68:71], v[112:115], v[76:79], v[68:71]
  ds_read_b128 v[144:147], v38 offset:3264
  s_waitcnt lgkmcnt(8)
  v_mfma_f32_16x16x32_bf16 v[72:75], v[112:115], v[100:103], v[72:75]
  ds_read_b128 v[112:115], v38 offset:704
  s_waitcnt lgkmcnt(7)
  v_mfma_f32_16x16x32_bf16 v[60:63], v[124:127], v[128:131], v[60:63]
  ds_read_b128 v[128:131], v38 offset:192
  s_waitcnt lgkmcnt(7)
  v_mfma_f32_16x16x32_bf16 v[64:67], v[124:127], v[132:135], v[64:67]
  ds_read_b128 v[148:151], v37 offset:3712
  ds_read_b128 v[152:155], v38 offset:3712
  s_waitcnt lgkmcnt(8)
  v_mfma_f32_16x16x32_bf16 v[68:71], v[124:127], v[96:99], v[68:71]
  ds_read_b128 v[156:159], v38 offset:3200
  s_waitcnt lgkmcnt(8)
  v_mfma_f32_16x16x32_bf16 v[72:75], v[124:127], v[116:119], v[72:75]
  ds_read_b128 v[124:127], v38 offset:640
  s_waitcnt lgkmcnt(7)
  v_mfma_f32_16x16x32_bf16 v[60:63], v[136:139], v[140:143], v[60:63]
  ds_read_b128 v[140:143], v38 offset:128
  s_waitcnt lgkmcnt(7)
  v_mfma_f32_16x16x32_bf16 v[64:67], v[136:139], v[144:147], v[64:67]
  ds_read_b128 v[160:163], v37 offset:3648
  ds_read_b128 v[164:167], v38 offset:3648
  s_waitcnt lgkmcnt(8)
  v_mfma_f32_16x16x32_bf16 v[68:71], v[136:139], v[112:115], v[68:71]
  ds_read_b128 v[168:171], v38 offset:3136
  s_waitcnt lgkmcnt(8)
  v_mfma_f32_16x16x32_bf16 v[72:75], v[136:139], v[128:131], v[72:75]
  ds_read_b128 v[136:139], v38 offset:576
  s_waitcnt lgkmcnt(7)
  v_mfma_f32_16x16x32_bf16 v[60:63], v[148:151], v[152:155], v[60:63]
  ds_read_b128 v[152:155], v38 offset:64
  s_waitcnt lgkmcnt(7)
  v_mfma_f32_16x16x32_bf16 v[64:67], v[148:151], v[156:159], v[64:67]
  ds_read_b128 v[172:175], v37 offset:3584
  ds_read_b128 v[176:179], v38 offset:3584
  s_waitcnt lgkmcnt(8)
  v_mfma_f32_16x16x32_bf16 v[68:71], v[148:151], v[124:127], v[68:71]
  ds_read_b128 v[180:183], v38 offset:3072
  s_waitcnt lgkmcnt(8)
  v_mfma_f32_16x16x32_bf16 v[72:75], v[148:151], v[140:143], v[72:75]
  ds_read_b128 v[148:151], v38 offset:512
  s_waitcnt lgkmcnt(7)
  v_mfma_f32_16x16x32_bf16 v[60:63], v[160:163], v[164:167], v[60:63]
  ds_read_b128 v[164:167], v38 offset:0
  s_waitcnt lgkmcnt(7)
  v_mfma_f32_16x16x32_bf16 v[64:67], v[160:163], v[168:171], v[64:67]
  ds_read_b128 v[184:187], v37 offset:3520
  s_waitcnt lgkmcnt(7)
  v_mfma_f32_16x16x32_bf16 v[68:71], v[160:163], v[136:139], v[68:71]
  ds_read_b128 v[188:191], v38 offset:3008
  s_waitcnt lgkmcnt(7)
  v_mfma_f32_16x16x32_bf16 v[72:75], v[160:163], v[152:155], v[72:75]
  s_waitcnt lgkmcnt(5)
  v_mfma_f32_16x16x32_bf16 v[60:63], v[172:175], v[176:179], v[60:63]
  ds_read_b128 v[160:163], v37 offset:3456
  s_waitcnt lgkmcnt(5)
  v_mfma_f32_16x16x32_bf16 v[64:67], v[172:175], v[180:183], v[64:67]
  ds_read_b128 v[176:179], v38 offset:2944
  s_waitcnt lgkmcnt(5)
  v_mfma_f32_16x16x32_bf16 v[68:71], v[172:175], v[148:151], v[68:71]
  s_waitcnt lgkmcnt(4)
  v_mfma_f32_16x16x32_bf16 v[72:75], v[172:175], v[164:167], v[72:75]
  ds_read_b128 v[172:175], v37 offset:3392
  s_waitcnt lgkmcnt(4)
  v_mfma_f32_16x16x32_bf16 v[60:63], v[184:187], v[84:87], v[60:63]
  ds_read_b128 v[84:87], v38 offset:2880
  s_waitcnt lgkmcnt(4)
  v_mfma_f32_16x16x32_bf16 v[64:67], v[184:187], v[188:191], v[64:67]
  v_mfma_f32_16x16x32_bf16 v[68:71], v[184:187], v[92:95], v[68:71]
  ds_read_b128 v[184:187], v37 offset:3328
  s_waitcnt lgkmcnt(4)
  v_mfma_f32_16x16x32_bf16 v[60:63], v[160:163], v[104:107], v[60:63]
  ds_read_b128 v[104:107], v38 offset:2816
  s_waitcnt lgkmcnt(4)
  v_mfma_f32_16x16x32_bf16 v[64:67], v[160:163], v[176:179], v[64:67]
  v_mfma_f32_16x16x32_bf16 v[68:71], v[160:163], v[80:83], v[68:71]
  ds_read_b128 v[160:163], v37 offset:3264
  s_waitcnt lgkmcnt(4)
  v_mfma_f32_16x16x32_bf16 v[60:63], v[172:175], v[120:123], v[60:63]
  ds_read_b128 v[120:123], v38 offset:2752
  s_waitcnt lgkmcnt(4)
  v_mfma_f32_16x16x32_bf16 v[64:67], v[172:175], v[84:87], v[64:67]
  v_mfma_f32_16x16x32_bf16 v[68:71], v[172:175], v[100:103], v[68:71]
  ds_read_b128 v[172:175], v37 offset:3200
  s_waitcnt lgkmcnt(4)
  v_mfma_f32_16x16x32_bf16 v[60:63], v[184:187], v[132:135], v[60:63]
  ds_read_b128 v[132:135], v38 offset:2688
  s_waitcnt lgkmcnt(4)
  v_mfma_f32_16x16x32_bf16 v[64:67], v[184:187], v[104:107], v[64:67]
  v_mfma_f32_16x16x32_bf16 v[68:71], v[184:187], v[116:119], v[68:71]
  ds_read_b128 v[184:187], v37 offset:3136
  s_waitcnt lgkmcnt(4)
  v_mfma_f32_16x16x32_bf16 v[60:63], v[160:163], v[144:147], v[60:63]
  ds_read_b128 v[144:147], v38 offset:2624
  s_waitcnt lgkmcnt(4)
  v_mfma_f32_16x16x32_bf16 v[64:67], v[160:163], v[120:123], v[64:67]
  v_mfma_f32_16x16x32_bf16 v[68:71], v[160:163], v[128:131], v[68:71]
  ds_read_b128 v[160:163], v37 offset:3072
  s_waitcnt lgkmcnt(4)
  v_mfma_f32_16x16x32_bf16 v[60:63], v[172:175], v[156:159], v[60:63]
  ds_read_b128 v[156:159], v38 offset:2560
  s_waitcnt lgkmcnt(4)
  v_mfma_f32_16x16x32_bf16 v[64:67], v[172:175], v[132:135], v[64:67]
  v_mfma_f32_16x16x32_bf16 v[68:71], v[172:175], v[140:143], v[68:71]
  ds_read_b128 v[172:175], v37 offset:3008
  s_waitcnt lgkmcnt(4)
  v_mfma_f32_16x16x32_bf16 v[60:63], v[184:187], v[168:171], v[60:63]
  ds_read_b128 v[168:171], v38 offset:2496
  s_waitcnt lgkmcnt(4)
  v_mfma_f32_16x16x32_bf16 v[64:67], v[184:187], v[144:147], v[64:67]
  ds_read_b128 v[192:195], v37 offset:2944
  v_mfma_f32_16x16x32_bf16 v[68:71], v[184:187], v[152:155], v[68:71]
  ds_read_b128 v[184:187], v38 offset:2432
  s_waitcnt lgkmcnt(5)
  v_mfma_f32_16x16x32_bf16 v[60:63], v[160:163], v[180:183], v[60:63]
  ds_read_b128 v[180:183], v37 offset:2880
  s_waitcnt lgkmcnt(5)
  v_mfma_f32_16x16x32_bf16 v[64:67], v[160:163], v[156:159], v[64:67]
  ds_read_b128 v[152:155], v38 offset:2368
  v_mfma_f32_16x16x32_bf16 v[68:71], v[160:163], v[164:167], v[68:71]
  ds_read_b128 v[160:163], v37 offset:2816
  s_waitcnt lgkmcnt(6)
  v_mfma_f32_16x16x32_bf16 v[60:63], v[172:175], v[188:191], v[60:63]
  ds_read_b128 v[188:191], v38 offset:2304
  s_waitcnt lgkmcnt(6)
  v_mfma_f32_16x16x32_bf16 v[64:67], v[172:175], v[168:171], v[64:67]
  ds_read_b128 v[172:175], v37 offset:2752
  s_waitcnt lgkmcnt(6)
  v_mfma_f32_16x16x32_bf16 v[60:63], v[192:195], v[176:179], v[60:63]
  ds_read_b128 v[176:179], v38 offset:2240
  s_waitcnt lgkmcnt(6)
  v_mfma_f32_16x16x32_bf16 v[64:67], v[192:195], v[184:187], v[64:67]
  ds_read_b128 v[192:195], v37 offset:2688
  s_waitcnt lgkmcnt(6)
  v_mfma_f32_16x16x32_bf16 v[60:63], v[180:183], v[84:87], v[60:63]
  ds_read_b128 v[84:87], v38 offset:2176
  s_waitcnt lgkmcnt(6)
  v_mfma_f32_16x16x32_bf16 v[64:67], v[180:183], v[152:155], v[64:67]
  ds_read_b128 v[180:183], v37 offset:2624
  s_waitcnt lgkmcnt(6)
  v_mfma_f32_16x16x32_bf16 v[60:63], v[160:163], v[104:107], v[60:63]
  ds_read_b128 v[104:107], v38 offset:2112
  s_waitcnt lgkmcnt(6)
  v_mfma_f32_16x16x32_bf16 v[64:67], v[160:163], v[188:191], v[64:67]
  ds_read_b128 v[160:163], v37 offset:2560
  s_waitcnt lgkmcnt(6)
  v_mfma_f32_16x16x32_bf16 v[60:63], v[172:175], v[120:123], v[60:63]
  ds_read_b128 v[120:123], v38 offset:2048
  s_waitcnt lgkmcnt(6)
  v_mfma_f32_16x16x32_bf16 v[64:67], v[172:175], v[176:179], v[64:67]
  ds_read_b128 v[172:175], v37 offset:2496
  s_waitcnt lgkmcnt(6)
  v_mfma_f32_16x16x32_bf16 v[60:63], v[192:195], v[132:135], v[60:63]
  ds_read_b128 v[132:135], v38 offset:1984
  s_waitcnt lgkmcnt(6)
  v_mfma_f32_16x16x32_bf16 v[64:67], v[192:195], v[84:87], v[64:67]
  ds_read_b128 v[192:195], v37 offset:2432
  s_waitcnt lgkmcnt(6)
  v_mfma_f32_16x16x32_bf16 v[60:63], v[180:183], v[144:147], v[60:63]
  ds_read_b128 v[144:147], v38 offset:1920
  s_waitcnt lgkmcnt(6)
  v_mfma_f32_16x16x32_bf16 v[64:67], v[180:183], v[104:107], v[64:67]
  ds_read_b128 v[180:183], v37 offset:2368
  s_waitcnt lgkmcnt(6)
  v_mfma_f32_16x16x32_bf16 v[60:63], v[160:163], v[156:159], v[60:63]
  ds_read_b128 v[156:159], v38 offset:1856
  s_waitcnt lgkmcnt(6)
  v_mfma_f32_16x16x32_bf16 v[64:67], v[160:163], v[120:123], v[64:67]
  ds_read_b128 v[160:163], v37 offset:2304
  s_waitcnt lgkmcnt(6)
  v_mfma_f32_16x16x32_bf16 v[60:63], v[172:175], v[168:171], v[60:63]
  ds_read_b128 v[168:171], v38 offset:1792
  s_waitcnt lgkmcnt(6)
  v_mfma_f32_16x16x32_bf16 v[64:67], v[172:175], v[132:135], v[64:67]
  ds_read_b128 v[172:175], v37 offset:2240
  s_waitcnt lgkmcnt(6)
  v_mfma_f32_16x16x32_bf16 v[60:63], v[192:195], v[184:187], v[60:63]
  ds_read_b128 v[184:187], v38 offset:1728
  s_waitcnt lgkmcnt(6)
  v_mfma_f32_16x16x32_bf16 v[64:67], v[192:195], v[144:147], v[64:67]
  ds_read_b128 v[192:195], v37 offset:2176
  s_waitcnt lgkmcnt(6)
  v_mfma_f32_16x16x32_bf16 v[60:63], v[180:183], v[152:155], v[60:63]
  ds_read_b128 v[152:155], v38 offset:1664
  s_waitcnt lgkmcnt(6)
  v_mfma_f32_16x16x32_bf16 v[64:67], v[180:183], v[156:159], v[64:67]
  ds_read_b128 v[180:183], v37 offset:2112
  s_waitcnt lgkmcnt(6)
  v_mfma_f32_16x16x32_bf16 v[60:63], v[160:163], v[188:191], v[60:63]
  ds_read_b128 v[188:191], v38 offset:1600
  s_waitcnt lgkmcnt(6)
  v_mfma_f32_16x16x32_bf16 v[64:67], v[160:163], v[168:171], v[64:67]
  ds_read_b128 v[160:163], v37 offset:2048
  s_waitcnt lgkmcnt(6)
  v_mfma_f32_16x16x32_bf16 v[60:63], v[172:175], v[176:179], v[60:63]
  ds_read_b128 v[176:179], v38 offset:1536
  s_waitcnt lgkmcnt(6)
  v_mfma_f32_16x16x32_bf16 v[64:67], v[172:175], v[184:187], v[64:67]
  ds_read_b128 v[172:175], v37 offset:1984
  s_waitcnt lgkmcnt(6)
  v_mfma_f32_16x16x32_bf16 v[60:63], v[192:195], v[84:87], v[60:63]
  ds_read_b128 v[84:87], v38 offset:1472
  s_waitcnt lgkmcnt(6)
  v_mfma_f32_16x16x32_bf16 v[64:67], v[192:195], v[152:155], v[64:67]
  ds_read_b128 v[192:195], v37 offset:1920
  s_waitcnt lgkmcnt(6)
  v_mfma_f32_16x16x32_bf16 v[60:63], v[180:183], v[104:107], v[60:63]
  ds_read_b128 v[104:107], v38 offset:1408
  s_waitcnt lgkmcnt(6)
  v_mfma_f32_16x16x32_bf16 v[64:67], v[180:183], v[188:191], v[64:67]
  ds_read_b128 v[180:183], v37 offset:1856
  s_waitcnt lgkmcnt(6)
  v_mfma_f32_16x16x32_bf16 v[60:63], v[160:163], v[120:123], v[60:63]
  ds_read_b128 v[120:123], v38 offset:1344
  s_waitcnt lgkmcnt(6)
  v_mfma_f32_16x16x32_bf16 v[64:67], v[160:163], v[176:179], v[64:67]
  ds_read_b128 v[160:163], v37 offset:1792
  s_waitcnt lgkmcnt(6)
  v_mfma_f32_16x16x32_bf16 v[60:63], v[172:175], v[132:135], v[60:63]
  ds_read_b128 v[132:135], v38 offset:1280
  s_waitcnt lgkmcnt(6)
  v_mfma_f32_16x16x32_bf16 v[64:67], v[172:175], v[84:87], v[64:67]
  ds_read_b128 v[172:175], v37 offset:1728
  s_waitcnt lgkmcnt(6)
  v_mfma_f32_16x16x32_bf16 v[60:63], v[192:195], v[144:147], v[60:63]
  ds_read_b128 v[144:147], v38 offset:1216
  s_waitcnt lgkmcnt(6)
  v_mfma_f32_16x16x32_bf16 v[64:67], v[192:195], v[104:107], v[64:67]
  ds_read_b128 v[192:195], v37 offset:1664
  s_waitcnt lgkmcnt(6)
  v_mfma_f32_16x16x32_bf16 v[60:63], v[180:183], v[156:159], v[60:63]
  ds_read_b128 v[156:159], v38 offset:1152
  s_waitcnt lgkmcnt(6)
  v_mfma_f32_16x16x32_bf16 v[64:67], v[180:183], v[120:123], v[64:67]
  ds_read_b128 v[180:183], v37 offset:1600
  s_waitcnt lgkmcnt(6)
  v_mfma_f32_16x16x32_bf16 v[60:63], v[160:163], v[168:171], v[60:63]
  ds_read_b128 v[168:171], v38 offset:1088
  s_waitcnt lgkmcnt(6)
  v_mfma_f32_16x16x32_bf16 v[64:67], v[160:163], v[132:135], v[64:67]
  ds_read_b128 v[160:163], v37 offset:1536
  s_waitcnt lgkmcnt(6)
  v_mfma_f32_16x16x32_bf16 v[60:63], v[172:175], v[184:187], v[60:63]
  ds_read_b128 v[184:187], v38 offset:1024
  s_waitcnt lgkmcnt(6)
  v_mfma_f32_16x16x32_bf16 v[64:67], v[172:175], v[144:147], v[64:67]
  ds_read_b128 v[172:175], v37 offset:1472
  s_waitcnt lgkmcnt(6)
  v_mfma_f32_16x16x32_bf16 v[60:63], v[192:195], v[152:155], v[60:63]
  s_waitcnt lgkmcnt(5)
  v_mfma_f32_16x16x32_bf16 v[64:67], v[192:195], v[156:159], v[64:67]
  ds_read_b128 v[152:155], v37 offset:1408
  s_waitcnt lgkmcnt(5)
  v_mfma_f32_16x16x32_bf16 v[60:63], v[180:183], v[188:191], v[60:63]
  s_waitcnt lgkmcnt(4)
  v_mfma_f32_16x16x32_bf16 v[64:67], v[180:183], v[168:171], v[64:67]
  ds_read_b128 v[180:183], v37 offset:1344
  s_waitcnt lgkmcnt(4)
  v_mfma_f32_16x16x32_bf16 v[60:63], v[160:163], v[176:179], v[60:63]
  s_waitcnt lgkmcnt(3)
  v_mfma_f32_16x16x32_bf16 v[64:67], v[160:163], v[184:187], v[64:67]
  ds_read_b128 v[160:163], v37 offset:1280
  s_waitcnt lgkmcnt(3)
  v_mfma_f32_16x16x32_bf16 v[60:63], v[172:175], v[84:87], v[60:63]
  v_mfma_f32_16x16x32_bf16 v[64:67], v[172:175], v[88:91], v[64:67]
  ds_read_b128 v[84:87], v37 offset:1216
  s_waitcnt lgkmcnt(3)
  v_mfma_f32_16x16x32_bf16 v[60:63], v[152:155], v[104:107], v[60:63]
  v_mfma_f32_16x16x32_bf16 v[64:67], v[152:155], v[108:111], v[64:67]
  ds_read_b128 v[104:107], v37 offset:1152
  s_waitcnt lgkmcnt(3)
  v_mfma_f32_16x16x32_bf16 v[60:63], v[180:183], v[120:123], v[60:63]
  v_mfma_f32_16x16x32_bf16 v[64:67], v[180:183], v[76:79], v[64:67]
  ds_read_b128 v[120:123], v37 offset:1088
  s_waitcnt lgkmcnt(3)
  v_mfma_f32_16x16x32_bf16 v[60:63], v[160:163], v[132:135], v[60:63]
  v_mfma_f32_16x16x32_bf16 v[64:67], v[160:163], v[96:99], v[64:67]
  ds_read_b128 v[132:135], v37 offset:1024
  s_waitcnt lgkmcnt(3)
  v_mfma_f32_16x16x32_bf16 v[60:63], v[84:87], v[144:147], v[60:63]
  v_mfma_f32_16x16x32_bf16 v[64:67], v[84:87], v[112:115], v[64:67]
  ds_read_b128 v[84:87], v37 offset:960
  s_waitcnt lgkmcnt(3)
  v_mfma_f32_16x16x32_bf16 v[60:63], v[104:107], v[156:159], v[60:63]
  v_mfma_f32_16x16x32_bf16 v[64:67], v[104:107], v[124:127], v[64:67]
  ds_read_b128 v[104:107], v37 offset:896
  s_waitcnt lgkmcnt(3)
  v_mfma_f32_16x16x32_bf16 v[60:63], v[120:123], v[168:171], v[60:63]
  v_mfma_f32_16x16x32_bf16 v[64:67], v[120:123], v[136:139], v[64:67]
  ds_read_b128 v[120:123], v37 offset:832
  s_waitcnt lgkmcnt(3)
  v_mfma_f32_16x16x32_bf16 v[60:63], v[132:135], v[184:187], v[60:63]
  v_mfma_f32_16x16x32_bf16 v[64:67], v[132:135], v[148:151], v[64:67]
  ds_read_b128 v[132:135], v37 offset:768
  s_waitcnt lgkmcnt(3)
  v_mfma_f32_16x16x32_bf16 v[60:63], v[84:87], v[88:91], v[60:63]
  v_mfma_f32_16x16x32_bf16 v[64:67], v[84:87], v[92:95], v[64:67]
  ds_read_b128 v[84:87], v37 offset:704
  s_waitcnt lgkmcnt(3)
  v_mfma_f32_16x16x32_bf16 v[60:63], v[104:107], v[108:111], v[60:63]
  v_mfma_f32_16x16x32_bf16 v[64:67], v[104:107], v[80:83], v[64:67]
  ds_read_b128 v[88:91], v37 offset:640
  s_waitcnt lgkmcnt(3)
  v_mfma_f32_16x16x32_bf16 v[60:63], v[120:123], v[76:79], v[60:63]
  v_mfma_f32_16x16x32_bf16 v[64:67], v[120:123], v[100:103], v[64:67]
  ds_read_b128 v[76:79], v37 offset:576
  s_waitcnt lgkmcnt(3)
  v_mfma_f32_16x16x32_bf16 v[60:63], v[132:135], v[96:99], v[60:63]
  ds_read_b128 v[96:99], v38 offset:64
  v_mfma_f32_16x16x32_bf16 v[64:67], v[132:135], v[116:119], v[64:67]
  ds_read_b128 v[104:107], v37 offset:512
  s_waitcnt lgkmcnt(4)
  v_mfma_f32_16x16x32_bf16 v[60:63], v[84:87], v[112:115], v[60:63]
  v_mfma_f32_16x16x32_bf16 v[64:67], v[84:87], v[128:131], v[64:67]
  ds_read_b128 v[84:87], v37 offset:448
  s_waitcnt lgkmcnt(4)
  v_mfma_f32_16x16x32_bf16 v[60:63], v[88:91], v[124:127], v[60:63]
  ds_read_b128 v[108:111], v37 offset:384
  v_mfma_f32_16x16x32_bf16 v[64:67], v[88:91], v[140:143], v[64:67]
  ds_read_b128 v[88:91], v37 offset:320
  s_waitcnt lgkmcnt(5)
  v_mfma_f32_16x16x32_bf16 v[60:63], v[76:79], v[136:139], v[60:63]
  ds_read_b128 v[112:115], v37 offset:256
  s_waitcnt lgkmcnt(5)
  v_mfma_f32_16x16x32_bf16 v[64:67], v[76:79], v[96:99], v[64:67]
  ds_read_b128 v[76:79], v37 offset:192
  s_waitcnt lgkmcnt(5)
  v_mfma_f32_16x16x32_bf16 v[60:63], v[104:107], v[148:151], v[60:63]
  ds_read_b128 v[120:123], v37 offset:128
  v_mfma_f32_16x16x32_bf16 v[64:67], v[104:107], v[164:167], v[64:67]
  ds_read_b128 v[104:107], v37 offset:64
  s_waitcnt lgkmcnt(6)
  v_mfma_f32_16x16x32_bf16 v[60:63], v[84:87], v[92:95], v[60:63]
  ds_read_b128 v[84:87], v37 offset:0
  s_waitcnt lgkmcnt(6)
  v_mfma_f32_16x16x32_bf16 v[60:63], v[108:111], v[80:83], v[60:63]
  s_waitcnt lgkmcnt(5)
  v_mfma_f32_16x16x32_bf16 v[60:63], v[88:91], v[100:103], v[60:63]
  s_waitcnt lgkmcnt(4)
  v_mfma_f32_16x16x32_bf16 v[60:63], v[112:115], v[116:119], v[60:63]
  s_waitcnt lgkmcnt(3)
  v_mfma_f32_16x16x32_bf16 v[60:63], v[76:79], v[128:131], v[60:63]
  s_waitcnt lgkmcnt(2)
  v_mfma_f32_16x16x32_bf16 v[60:63], v[120:123], v[140:143], v[60:63]
  s_waitcnt lgkmcnt(1)
  v_mfma_f32_16x16x32_bf16 v[60:63], v[104:107], v[96:99], v[60:63]
  s_waitcnt lgkmcnt(0)
  v_mfma_f32_16x16x32_bf16 v[60:63], v[84:87], v[164:167], v[60:63]
  ds_read_b64 v[76:77], v42 offset:3584
  ds_read_b64 v[78:79], v42 offset:3072
  ds_read_b64 v[80:81], v42 offset:512
  ds_read_b64 v[82:83], v42 offset:0
  s_lshl_b32 s5, s8, 12
  s_add_u32 s5, s5, 14680064
  s_waitcnt lgkmcnt(3)
  v_lshlrev_b32 v84, 16, v76
  v_and_b32 v85, 0xffff0000, v76
  v_lshlrev_b32 v86, 16, v77
  v_and_b32 v87, 0xffff0000, v77
  v_mul_f32 v84, v84, v12
  v_mul_f32 v85, v85, v12
  v_mul_f32 v86, v86, v12
  v_mul_f32 v87, v87, v12
  v_cvt_pk_bf16_f32 v88, v84, v85
  v_cvt_pk_bf16_f32 v90, v60, v61
  v_cvt_pk_bf16_f32 v89, v86, v87
  v_cvt_pk_bf16_f32 v91, v62, v63
  v_lshlrev_b32 v84, 16, v88
  v_and_b32 v85, 0xffff0000, v88
  v_lshlrev_b32 v60, 16, v90
  v_and_b32 v61, 0xffff0000, v90
  v_lshlrev_b32 v86, 16, v89
  v_and_b32 v87, 0xffff0000, v89
  v_lshlrev_b32 v62, 16, v91
  v_and_b32 v63, 0xffff0000, v91
  v_add_f32 v84, v84, v60
  v_add_f32 v85, v85, v61
  v_add_f32 v86, v86, v62
  v_add_f32 v87, v87, v63
  v_cvt_pk_bf16_f32 v60, v84, v85
  v_cvt_pk_bf16_f32 v61, v86, v87
  buffer_store_dwordx2 v[60:61], v41, s[40:43], s5 offen offset:3584 sc1
  s_waitcnt lgkmcnt(2)
  v_lshlrev_b32 v84, 16, v78
  v_and_b32 v85, 0xffff0000, v78
  v_lshlrev_b32 v86, 16, v79
  v_and_b32 v87, 0xffff0000, v79
  v_mul_f32 v84, v84, v12
  v_mul_f32 v85, v85, v12
  v_mul_f32 v86, v86, v12
  v_mul_f32 v87, v87, v12
  v_cvt_pk_bf16_f32 v88, v84, v85
  v_cvt_pk_bf16_f32 v90, v64, v65
  v_cvt_pk_bf16_f32 v89, v86, v87
  v_cvt_pk_bf16_f32 v91, v66, v67
  v_lshlrev_b32 v84, 16, v88
  v_and_b32 v85, 0xffff0000, v88
  v_lshlrev_b32 v64, 16, v90
  v_and_b32 v65, 0xffff0000, v90
  v_lshlrev_b32 v86, 16, v89
  v_and_b32 v87, 0xffff0000, v89
  v_lshlrev_b32 v66, 16, v91
  v_and_b32 v67, 0xffff0000, v91
  v_add_f32 v84, v84, v64
  v_add_f32 v85, v85, v65
  v_add_f32 v86, v86, v66
  v_add_f32 v87, v87, v67
  v_cvt_pk_bf16_f32 v64, v84, v85
  v_cvt_pk_bf16_f32 v65, v86, v87
  buffer_store_dwordx2 v[64:65], v41, s[40:43], s5 offen offset:3072 sc1
  s_waitcnt lgkmcnt(1)
  v_lshlrev_b32 v84, 16, v80
  v_and_b32 v85, 0xffff0000, v80
  v_lshlrev_b32 v86, 16, v81
  v_and_b32 v87, 0xffff0000, v81
  v_mul_f32 v84, v84, v12
  v_mul_f32 v85, v85, v12
  v_mul_f32 v86, v86, v12
  v_mul_f32 v87, v87, v12
  v_cvt_pk_bf16_f32 v88, v84, v85
  v_cvt_pk_bf16_f32 v90, v68, v69
  v_cvt_pk_bf16_f32 v89, v86, v87
  v_cvt_pk_bf16_f32 v91, v70, v71
  v_lshlrev_b32 v84, 16, v88
  v_and_b32 v85, 0xffff0000, v88
  v_lshlrev_b32 v68, 16, v90
  v_and_b32 v69, 0xffff0000, v90
  v_lshlrev_b32 v86, 16, v89
  v_and_b32 v87, 0xffff0000, v89
  v_lshlrev_b32 v70, 16, v91
  v_and_b32 v71, 0xffff0000, v91
  v_add_f32 v84, v84, v68
  v_add_f32 v85, v85, v69
  v_add_f32 v86, v86, v70
  v_add_f32 v87, v87, v71
  v_cvt_pk_bf16_f32 v68, v84, v85
  v_cvt_pk_bf16_f32 v69, v86, v87
  buffer_store_dwordx2 v[68:69], v41, s[40:43], s5 offen offset:512 sc1
  s_waitcnt lgkmcnt(0)
  v_lshlrev_b32 v84, 16, v82
  v_and_b32 v85, 0xffff0000, v82
  v_lshlrev_b32 v86, 16, v83
  v_and_b32 v87, 0xffff0000, v83
  v_mul_f32 v84, v84, v12
  v_mul_f32 v85, v85, v12
  v_mul_f32 v86, v86, v12
  v_mul_f32 v87, v87, v12
  v_cvt_pk_bf16_f32 v88, v84, v85
  v_cvt_pk_bf16_f32 v90, v72, v73
  v_cvt_pk_bf16_f32 v89, v86, v87
  v_cvt_pk_bf16_f32 v91, v74, v75
  v_lshlrev_b32 v84, 16, v88
  v_and_b32 v85, 0xffff0000, v88
  v_lshlrev_b32 v72, 16, v90
  v_and_b32 v73, 0xffff0000, v90
  v_lshlrev_b32 v86, 16, v89
  v_and_b32 v87, 0xffff0000, v89
  v_lshlrev_b32 v74, 16, v91
  v_and_b32 v75, 0xffff0000, v91
  v_add_f32 v84, v84, v72
  v_add_f32 v85, v85, v73
  v_add_f32 v86, v86, v74
  v_add_f32 v87, v87, v75
  v_cvt_pk_bf16_f32 v72, v84, v85
  v_cvt_pk_bf16_f32 v73, v86, v87
  buffer_store_dwordx2 v[72:73], v41, s[40:43], s5 offen offset:0 sc1
  s_cmp_ge_u32 s55, 28
  s_cbranch_scc1 c_ng0
  v_lshlrev_b32 v100, 16, v252
  v_and_b32 v101, 0xffff0000, v252
  v_lshlrev_b32 v102, 16, v253
  v_and_b32 v103, 0xffff0000, v253
  v_lshlrev_b32 v104, 16, v254
  v_and_b32 v105, 0xffff0000, v254
  v_lshlrev_b32 v106, 16, v255
  v_and_b32 v107, 0xffff0000, v255
  v_lshlrev_b32 v92, 16, v240
  v_and_b32 v93, 0xffff0000, v240
  v_lshlrev_b32 v94, 16, v241
  v_and_b32 v95, 0xffff0000, v241
  v_lshlrev_b32 v96, 16, v242
  v_and_b32 v97, 0xffff0000, v242
  v_lshlrev_b32 v98, 16, v243
  v_and_b32 v99, 0xffff0000, v243
  v_mul_f32 v92, v92, v100
  v_mul_f32 v93, v93, v101
  v_mul_f32 v94, v94, v102
  v_mul_f32 v95, v95, v103
  v_mul_f32 v96, v96, v104
  v_mul_f32 v97, v97, v105
  v_mul_f32 v98, v98, v106
  v_mul_f32 v99, v99, v107
  v_cvt_pk_bf16_f32 v240, v92, v93
  v_cvt_pk_bf16_f32 v241, v94, v95
  v_cvt_pk_bf16_f32 v242, v96, v97
  v_cvt_pk_bf16_f32 v243, v98, v99
  v_lshlrev_b32 v92, 16, v240
  v_and_b32 v93, 0xffff0000, v240
  v_lshlrev_b32 v94, 16, v241
  v_and_b32 v95, 0xffff0000, v241
  v_lshlrev_b32 v96, 16, v242
  v_and_b32 v97, 0xffff0000, v242
  v_lshlrev_b32 v98, 16, v243
  v_and_b32 v99, 0xffff0000, v243
  v_add_f32 v92, v92, v96
  v_add_f32 v93, v93, v97
  v_add_f32 v94, v94, v98
  v_add_f32 v95, v95, v99
  v_add_f32 v92, v92, v94
  v_add_f32 v93, v93, v95
  v_add_f32 v108, v92, v93
  v_lshlrev_b32 v92, 16, v244
  v_and_b32 v93, 0xffff0000, v244
  v_lshlrev_b32 v94, 16, v245
  v_and_b32 v95, 0xffff0000, v245
  v_lshlrev_b32 v96, 16, v246
  v_and_b32 v97, 0xffff0000, v246
  v_lshlrev_b32 v98, 16, v247
  v_and_b32 v99, 0xffff0000, v247
  v_mul_f32 v92, v92, v100
  v_mul_f32 v93, v93, v101
  v_mul_f32 v94, v94, v102
  v_mul_f32 v95, v95, v103
  v_mul_f32 v96, v96, v104
  v_mul_f32 v97, v97, v105
  v_mul_f32 v98, v98, v106
  v_mul_f32 v99, v99, v107
  v_cvt_pk_bf16_f32 v244, v92, v93
  v_cvt_pk_bf16_f32 v245, v94, v95
  v_cvt_pk_bf16_f32 v246, v96, v97
  v_cvt_pk_bf16_f32 v247, v98, v99
  v_lshlrev_b32 v92, 16, v244
  v_and_b32 v93, 0xffff0000, v244
  v_lshlrev_b32 v94, 16, v245
  v_and_b32 v95, 0xffff0000, v245
  v_lshlrev_b32 v96, 16, v246
  v_and_b32 v97, 0xffff0000, v246
  v_lshlrev_b32 v98, 16, v247
  v_and_b32 v99, 0xffff0000, v247
  v_add_f32 v92, v92, v96
  v_add_f32 v93, v93, v97
  v_add_f32 v94, v94, v98
  v_add_f32 v95, v95, v99
  v_add_f32 v92, v92, v94
  v_add_f32 v93, v93, v95
  v_add_f32 v109, v92, v93
  v_lshlrev_b32 v92, 16, v248
  v_and_b32 v93, 0xffff0000, v248
  v_lshlrev_b32 v94, 16, v249
  v_and_b32 v95, 0xffff0000, v249
  v_lshlrev_b32 v96, 16, v250
  v_and_b32 v97, 0xffff0000, v250
  v_lshlrev_b32 v98, 16, v251
  v_and_b32 v99, 0xffff0000, v251
  v_mul_f32 v92, v92, v100
  v_mul_f32 v93, v93, v101
  v_mul_f32 v94, v94, v102
  v_mul_f32 v95, v95, v103
  v_mul_f32 v96, v96, v104
  v_mul_f32 v97, v97, v105
  v_mul_f32 v98, v98, v106
  v_mul_f32 v99, v99, v107
  v_cvt_pk_bf16_f32 v248, v92, v93
  v_cvt_pk_bf16_f32 v249, v94, v95
  v_cvt_pk_bf16_f32 v250, v96, v97
  v_cvt_pk_bf16_f32 v251, v98, v99
  v_lshlrev_b32 v92, 16, v248
  v_and_b32 v93, 0xffff0000, v248
  v_lshlrev_b32 v94, 16, v249
  v_and_b32 v95, 0xffff0000, v249
  v_lshlrev_b32 v96, 16, v250
  v_and_b32 v97, 0xffff0000, v250
  v_lshlrev_b32 v98, 16, v251
  v_and_b32 v99, 0xffff0000, v251
  v_add_f32 v92, v92, v96
  v_add_f32 v93, v93, v97
  v_add_f32 v94, v94, v98
  v_add_f32 v95, v95, v99
  v_add_f32 v92, v92, v94
  v_add_f32 v93, v93, v95
  v_add_f32 v110, v92, v93
  v_mov_b32 v111, 0
  s_nop 0
  v_permlane32_swap_b32 v108, v110
  v_permlane32_swap_b32 v109, v111
  v_add_f32 v108, v108, v110
  v_add_f32 v109, v109, v111
  s_nop 1
  v_permlane16_swap_b32 v108, v109
  v_add_f32 v108, v108, v109
  s_nop 1
  v_add_f32_dpp v108, v108, v108 row_mirror row_mask:0xf bank_mask:0xf
  s_nop 1
  v_add_f32_dpp v108, v108, v108 row_half_mirror row_mask:0xf bank_mask:0xf
  s_nop 1
  v_add_f32_dpp v108, v108, v108 quad_perm:[2,3,0,1] row_mask:0xf bank_mask:0xf
  s_nop 1
  v_add_f32_dpp v108, v108, v108 quad_perm:[1,0,3,2] row_mask:0xf bank_mask:0xf
  v_cvt_pk_bf16_f32 v108, v108, v108
  v_lshlrev_b32 v108, 16, v108
  v_mul_f32 v108, 0xbfb8aa3b, v108
  v_exp_f32 v108, v108
  s_nop 0
  v_add_f32 v108, 1.0, v108
  v_rcp_f32 v108, v108
  s_nop 0
  v_cvt_pk_bf16_f32 v108, v108, v108
  v_lshlrev_b32 v108, 16, v108
  v_lshrrev_b32 v3, 4, v1
  v_mul_u32_u24 v3, 28, v3
  v_add_u32 v3, s15, v3
  v_and_b32 v4, 15, v1
  v_lshl_add_u32 v4, v4, 6, v3
  v_cmp_gt_u32 vcc, 64, v4
  v_lshlrev_b32 v3, 2, v3
  v_mov_b32 v4, 1073741824
  v_cndmask_b32 v3, v4, v3, vcc
  s_lshl_b32 s5, s12, 8
  s_add_u32 s5, s5, 16777216
  buffer_store_dword v108, v3, s[40:43], s5 offen sc1
c_ng0:
  s_waitcnt vmcnt(0)
  v_mov_b32 v3, 1
  v_mov_b32 v4, 162604
  s_mov_b64 exec, 1
  ds_add_rtn_u32 v5, v4, v3
  s_lshl_b32 s5, s2, 7
  s_add_u32 s5, s5, 17473536
  s_waitcnt lgkmcnt(0)
  v_readfirstlane_b32 s6, v5
  s_mov_b64 exec, -1
  s_cmp_eq_u32 s6, 3
  s_cselect_b32 s5, s5, 1073741824
  buffer_store_dword v2, off, s[40:43], s5 sc1
  s_endpgm
c_v1:
  s_waitcnt vmcnt(0)
  s_waitcnt lgkmcnt(0)
  v_mov_b32 v17, 3
  ds_write_b32 v15, v17
  s_mov_b32 s48, s30
  s_mov_b32 s49, s31
  s_mov_b32 s50, 917504
  s_mov_b32 s51, 0x20000
  s_lshl_b32 s5, s55, 2
  s_add_u32 s5, s5, s10
  s_mul_i32 s5, s5, 7168
  v_min_u32 v3, 55, v1
  v_lshlrev_b32 v3, 7, v3
  buffer_load_dword v6, v3, s[48:51], s5 offen
c_y1_w:
  ds_read_b32 v17, v16
  s_waitcnt lgkmcnt(0)
  v_readfirstlane_b32 s36, v17
  s_cmp_ge_u32 s36, 3
  s_cbranch_scc1 c_y1_g
  s_add_u32 s53, s53, 1
  s_cmp_ge_u32 s53, 2097152
  s_cbranch_scc1 c_y1_g
  s_sleep 1
  s_branch c_y1_w
c_y1_g:
  ds_read_b128 v[76:79], v37 offset:4032
  ds_read_b128 v[80:83], v38 offset:3008
  ds_read_b128 v[84:87], v38 offset:2496
  ds_read_b128 v[88:91], v38 offset:1984
  ds_read_b128 v[92:95], v38 offset:1472
  ds_read_b128 v[96:99], v37 offset:3968
  ds_read_b128 v[100:103], v38 offset:2944
  ds_read_b128 v[104:107], v38 offset:2432
  ds_read_b128 v[108:111], v38 offset:1920
  s_waitcnt lgkmcnt(7)
  v_mfma_f32_16x16x32_bf16 v[60:63], v[76:79], v[80:83], 0
  ds_read_b128 v[80:83], v38 offset:1408
  s_waitcnt lgkmcnt(7)
  v_mfma_f32_16x16x32_bf16 v[64:67], v[76:79], v[84:87], 0
  ds_read_b128 v[112:115], v37 offset:3904
  ds_read_b128 v[116:119], v38 offset:2880
  s_waitcnt lgkmcnt(8)
  v_mfma_f32_16x16x32_bf16 v[68:71], v[76:79], v[88:91], 0
  ds_read_b128 v[120:123], v38 offset:2368
  s_waitcnt lgkmcnt(8)
  v_mfma_f32_16x16x32_bf16 v[72:75], v[76:79], v[92:95], 0
  ds_read_b128 v[76:79], v38 offset:1856
  s_waitcnt lgkmcnt(7)
  v_mfma_f32_16x16x32_bf16 v[60:63], v[96:99], v[100:103], v[60:63]
  ds_read_b128 v[100:103], v38 offset:1344
  s_waitcnt lgkmcnt(7)
  v_mfma_f32_16x16x32_bf16 v[64:67], v[96:99], v[104:107], v[64:67]
  ds_read_b128 v[124:127], v37 offset:3840
  ds_read_b128 v[128:131], v38 offset:2816
  s_waitcnt lgkmcnt(8)
  v_mfma_f32_16x16x32_bf16 v[68:71], v[96:99], v[108:111], v[68:71]
  ds_read_b128 v[132:135], v38 offset:2304
  s_waitcnt lgkmcnt(8)
  v_mfma_f32_16x16x32_bf16 v[72:75], v[96:99], v[80:83], v[72:75]
  ds_read_b128 v[96:99], v38 offset:1792
  s_waitcnt lgkmcnt(7)
  v_mfma_f32_16x16x32_bf16 v[60:63], v[112:115], v[116:119], v[60:63]
  ds_read_b128 v[116:119], v38 offset:1280
  s_waitcnt lgkmcnt(7)
  v_mfma_f32_16x16x32_bf16 v[64:67], v[112:115], v[120:123], v[64:67]
  ds_read_b128 v[136:139], v37 offset:3776
  ds_read_b128 v[140:143], v38 offset:2752
  s_waitcnt lgkmcnt(8)
  v_mfma_f32_16x16x32_bf16 v[68:71], v[112:115], v[76:79], v[68:71]
  ds_read_b128 v[144:147], v38 offset:2240
  s_waitcnt lgkmcnt(8)
  v_mfma_f32_16x16x32_bf16 v[72:75], v[112:115], v[100:103], v[72:75]
  ds_read_b128 v[112:115], v38 offset:1728
  s_waitcnt lgkmcnt(7)
  v_mfma_f32_16x16x32_bf16 v[60:63], v[124:127], v[128:131], v[60:63]
  ds_read_b128 v[128:131], v38 offset:1216
  s_waitcnt lgkmcnt(7)
  v_mfma_f32_16x16x32_bf16 v[64:67], v[124:127], v[132:135], v[64:67]
  ds_read_b128 v[148:151], v37 offset:3712
  ds_read_b128 v[152:155], v38 offset:2688
  s_waitcnt lgkmcnt(8)
  v_mfma_f32_16x16x32_bf16 v[68:71], v[124:127], v[96:99], v[68:71]
  ds_read_b128 v[156:159], v38 offset:2176
  s_waitcnt lgkmcnt(8)
  v_mfma_f32_16x16x32_bf16 v[72:75], v[124:127], v[116:119], v[72:75]
  ds_read_b128 v[124:127], v38 offset:1664
  s_waitcnt lgkmcnt(7)
  v_mfma_f32_16x16x32_bf16 v[60:63], v[136:139], v[140:143], v[60:63]
  ds_read_b128 v[140:143], v38 offset:1152
  s_waitcnt lgkmcnt(7)
  v_mfma_f32_16x16x32_bf16 v[64:67], v[136:139], v[144:147], v[64:67]
  ds_read_b128 v[160:163], v37 offset:3648
  ds_read_b128 v[164:167], v38 offset:2624
  s_waitcnt lgkmcnt(8)
  v_mfma_f32_16x16x32_bf16 v[68:71], v[136:139], v[112:115], v[68:71]
  ds_read_b128 v[168:171], v38 offset:2112
  s_waitcnt lgkmcnt(8)
  v_mfma_f32_16x16x32_bf16 v[72:75], v[136:139], v[128:131], v[72:75]
  ds_read_b128 v[136:139], v38 offset:1600
  s_waitcnt lgkmcnt(7)
  v_mfma_f32_16x16x32_bf16 v[60:63], v[148:151], v[152:155], v[60:63]
  ds_read_b128 v[152:155], v38 offset:1088
  s_waitcnt lgkmcnt(7)
  v_mfma_f32_16x16x32_bf16 v[64:67], v[148:151], v[156:159], v[64:67]
  ds_read_b128 v[172:175], v37 offset:3584
  ds_read_b128 v[176:179], v38 offset:2560
  s_waitcnt lgkmcnt(8)
  v_mfma_f32_16x16x32_bf16 v[68:71], v[148:151], v[124:127], v[68:71]
  ds_read_b128 v[180:183], v38 offset:2048
  s_waitcnt lgkmcnt(8)
  v_mfma_f32_16x16x32_bf16 v[72:75], v[148:151], v[140:143], v[72:75]
  ds_read_b128 v[148:151], v38 offset:1536
  s_waitcnt lgkmcnt(7)
  v_mfma_f32_16x16x32_bf16 v[60:63], v[160:163], v[164:167], v[60:63]
  ds_read_b128 v[164:167], v38 offset:1024
  s_waitcnt lgkmcnt(7)
  v_mfma_f32_16x16x32_bf16 v[64:67], v[160:163], v[168:171], v[64:67]
  ds_read_b128 v[184:187], v37 offset:3520
  s_waitcnt lgkmcnt(7)
  v_mfma_f32_16x16x32_bf16 v[68:71], v[160:163], v[136:139], v[68:71]
  s_waitcnt lgkmcnt(6)
  v_mfma_f32_16x16x32_bf16 v[72:75], v[160:163], v[152:155], v[72:75]
  s_waitcnt lgkmcnt(4)
  v_mfma_f32_16x16x32_bf16 v[60:63], v[172:175], v[176:179], v[60:63]
  ds_read_b128 v[160:163], v38 offset:960
  s_waitcnt lgkmcnt(4)
  v_mfma_f32_16x16x32_bf16 v[64:67], v[172:175], v[180:183], v[64:67]
  ds_read_b128 v[176:179], v37 offset:3456
  s_waitcnt lgkmcnt(4)
  v_mfma_f32_16x16x32_bf16 v[68:71], v[172:175], v[148:151], v[68:71]
  s_waitcnt lgkmcnt(3)
  v_mfma_f32_16x16x32_bf16 v[72:75], v[172:175], v[164:167], v[72:75]
  s_waitcnt lgkmcnt(2)
  v_mfma_f32_16x16x32_bf16 v[60:63], v[184:187], v[84:87], v[60:63]
  ds_read_b128 v[84:87], v38 offset:896
  v_mfma_f32_16x16x32_bf16 v[64:67], v[184:187], v[88:91], v[64:67]
  ds_read_b128 v[172:175], v37 offset:3392
  v_mfma_f32_16x16x32_bf16 v[68:71], v[184:187], v[92:95], v[68:71]
  s_waitcnt lgkmcnt(3)
  v_mfma_f32_16x16x32_bf16 v[72:75], v[184:187], v[160:163], v[72:75]
  s_waitcnt lgkmcnt(2)
  v_mfma_f32_16x16x32_bf16 v[60:63], v[176:179], v[104:107], v[60:63]
  ds_read_b128 v[104:107], v38 offset:832
  v_mfma_f32_16x16x32_bf16 v[64:67], v[176:179], v[108:111], v[64:67]
  ds_read_b128 v[184:187], v37 offset:3328
  v_mfma_f32_16x16x32_bf16 v[68:71], v[176:179], v[80:83], v[68:71]
  s_waitcnt lgkmcnt(3)
  v_mfma_f32_16x16x32_bf16 v[72:75], v[176:179], v[84:87], v[72:75]
  s_waitcnt lgkmcnt(2)
  v_mfma_f32_16x16x32_bf16 v[60:63], v[172:175], v[120:123], v[60:63]
  ds_read_b128 v[120:123], v38 offset:768
  v_mfma_f32_16x16x32_bf16 v[64:67], v[172:175], v[76:79], v[64:67]
  ds_read_b128 v[176:179], v37 offset:3264
  v_mfma_f32_16x16x32_bf16 v[68:71], v[172:175], v[100:103], v[68:71]
  s_waitcnt lgkmcnt(3)
  v_mfma_f32_16x16x32_bf16 v[72:75], v[172:175], v[104:107], v[72:75]
  s_waitcnt lgkmcnt(2)
  v_mfma_f32_16x16x32_bf16 v[60:63], v[184:187], v[132:135], v[60:63]
  ds_read_b128 v[132:135], v38 offset:704
  v_mfma_f32_16x16x32_bf16 v[64:67], v[184:187], v[96:99], v[64:67]
  ds_read_b128 v[172:175], v37 offset:3200
  v_mfma_f32_16x16x32_bf16 v[68:71], v[184:187], v[116:119], v[68:71]
  s_waitcnt lgkmcnt(3)
  v_mfma_f32_16x16x32_bf16 v[72:75], v[184:187], v[120:123], v[72:75]
  s_waitcnt lgkmcnt(2)
  v_mfma_f32_16x16x32_bf16 v[60:63], v[176:179], v[144:147], v[60:63]
  ds_read_b128 v[144:147], v38 offset:640
  v_mfma_f32_16x16x32_bf16 v[64:67], v[176:179], v[112:115], v[64:67]
  ds_read_b128 v[184:187], v37 offset:3136
  v_mfma_f32_16x16x32_bf16 v[68:71], v[176:179], v[128:131], v[68:71]
  s_waitcnt lgkmcnt(3)
  v_mfma_f32_16x16x32_bf16 v[72:75], v[176:179], v[132:135], v[72:75]
  s_waitcnt lgkmcnt(2)
  v_mfma_f32_16x16x32_bf16 v[60:63], v[172:175], v[156:159], v[60:63]
  ds_read_b128 v[156:159], v38 offset:576
  v_mfma_f32_16x16x32_bf16 v[64:67], v[172:175], v[124:127], v[64:67]
  ds_read_b128 v[176:179], v37 offset:3072
  v_mfma_f32_16x16x32_bf16 v[68:71], v[172:175], v[140:143], v[68:71]
  s_waitcnt lgkmcnt(3)
  v_mfma_f32_16x16x32_bf16 v[72:75], v[172:175], v[144:147], v[72:75]
  s_waitcnt lgkmcnt(2)
  v_mfma_f32_16x16x32_bf16 v[60:63], v[184:187], v[168:171], v[60:63]
  ds_read_b128 v[168:171], v38 offset:512
  v_mfma_f32_16x16x32_bf16 v[64:67], v[184:187], v[136:139], v[64:67]
  ds_read_b128 v[172:175], v37 offset:3008
  v_mfma_f32_16x16x32_bf16 v[68:71], v[184:187], v[152:155], v[68:71]
  s_waitcnt lgkmcnt(3)
  v_mfma_f32_16x16x32_bf16 v[72:75], v[184:187], v[156:159], v[72:75]
  s_waitcnt lgkmcnt(2)
  v_mfma_f32_16x16x32_bf16 v[60:63], v[176:179], v[180:183], v[60:63]
  ds_read_b128 v[180:183], v38 offset:448
  v_mfma_f32_16x16x32_bf16 v[64:67], v[176:179], v[148:151], v[64:67]
  ds_read_b128 v[184:187], v37 offset:2944
  v_mfma_f32_16x16x32_bf16 v[68:71], v[176:179], v[164:167], v[68:71]
  s_waitcnt lgkmcnt(3)
  v_mfma_f32_16x16x32_bf16 v[72:75], v[176:179], v[168:171], v[72:75]
  s_waitcnt lgkmcnt(2)
  v_mfma_f32_16x16x32_bf16 v[60:63], v[172:175], v[88:91], v[60:63]
  ds_read_b128 v[88:91], v38 offset:384
  v_mfma_f32_16x16x32_bf16 v[64:67], v[172:175], v[92:95], v[64:67]
  ds_read_b128 v[176:179], v37 offset:2880
  v_mfma_f32_16x16x32_bf16 v[68:71], v[172:175], v[160:163], v[68:71]
  s_waitcnt lgkmcnt(3)
  v_mfma_f32_16x16x32_bf16 v[72:75], v[172:175], v[180:183], v[72:75]
  s_waitcnt lgkmcnt(2)
  v_mfma_f32_16x16x32_bf16 v[60:63], v[184:187], v[108:111], v[60:63]
  ds_read_b128 v[108:111], v38 offset:320
  v_mfma_f32_16x16x32_bf16 v[64:67], v[184:187], v[80:83], v[64:67]
  ds_read_b128 v[172:175], v37 offset:2816
  v_mfma_f32_16x16x32_bf16 v[68:71], v[184:187], v[84:87], v[68:71]
  s_waitcnt lgkmcnt(3)
  v_mfma_f32_16x16x32_bf16 v[72:75], v[184:187], v[88:91], v[72:75]
  s_waitcnt lgkmcnt(2)
  v_mfma_f32_16x16x32_bf16 v[60:63], v[176:179], v[76:79], v[60:63]
  ds_read_b128 v[76:79], v38 offset:256
  v_mfma_f32_16x16x32_bf16 v[64:67], v[176:179], v[100:103], v[64:67]
  ds_read_b128 v[184:187], v37 offset:2752
  v_mfma_f32_16x16x32_bf16 v[68:71], v[176:179], v[104:107], v[68:71]
  s_waitcnt lgkmcnt(3)
  v_mfma_f32_16x16x32_bf16 v[72:75], v[176:179], v[108:111], v[72:75]
  s_waitcnt lgkmcnt(2)
  v_mfma_f32_16x16x32_bf16 v[60:63], v[172:175], v[96:99], v[60:63]
  ds_read_b128 v[96:99], v38 offset:192
  v_mfma_f32_16x16x32_bf16 v[64:67], v[172:175], v[116:119], v[64:67]
  ds_read_b128 v[176:179], v37 offset:2688
  v_mfma_f32_16x16x32_bf16 v[68:71], v[172:175], v[120:123], v[68:71]
  s_waitcnt lgkmcnt(3)
  v_mfma_f32_16x16x32_bf16 v[72:75], v[172:175], v[76:79], v[72:75]
  s_waitcnt lgkmcnt(2)
  v_mfma_f32_16x16x32_bf16 v[60:63], v[184:187], v[112:115], v[60:63]
  ds_read_b128 v[112:115], v38 offset:128
  v_mfma_f32_16x16x32_bf16 v[64:67], v[184:187], v[128:131], v[64:67]
  ds_read_b128 v[172:175], v37 offset:2624
  v_mfma_f32_16x16x32_bf16 v[68:71], v[184:187], v[132:135], v[68:71]
  s_waitcnt lgkmcnt(3)
  v_mfma_f32_16x16x32_bf16 v[72:75], v[184:187], v[96:99], v[72:75]
  s_waitcnt lgkmcnt(2)
  v_mfma_f32_16x16x32_bf16 v[60:63], v[176:179], v[124:127], v[60:63]
  ds_read_b128 v[124:127], v38 offset:64
  v_mfma_f32_16x16x32_bf16 v[64:67], v[176:179], v[140:143], v[64:67]
  ds_read_b128 v[184:187], v37 offset:2560
  v_mfma_f32_16x16x32_bf16 v[68:71], v[176:179], v[144:147], v[68:71]
  s_waitcnt lgkmcnt(3)
  v_mfma_f32_16x16x32_bf16 v[72:75], v[176:179], v[112:115], v[72:75]
  s_waitcnt lgkmcnt(2)
  v_mfma_f32_16x16x32_bf16 v[60:63], v[172:175], v[136:139], v[60:63]
  ds_read_b128 v[136:139], v38 offset:0
  v_mfma_f32_16x16x32_bf16 v[64:67], v[172:175], v[152:155], v[64:67]
  ds_read_b128 v[176:179], v37 offset:2496
  v_mfma_f32_16x16x32_bf16 v[68:71], v[172:175], v[156:159], v[68:71]
  s_waitcnt lgkmcnt(3)
  v_mfma_f32_16x16x32_bf16 v[72:75], v[172:175], v[124:127], v[72:75]
  s_waitcnt lgkmcnt(2)
  v_mfma_f32_16x16x32_bf16 v[60:63], v[184:187], v[148:151], v[60:63]
  ds_read_b128 v[148:151], v37 offset:2432
  v_mfma_f32_16x16x32_bf16 v[64:67], v[184:187], v[164:167], v[64:67]
  v_mfma_f32_16x16x32_bf16 v[68:71], v[184:187], v[168:171], v[68:71]
  s_waitcnt lgkmcnt(2)
  v_mfma_f32_16x16x32_bf16 v[72:75], v[184:187], v[136:139], v[72:75]
  ds_read_b128 v[172:175], v37 offset:2368
  s_waitcnt lgkmcnt(2)
  v_mfma_f32_16x16x32_bf16 v[60:63], v[176:179], v[92:95], v[60:63]
  v_mfma_f32_16x16x32_bf16 v[64:67], v[176:179], v[160:163], v[64:67]
  v_mfma_f32_16x16x32_bf16 v[68:71], v[176:179], v[180:183], v[68:71]
  ds_read_b128 v[92:95], v37 offset:2304
  s_waitcnt lgkmcnt(2)
  v_mfma_f32_16x16x32_bf16 v[60:63], v[148:151], v[80:83], v[60:63]
  v_mfma_f32_16x16x32_bf16 v[64:67], v[148:151], v[84:87], v[64:67]
  v_mfma_f32_16x16x32_bf16 v[68:71], v[148:151], v[88:91], v[68:71]
  ds_read_b128 v[80:83], v37 offset:2240
  s_waitcnt lgkmcnt(2)
  v_mfma_f32_16x16x32_bf16 v[60:63], v[172:175], v[100:103], v[60:63]
  v_mfma_f32_16x16x32_bf16 v[64:67], v[172:175], v[104:107], v[64:67]
  v_mfma_f32_16x16x32_bf16 v[68:71], v[172:175], v[108:111], v[68:71]
  ds_read_b128 v[100:103], v37 offset:2176
  s_waitcnt lgkmcnt(2)
  v_mfma_f32_16x16x32_bf16 v[60:63], v[92:95], v[116:119], v[60:63]
  v_mfma_f32_16x16x32_bf16 v[64:67], v[92:95], v[120:123], v[64:67]
  v_mfma_f32_16x16x32_bf16 v[68:71], v[92:95], v[76:79], v[68:71]
  ds_read_b128 v[92:95], v37 offset:2112
  s_waitcnt lgkmcnt(2)
  v_mfma_f32_16x16x32_bf16 v[60:63], v[80:83], v[128:131], v[60:63]
  v_mfma_f32_16x16x32_bf16 v[64:67], v[80:83], v[132:135], v[64:67]
  v_mfma_f32_16x16x32_bf16 v[68:71], v[80:83], v[96:99], v[68:71]
  ds_read_b128 v[80:83], v37 offset:2048
  s_waitcnt lgkmcnt(2)
  v_mfma_f32_16x16x32_bf16 v[60:63], v[100:103], v[140:143], v[60:63]
  v_mfma_f32_16x16x32_bf16 v[64:67], v[100:103], v[144:147], v[64:67]
  v_mfma_f32_16x16x32_bf16 v[68:71], v[100:103], v[112:115], v[68:71]
  ds_read_b128 v[100:103], v37 offset:1984
  s_waitcnt lgkmcnt(2)
  v_mfma_f32_16x16x32_bf16 v[60:63], v[92:95], v[152:155], v[60:63]
  v_mfma_f32_16x16x32_bf16 v[64:67], v[92:95], v[156:159], v[64:67]
  ds_read_b128 v[116:119], v37 offset:1920
  v_mfma_f32_16x16x32_bf16 v[68:71], v[92:95], v[124:127], v[68:71]
  s_waitcnt lgkmcnt(2)
  v_mfma_f32_16x16x32_bf16 v[60:63], v[80:83], v[164:167], v[60:63]
  ds_read_b128 v[92:95], v37 offset:1856
  v_mfma_f32_16x16x32_bf16 v[64:67], v[80:83], v[168:171], v[64:67]
  v_mfma_f32_16x16x32_bf16 v[68:71], v[80:83], v[136:139], v[68:71]
  ds_read_b128 v[80:83], v37 offset:1792
  s_waitcnt lgkmcnt(3)
  v_mfma_f32_16x16x32_bf16 v[60:63], v[100:103], v[160:163], v[60:63]
  v_mfma_f32_16x16x32_bf16 v[64:67], v[100:103], v[180:183], v[64:67]
  ds_read_b128 v[100:103], v37 offset:1728
  s_waitcnt lgkmcnt(3)
  v_mfma_f32_16x16x32_bf16 v[60:63], v[116:119], v[84:87], v[60:63]
  v_mfma_f32_16x16x32_bf16 v[64:67], v[116:119], v[88:91], v[64:67]
  ds_read_b128 v[84:87], v37 offset:1664
  s_waitcnt lgkmcnt(3)
  v_mfma_f32_16x16x32_bf16 v[60:63], v[92:95], v[104:107], v[60:63]
  v_mfma_f32_16x16x32_bf16 v[64:67], v[92:95], v[108:111], v[64:67]
  ds_read_b128 v[92:95], v37 offset:1600
  s_waitcnt lgkmcnt(3)
  v_mfma_f32_16x16x32_bf16 v[60:63], v[80:83], v[120:123], v[60:63]
  v_mfma_f32_16x16x32_bf16 v[64:67], v[80:83], v[76:79], v[64:67]
  ds_read_b128 v[80:83], v37 offset:1536
  s_waitcnt lgkmcnt(3)
  v_mfma_f32_16x16x32_bf16 v[60:63], v[100:103], v[132:135], v[60:63]
  v_mfma_f32_16x16x32_bf16 v[64:67], v[100:103], v[96:99], v[64:67]
  ds_read_b128 v[100:103], v37 offset:1472
  s_waitcnt lgkmcnt(3)
  v_mfma_f32_16x16x32_bf16 v[60:63], v[84:87], v[144:147], v[60:63]
  ds_read_b128 v[104:107], v37 offset:1408
  v_mfma_f32_16x16x32_bf16 v[64:67], v[84:87], v[112:115], v[64:67]
  ds_read_b128 v[84:87], v37 offset:1344
  s_waitcnt lgkmcnt(4)
  v_mfma_f32_16x16x32_bf16 v[60:63], v[92:95], v[156:159], v[60:63]
  ds_read_b128 v[116:119], v37 offset:1280
  v_mfma_f32_16x16x32_bf16 v[64:67], v[92:95], v[124:127], v[64:67]
  ds_read_b128 v[92:95], v37 offset:1216
  s_waitcnt lgkmcnt(5)
  v_mfma_f32_16x16x32_bf16 v[60:63], v[80:83], v[168:171], v[60:63]
  ds_read_b128 v[120:123], v37 offset:1152
  v_mfma_f32_16x16x32_bf16 v[64:67], v[80:83], v[136:139], v[64:67]
  ds_read_b128 v[80:83], v37 offset:1088
  s_waitcnt lgkmcnt(6)
  v_mfma_f32_16x16x32_bf16 v[60:63], v[100:103], v[180:183], v[60:63]
  ds_read_b128 v[100:103], v37 offset:1024
  s_waitcnt lgkmcnt(6)
  v_mfma_f32_16x16x32_bf16 v[60:63], v[104:107], v[88:91], v[60:63]
  s_waitcnt lgkmcnt(5)
  v_mfma_f32_16x16x32_bf16 v[60:63], v[84:87], v[108:111], v[60:63]
  s_waitcnt lgkmcnt(4)
  v_mfma_f32_16x16x32_bf16 v[60:63], v[116:119], v[76:79], v[60:63]
  s_waitcnt lgkmcnt(3)
  v_mfma_f32_16x16x32_bf16 v[60:63], v[92:95], v[96:99], v[60:63]
  s_waitcnt lgkmcnt(2)
  v_mfma_f32_16x16x32_bf16 v[60:63], v[120:123], v[112:115], v[60:63]
  s_waitcnt lgkmcnt(1)
  v_mfma_f32_16x16x32_bf16 v[60:63], v[80:83], v[124:127], v[60:63]
  s_waitcnt lgkmcnt(0)
  v_mfma_f32_16x16x32_bf16 v[60:63], v[100:103], v[136:139], v[60:63]
  ds_read_b64 v[76:77], v42 offset:2560
  ds_read_b64 v[78:79], v42 offset:2048
  ds_read_b64 v[80:81], v42 offset:1536
  ds_read_b64 v[82:83], v42 offset:1024
  s_lshl_b32 s5, s8, 12
  s_add_u32 s5, s5, 14680064
  s_waitcnt lgkmcnt(3)
  v_lshlrev_b32 v84, 16, v76
  v_and_b32 v85, 0xffff0000, v76
  v_lshlrev_b32 v86, 16, v77
  v_and_b32 v87, 0xffff0000, v77
  v_mul_f32 v84, v84, v12
  v_mul_f32 v85, v85, v12
  v_mul_f32 v86, v86, v12
  v_mul_f32 v87, v87, v12
  v_cvt_pk_bf16_f32 v88, v84, v85
  v_cvt_pk_bf16_f32 v90, v60, v61
  v_cvt_pk_bf16_f32 v89, v86, v87
  v_cvt_pk_bf16_f32 v91, v62, v63
  v_lshlrev_b32 v84, 16, v88
  v_and_b32 v85, 0xffff0000, v88
  v_lshlrev_b32 v60, 16, v90
  v_and_b32 v61, 0xffff0000, v90
  v_lshlrev_b32 v86, 16, v89
  v_and_b32 v87, 0xffff0000, v89
  v_lshlrev_b32 v62, 16, v91
  v_and_b32 v63, 0xffff0000, v91
  v_add_f32 v84, v84, v60
  v_add_f32 v85, v85, v61
  v_add_f32 v86, v86, v62
  v_add_f32 v87, v87, v63
  v_cvt_pk_bf16_f32 v60, v84, v85
  v_cvt_pk_bf16_f32 v61, v86, v87
  buffer_store_dwordx2 v[60:61], v41, s[40:43], s5 offen offset:2560 sc1
  s_waitcnt lgkmcnt(2)
  v_lshlrev_b32 v84, 16, v78
  v_and_b32 v85, 0xffff0000, v78
  v_lshlrev_b32 v86, 16, v79
  v_and_b32 v87, 0xffff0000, v79
  v_mul_f32 v84, v84, v12
  v_mul_f32 v85, v85, v12
  v_mul_f32 v86, v86, v12
  v_mul_f32 v87, v87, v12
  v_cvt_pk_bf16_f32 v88, v84, v85
  v_cvt_pk_bf16_f32 v90, v64, v65
  v_cvt_pk_bf16_f32 v89, v86, v87
  v_cvt_pk_bf16_f32 v91, v66, v67
  v_lshlrev_b32 v84, 16, v88
  v_and_b32 v85, 0xffff0000, v88
  v_lshlrev_b32 v64, 16, v90
  v_and_b32 v65, 0xffff0000, v90
  v_lshlrev_b32 v86, 16, v89
  v_and_b32 v87, 0xffff0000, v89
  v_lshlrev_b32 v66, 16, v91
  v_and_b32 v67, 0xffff0000, v91
  v_add_f32 v84, v84, v64
  v_add_f32 v85, v85, v65
  v_add_f32 v86, v86, v66
  v_add_f32 v87, v87, v67
  v_cvt_pk_bf16_f32 v64, v84, v85
  v_cvt_pk_bf16_f32 v65, v86, v87
  buffer_store_dwordx2 v[64:65], v41, s[40:43], s5 offen offset:2048 sc1
  s_waitcnt lgkmcnt(1)
  v_lshlrev_b32 v84, 16, v80
  v_and_b32 v85, 0xffff0000, v80
  v_lshlrev_b32 v86, 16, v81
  v_and_b32 v87, 0xffff0000, v81
  v_mul_f32 v84, v84, v12
  v_mul_f32 v85, v85, v12
  v_mul_f32 v86, v86, v12
  v_mul_f32 v87, v87, v12
  v_cvt_pk_bf16_f32 v88, v84, v85
  v_cvt_pk_bf16_f32 v90, v68, v69
  v_cvt_pk_bf16_f32 v89, v86, v87
  v_cvt_pk_bf16_f32 v91, v70, v71
  v_lshlrev_b32 v84, 16, v88
  v_and_b32 v85, 0xffff0000, v88
  v_lshlrev_b32 v68, 16, v90
  v_and_b32 v69, 0xffff0000, v90
  v_lshlrev_b32 v86, 16, v89
  v_and_b32 v87, 0xffff0000, v89
  v_lshlrev_b32 v70, 16, v91
  v_and_b32 v71, 0xffff0000, v91
  v_add_f32 v84, v84, v68
  v_add_f32 v85, v85, v69
  v_add_f32 v86, v86, v70
  v_add_f32 v87, v87, v71
  v_cvt_pk_bf16_f32 v68, v84, v85
  v_cvt_pk_bf16_f32 v69, v86, v87
  buffer_store_dwordx2 v[68:69], v41, s[40:43], s5 offen offset:1536 sc1
  s_waitcnt lgkmcnt(0)
  v_lshlrev_b32 v84, 16, v82
  v_and_b32 v85, 0xffff0000, v82
  v_lshlrev_b32 v86, 16, v83
  v_and_b32 v87, 0xffff0000, v83
  v_mul_f32 v84, v84, v12
  v_mul_f32 v85, v85, v12
  v_mul_f32 v86, v86, v12
  v_mul_f32 v87, v87, v12
  v_cvt_pk_bf16_f32 v88, v84, v85
  v_cvt_pk_bf16_f32 v90, v72, v73
  v_cvt_pk_bf16_f32 v89, v86, v87
  v_cvt_pk_bf16_f32 v91, v74, v75
  v_lshlrev_b32 v84, 16, v88
  v_and_b32 v85, 0xffff0000, v88
  v_lshlrev_b32 v72, 16, v90
  v_and_b32 v73, 0xffff0000, v90
  v_lshlrev_b32 v86, 16, v89
  v_and_b32 v87, 0xffff0000, v89
  v_lshlrev_b32 v74, 16, v91
  v_and_b32 v75, 0xffff0000, v91
  v_add_f32 v84, v84, v72
  v_add_f32 v85, v85, v73
  v_add_f32 v86, v86, v74
  v_add_f32 v87, v87, v75
  v_cvt_pk_bf16_f32 v72, v84, v85
  v_cvt_pk_bf16_f32 v73, v86, v87
  buffer_store_dwordx2 v[72:73], v41, s[40:43], s5 offen offset:1024 sc1
  s_cmp_ge_u32 s55, 28
  s_cbranch_scc1 c_ng1
  v_lshlrev_b32 v100, 16, v252
  v_and_b32 v101, 0xffff0000, v252
  v_lshlrev_b32 v102, 16, v253
  v_and_b32 v103, 0xffff0000, v253
  v_lshlrev_b32 v104, 16, v254
  v_and_b32 v105, 0xffff0000, v254
  v_lshlrev_b32 v106, 16, v255
  v_and_b32 v107, 0xffff0000, v255
  v_lshlrev_b32 v92, 16, v240
  v_and_b32 v93, 0xffff0000, v240
  v_lshlrev_b32 v94, 16, v241
  v_and_b32 v95, 0xffff0000, v241
  v_lshlrev_b32 v96, 16, v242
  v_and_b32 v97, 0xffff0000, v242
  v_lshlrev_b32 v98, 16, v243
  v_and_b32 v99, 0xffff0000, v243
  v_mul_f32 v92, v92, v100
  v_mul_f32 v93, v93, v101
  v_mul_f32 v94, v94, v102
  v_mul_f32 v95, v95, v103
  v_mul_f32 v96, v96, v104
  v_mul_f32 v97, v97, v105
  v_mul_f32 v98, v98, v106
  v_mul_f32 v99, v99, v107
  v_cvt_pk_bf16_f32 v240, v92, v93
  v_cvt_pk_bf16_f32 v241, v94, v95
  v_cvt_pk_bf16_f32 v242, v96, v97
  v_cvt_pk_bf16_f32 v243, v98, v99
  v_lshlrev_b32 v92, 16, v240
  v_and_b32 v93, 0xffff0000, v240
  v_lshlrev_b32 v94, 16, v241
  v_and_b32 v95, 0xffff0000, v241
  v_lshlrev_b32 v96, 16, v242
  v_and_b32 v97, 0xffff0000, v242
  v_lshlrev_b32 v98, 16, v243
  v_and_b32 v99, 0xffff0000, v243
  v_add_f32 v92, v92, v96
  v_add_f32 v93, v93, v97
  v_add_f32 v94, v94, v98
  v_add_f32 v95, v95, v99
  v_add_f32 v92, v92, v94
  v_add_f32 v93, v93, v95
  v_add_f32 v108, v92, v93
  v_lshlrev_b32 v92, 16, v244
  v_and_b32 v93, 0xffff0000, v244
  v_lshlrev_b32 v94, 16, v245
  v_and_b32 v95, 0xffff0000, v245
  v_lshlrev_b32 v96, 16, v246
  v_and_b32 v97, 0xffff0000, v246
  v_lshlrev_b32 v98, 16, v247
  v_and_b32 v99, 0xffff0000, v247
  v_mul_f32 v92, v92, v100
  v_mul_f32 v93, v93, v101
  v_mul_f32 v94, v94, v102
  v_mul_f32 v95, v95, v103
  v_mul_f32 v96, v96, v104
  v_mul_f32 v97, v97, v105
  v_mul_f32 v98, v98, v106
  v_mul_f32 v99, v99, v107
  v_cvt_pk_bf16_f32 v244, v92, v93
  v_cvt_pk_bf16_f32 v245, v94, v95
  v_cvt_pk_bf16_f32 v246, v96, v97
  v_cvt_pk_bf16_f32 v247, v98, v99
  v_lshlrev_b32 v92, 16, v244
  v_and_b32 v93, 0xffff0000, v244
  v_lshlrev_b32 v94, 16, v245
  v_and_b32 v95, 0xffff0000, v245
  v_lshlrev_b32 v96, 16, v246
  v_and_b32 v97, 0xffff0000, v246
  v_lshlrev_b32 v98, 16, v247
  v_and_b32 v99, 0xffff0000, v247
  v_add_f32 v92, v92, v96
  v_add_f32 v93, v93, v97
  v_add_f32 v94, v94, v98
  v_add_f32 v95, v95, v99
  v_add_f32 v92, v92, v94
  v_add_f32 v93, v93, v95
  v_add_f32 v109, v92, v93
  v_lshlrev_b32 v92, 16, v248
  v_and_b32 v93, 0xffff0000, v248
  v_lshlrev_b32 v94, 16, v249
  v_and_b32 v95, 0xffff0000, v249
  v_lshlrev_b32 v96, 16, v250
  v_and_b32 v97, 0xffff0000, v250
  v_lshlrev_b32 v98, 16, v251
  v_and_b32 v99, 0xffff0000, v251
  v_mul_f32 v92, v92, v100
  v_mul_f32 v93, v93, v101
  v_mul_f32 v94, v94, v102
  v_mul_f32 v95, v95, v103
  v_mul_f32 v96, v96, v104
  v_mul_f32 v97, v97, v105
  v_mul_f32 v98, v98, v106
  v_mul_f32 v99, v99, v107
  v_cvt_pk_bf16_f32 v248, v92, v93
  v_cvt_pk_bf16_f32 v249, v94, v95
  v_cvt_pk_bf16_f32 v250, v96, v97
  v_cvt_pk_bf16_f32 v251, v98, v99
  v_lshlrev_b32 v92, 16, v248
  v_and_b32 v93, 0xffff0000, v248
  v_lshlrev_b32 v94, 16, v249
  v_and_b32 v95, 0xffff0000, v249
  v_lshlrev_b32 v96, 16, v250
  v_and_b32 v97, 0xffff0000, v250
  v_lshlrev_b32 v98, 16, v251
  v_and_b32 v99, 0xffff0000, v251
  v_add_f32 v92, v92, v96
  v_add_f32 v93, v93, v97
  v_add_f32 v94, v94, v98
  v_add_f32 v95, v95, v99
  v_add_f32 v92, v92, v94
  v_add_f32 v93, v93, v95
  v_add_f32 v110, v92, v93
  v_mov_b32 v111, 0
  s_nop 0
  v_permlane32_swap_b32 v108, v110
  v_permlane32_swap_b32 v109, v111
  v_add_f32 v108, v108, v110
  v_add_f32 v109, v109, v111
  s_nop 1
  v_permlane16_swap_b32 v108, v109
  v_add_f32 v108, v108, v109
  s_nop 1
  v_add_f32_dpp v108, v108, v108 row_mirror row_mask:0xf bank_mask:0xf
  s_nop 1
  v_add_f32_dpp v108, v108, v108 row_half_mirror row_mask:0xf bank_mask:0xf
  s_nop 1
  v_add_f32_dpp v108, v108, v108 quad_perm:[2,3,0,1] row_mask:0xf bank_mask:0xf
  s_nop 1
  v_add_f32_dpp v108, v108, v108 quad_perm:[1,0,3,2] row_mask:0xf bank_mask:0xf
  v_cvt_pk_bf16_f32 v108, v108, v108
  v_lshlrev_b32 v108, 16, v108
  v_mul_f32 v108, 0xbfb8aa3b, v108
  v_exp_f32 v108, v108
  s_nop 0
  v_add_f32 v108, 1.0, v108
  v_rcp_f32 v108, v108
  s_nop 0
  v_cvt_pk_bf16_f32 v108, v108, v108
  v_lshlrev_b32 v108, 16, v108
  v_lshrrev_b32 v3, 4, v1
  v_mul_u32_u24 v3, 28, v3
  v_add_u32 v3, s15, v3
  v_and_b32 v4, 15, v1
  v_lshl_add_u32 v4, v4, 6, v3
  v_cmp_gt_u32 vcc, 64, v4
  v_lshlrev_b32 v3, 2, v3
  v_mov_b32 v4, 1073741824
  v_cndmask_b32 v3, v4, v3, vcc
  s_lshl_b32 s5, s12, 8
  s_add_u32 s5, s5, 16777216
  buffer_store_dword v108, v3, s[40:43], s5 offen sc1
c_ng1:
  s_waitcnt vmcnt(0)
  v_mov_b32 v3, 1
  v_mov_b32 v4, 162604
  s_mov_b64 exec, 1
  ds_add_rtn_u32 v5, v4, v3
  s_lshl_b32 s5, s2, 7
  s_add_u32 s5, s5, 17473536
  s_waitcnt lgkmcnt(0)
  v_readfirstlane_b32 s6, v5
  s_mov_b64 exec, -1
  s_cmp_eq_u32 s6, 3
  s_cselect_b32 s5, s5, 1073741824
  buffer_store_dword v2, off, s[40:43], s5 sc1
  s_endpgm
p1_retry:
  s_add_u32 s53, s53, 1
  s_cmp_ge_u32 s53, 131072
  s_cbranch_scc1 p1_ready
  s_sleep 1
  s_lshl_b32 s22, s12, 1
  s_add_u32 s22, s22, s10
  s_mul_i32 s22, s22, 7168
  s_add_u32 s22, s22, 16842752
  s_add_u32 s5, s22, 4096
  buffer_load_dwordx2 v[156:157], v38, s[40:43], s22 offen offset:0 sc1
  buffer_load_dwordx2 v[158:159], v38, s[40:43], s22 offen offset:512 sc1
  buffer_load_dwordx2 v[160:161], v38, s[40:43], s22 offen offset:1024 sc1
  buffer_load_dwordx2 v[162:163], v38, s[40:43], s22 offen offset:1536 sc1
  buffer_load_dwordx2 v[164:165], v38, s[40:43], s22 offen offset:2048 sc1
  buffer_load_dwordx2 v[166:167], v38, s[40:43], s22 offen offset:2560 sc1
  buffer_load_dwordx2 v[168:169], v38, s[40:43], s22 offen offset:3072 sc1
  buffer_load_dwordx2 v[170:171], v38, s[40:43], s22 offen offset:3584 sc1
  buffer_load_dwordx2 v[172:173], v38, s[40:43], s5 offen offset:0 sc1
  buffer_load_dwordx2 v[174:175], v38, s[40:43], s5 offen offset:512 sc1
  buffer_load_dwordx2 v[176:177], v38, s[40:43], s5 offen offset:1024 sc1
  buffer_load_dwordx2 v[178:179], v38, s[40:43], s5 offen offset:1536 sc1
  buffer_load_dwordx2 v[180:181], v38, s[40:43], s5 offen offset:2048 sc1
  buffer_load_dwordx2 v[182:183], v38, s[40:43], s5 offen offset:2560 sc1
  s_waitcnt vmcnt(0)
  s_branch p1_check
p2_z_s:
p2_z_w:
  buffer_load_dword v253, v252, s[40:43], 0 offen sc1
  s_waitcnt vmcnt(0)
  v_xor_b32 v253, v253, v2
  v_cmp_ne_u32 vcc, 0, v253
  s_cmp_eq_u64 vcc, 0
  s_cbranch_scc1 p2_z_g
  s_add_u32 s53, s53, 1
  s_cmp_ge_u32 s53, 131072
  s_cbranch_scc1 p2_z_g
  s_sleep 2
  s_branch p2_z_w
p2_z_g:
  s_branch p2_z_b
pk_end:
  s_endpgm
code_end:
.section .rodata,"a"
.p2align 6
.amdhsa_kernel gated_mix__ssm_conv_s4d__mixer_gmlp__prompt_kernel
  .amdhsa_next_free_vgpr 256
  .amdhsa_next_free_sgpr 102
  .amdhsa_accum_offset 256
  .amdhsa_group_segment_fixed_size 0
  .amdhsa_kernarg_size 128
  .amdhsa_user_sgpr_count 2
  .amdhsa_user_sgpr_kernarg_segment_ptr 1
  .amdhsa_system_sgpr_workgroup_id_x 1
  .amdhsa_float_denorm_mode_32 3
.end_amdhsa_kernel
```
